```python
import torch

def _softmax(x, axis=-1):
    return torch.softmax(x, dim=axis)
def _gelu(x):
    return torch.nn.functional.gelu(x, approximate="tanh")
def _silu(x):
    return torch.nn.functional.silu(x)
def _sigmoid(x):
    return torch.sigmoid(x)
def _layernorm(x, axis=-1, eps=1e-5):
    m = x.mean(dim=axis, keepdim=True)
    v = x.var(dim=axis, keepdim=True, unbiased=False)
    return (x - m) / torch.sqrt(v + eps)
def _scatter_add(tgt, idx, src, axis=0):
    return tgt.clone().index_add_(axis, idx, src)
def _segment_sum(src, seg, n):
    out = torch.zeros((n,) + src.shape[1:], dtype=src.dtype)
    return out.index_add_(0, seg, src)
def _pad(x, pw):
    flat = tuple(v for pair in reversed(pw) for v in pair)
    return torch.nn.functional.pad(x, flat)

kernel_name = 'standalone__mha_softmax__near_ridge'

def setup_inputs():

    _w = (lambda a: (lambda t: t.to(torch.bfloat16) if t.is_floating_point() else t)(torch.as_tensor(a)))
    B, H, Sq, Sk, D = 16, 32, 192, 1024, 128
    return {
        "q": _w((lambda *s: torch.randn(*s, dtype=torch.bfloat16) * 0.8)(B, H, Sq, D)),
        "k": _w((lambda *s: torch.randn(*s, dtype=torch.bfloat16) * 0.8)(B, H, Sk, D)),
        "v": _w((lambda *s: torch.randn(*s, dtype=torch.bfloat16) * 0.05)(B, H, Sk, D)),
    }

def reference(q, k, v):
    scale = q.shape[-1] ** -0.5
    scores = torch.einsum("bhqd,bhkd->bhqk", q, k) * scale
    p = _softmax(scores, axis=-1)
    return torch.einsum("bhqk,bhkd->bhqd", p, v)
```

```asm
; @launch grid=(512,1,1) block=(128,1,1) lds=81920
.amdgcn_target "amdgcn-amd-amdhsa--gfx950"
.text
.globl standalone__mha_softmax__near_ridge_kernel
.p2align 8
.type standalone__mha_softmax__near_ridge_kernel,@function
standalone__mha_softmax__near_ridge_kernel:
    s_cmp_ge_u32 s2, 512
    s_cbranch_scc1 L_end
    s_load_dwordx8 s[4:11], s[0:1], 0
    v_lshrrev_b32 v81, 6, v0
    v_and_b32 v76, 63, v0
    v_readfirstlane_b32 s28, v81
    v_and_b32 v77, 15, v76
    v_lshrrev_b32 v78, 4, v76
    v_lshlrev_b32 v82, 8, v78
    v_lshlrev_b32 v81, 1, v78
    v_xor_b32 v81, v77, v81
    v_lshl_add_u32 v152, v81, 4, v82
    v_xor_b32 v153, 128, v152
    v_lshlrev_b32 v81, 2, v78
    v_xor_b32 v81, v77, v81
    v_lshl_add_u32 v154, v81, 4, v82
    s_and_b32 s28, s28, 1
    s_lshl_b32 s32, s28, 12
    s_mul_i32 s34, s28, 24576
    s_mov_b32 s33, 0x41000000
    s_mov_b32 s38, 0x3e0293ee
    s_mov_b32 s39, 0
    s_mul_i32 s40, s2, 262144
    s_mul_i32 s41, s2, 49152
    s_mov_b32 s18, 262144
    s_mov_b32 s19, 0x20000
    s_mov_b32 s14, 49152
    s_mov_b32 s15, 0x20000
    s_mov_b32 s22, 262144
    s_mov_b32 s23, 0x20000
    s_mov_b32 s26, 49152
    s_mov_b32 s27, 0x20000
    s_waitcnt lgkmcnt(0)
    s_add_u32 s16, s6, s40
    s_addc_u32 s17, s7, 0
    s_and_b32 s17, s17, 0xffff
    s_add_u32 s12, s4, s41
    s_addc_u32 s13, s5, 0
    s_and_b32 s13, s13, 0xffff
    s_add_u32 s20, s8, s40
    s_addc_u32 s21, s9, 0
    s_and_b32 s21, s21, 0xffff
    s_add_u32 s24, s10, s41
    s_addc_u32 s25, s11, 0
    s_and_b32 s25, s25, 0xffff
    s_mov_b32 s30, s32
    s_mov_b32 s31, s32
    s_mov_b32 s18, 0x40000
    s_mov_b32 s22, 0x40000
    s_mov_b32 s29, 0
    s_add_u32 m0, s32, 0
    s_nop 0
    buffer_load_dwordx4 v152, s[16:19], s30 offen nt lds
    buffer_load_dwordx4 v153, s[16:19], s30 offen offset:1024 nt lds
    buffer_load_dwordx4 v152, s[16:19], s30 offen offset:2048 nt lds
    buffer_load_dwordx4 v153, s[16:19], s30 offen offset:3072 nt lds
    s_add_u32 s30, s30, 8192
    s_add_u32 m0, s32, 16384
    s_add_u32 s35, s34, 0
    buffer_load_dwordx4 v152, s[12:15], s35 offen nt lds
    buffer_load_dwordx4 v153, s[12:15], s35 offen offset:1024 nt lds
    buffer_load_dwordx4 v152, s[12:15], s35 offen offset:2048 nt lds
    buffer_load_dwordx4 v153, s[12:15], s35 offen offset:3072 nt lds
    v_mbcnt_lo_u32_b32 v76, -1, 0
    v_mbcnt_hi_u32_b32 v76, -1, v76
    v_and_b32 v77, 15, v76
    v_lshrrev_b32 v78, 4, v76
    v_lshlrev_b32 v81, 1, v77
    v_and_b32 v81, 15, v81
    v_xor_b32 v81, v81, v78
    v_lshlrev_b32 v82, 8, v77
    v_lshl_add_u32 v144, v81, 4, v82
    s_add_u32 s35, s32, 16384
    v_xor_b32 v145, 64, v144
    v_xor_b32 v146, 128, v144
    v_xor_b32 v147, 192, v144
    v_add_u32 v72, s35, v144
    v_add_u32 v73, s35, v145
    v_add_u32 v74, s35, v146
    v_add_u32 v75, s35, v147
    v_lshrrev_b32 v81, 2, v77
    v_lshl_add_u32 v82, v78, 2, v81
    v_lshlrev_b32 v82, 8, v82
    v_lshl_add_u32 v81, v81, 6, v82
    v_and_b32 v82, 3, v77
    v_lshl_add_u32 v81, v82, 3, v81
    v_xor_b32 v82, 0, v81
    v_add_u32 v148, 40960, v82
    v_xor_b32 v82, 64, v81
    v_add_u32 v149, 40960, v82
    v_xor_b32 v82, 128, v81
    v_add_u32 v150, 40960, v82
    v_xor_b32 v82, 192, v81
    v_add_u32 v151, 40960, v82
    v_mov_b32 v81, 0x3f803f80
    v_accvgpr_write_b32 a248, v81
    v_accvgpr_write_b32 a249, v81
    v_accvgpr_write_b32 a250, v81
    v_accvgpr_write_b32 a251, v81
    v_accvgpr_write_b32 a0, 0
    v_accvgpr_write_b32 a1, 0
    v_accvgpr_write_b32 a2, 0
    v_accvgpr_write_b32 a3, 0
    v_accvgpr_write_b32 a4, 0
    v_accvgpr_write_b32 a5, 0
    v_accvgpr_write_b32 a6, 0
    v_accvgpr_write_b32 a7, 0
    v_accvgpr_write_b32 a8, 0
    v_accvgpr_write_b32 a9, 0
    v_accvgpr_write_b32 a10, 0
    v_accvgpr_write_b32 a11, 0
    v_accvgpr_write_b32 a12, 0
    v_accvgpr_write_b32 a13, 0
    v_accvgpr_write_b32 a14, 0
    v_accvgpr_write_b32 a15, 0
    v_accvgpr_write_b32 a16, 0
    v_accvgpr_write_b32 a17, 0
    v_accvgpr_write_b32 a18, 0
    v_accvgpr_write_b32 a19, 0
    v_accvgpr_write_b32 a20, 0
    v_accvgpr_write_b32 a21, 0
    v_accvgpr_write_b32 a22, 0
    v_accvgpr_write_b32 a23, 0
    v_accvgpr_write_b32 a24, 0
    v_accvgpr_write_b32 a25, 0
    v_accvgpr_write_b32 a26, 0
    v_accvgpr_write_b32 a27, 0
    v_accvgpr_write_b32 a28, 0
    v_accvgpr_write_b32 a29, 0
    v_accvgpr_write_b32 a30, 0
    v_accvgpr_write_b32 a31, 0
    v_accvgpr_write_b32 a32, 0
    v_accvgpr_write_b32 a33, 0
    v_accvgpr_write_b32 a34, 0
    v_accvgpr_write_b32 a35, 0
    v_accvgpr_write_b32 a36, 0
    v_accvgpr_write_b32 a37, 0
    v_accvgpr_write_b32 a38, 0
    v_accvgpr_write_b32 a39, 0
    v_accvgpr_write_b32 a40, 0
    v_accvgpr_write_b32 a41, 0
    v_accvgpr_write_b32 a42, 0
    v_accvgpr_write_b32 a43, 0
    v_accvgpr_write_b32 a44, 0
    v_accvgpr_write_b32 a45, 0
    v_accvgpr_write_b32 a46, 0
    v_accvgpr_write_b32 a47, 0
    v_accvgpr_write_b32 a48, 0
    v_accvgpr_write_b32 a49, 0
    v_accvgpr_write_b32 a50, 0
    v_accvgpr_write_b32 a51, 0
    v_accvgpr_write_b32 a52, 0
    v_accvgpr_write_b32 a53, 0
    v_accvgpr_write_b32 a54, 0
    v_accvgpr_write_b32 a55, 0
    v_accvgpr_write_b32 a56, 0
    v_accvgpr_write_b32 a57, 0
    v_accvgpr_write_b32 a58, 0
    v_accvgpr_write_b32 a59, 0
    v_accvgpr_write_b32 a60, 0
    v_accvgpr_write_b32 a61, 0
    v_accvgpr_write_b32 a62, 0
    v_accvgpr_write_b32 a63, 0
    v_accvgpr_write_b32 a64, 0
    v_accvgpr_write_b32 a65, 0
    v_accvgpr_write_b32 a66, 0
    v_accvgpr_write_b32 a67, 0
    v_accvgpr_write_b32 a68, 0
    v_accvgpr_write_b32 a69, 0
    v_accvgpr_write_b32 a70, 0
    v_accvgpr_write_b32 a71, 0
    v_accvgpr_write_b32 a72, 0
    v_accvgpr_write_b32 a73, 0
    v_accvgpr_write_b32 a74, 0
    v_accvgpr_write_b32 a75, 0
    v_accvgpr_write_b32 a76, 0
    v_accvgpr_write_b32 a77, 0
    v_accvgpr_write_b32 a78, 0
    v_accvgpr_write_b32 a79, 0
    v_accvgpr_write_b32 a80, 0
    v_accvgpr_write_b32 a81, 0
    v_accvgpr_write_b32 a82, 0
    v_accvgpr_write_b32 a83, 0
    v_accvgpr_write_b32 a84, 0
    v_accvgpr_write_b32 a85, 0
    v_accvgpr_write_b32 a86, 0
    v_accvgpr_write_b32 a87, 0
    v_accvgpr_write_b32 a88, 0
    v_accvgpr_write_b32 a89, 0
    v_accvgpr_write_b32 a90, 0
    v_accvgpr_write_b32 a91, 0
    v_accvgpr_write_b32 a92, 0
    v_accvgpr_write_b32 a93, 0
    v_accvgpr_write_b32 a94, 0
    v_accvgpr_write_b32 a95, 0
    v_accvgpr_write_b32 a96, 0
    v_accvgpr_write_b32 a97, 0
    v_accvgpr_write_b32 a98, 0
    v_accvgpr_write_b32 a99, 0
    v_accvgpr_write_b32 a100, 0
    v_accvgpr_write_b32 a101, 0
    v_accvgpr_write_b32 a102, 0
    v_accvgpr_write_b32 a103, 0
    v_accvgpr_write_b32 a104, 0
    v_accvgpr_write_b32 a105, 0
    v_accvgpr_write_b32 a106, 0
    v_accvgpr_write_b32 a107, 0
    v_accvgpr_write_b32 a108, 0
    v_accvgpr_write_b32 a109, 0
    v_accvgpr_write_b32 a110, 0
    v_accvgpr_write_b32 a111, 0
    v_accvgpr_write_b32 a112, 0
    v_accvgpr_write_b32 a113, 0
    v_accvgpr_write_b32 a114, 0
    v_accvgpr_write_b32 a115, 0
    v_accvgpr_write_b32 a116, 0
    v_accvgpr_write_b32 a117, 0
    v_accvgpr_write_b32 a118, 0
    v_accvgpr_write_b32 a119, 0
    v_accvgpr_write_b32 a120, 0
    v_accvgpr_write_b32 a121, 0
    v_accvgpr_write_b32 a122, 0
    v_accvgpr_write_b32 a123, 0
    v_accvgpr_write_b32 a124, 0
    v_accvgpr_write_b32 a125, 0
    v_accvgpr_write_b32 a126, 0
    v_accvgpr_write_b32 a127, 0
    v_accvgpr_write_b32 a128, 0
    v_accvgpr_write_b32 a129, 0
    v_accvgpr_write_b32 a130, 0
    v_accvgpr_write_b32 a131, 0
    v_accvgpr_write_b32 a132, 0
    v_accvgpr_write_b32 a133, 0
    v_accvgpr_write_b32 a134, 0
    v_accvgpr_write_b32 a135, 0
    v_accvgpr_write_b32 a136, 0
    v_accvgpr_write_b32 a137, 0
    v_accvgpr_write_b32 a138, 0
    v_accvgpr_write_b32 a139, 0
    v_accvgpr_write_b32 a140, 0
    v_accvgpr_write_b32 a141, 0
    v_accvgpr_write_b32 a142, 0
    v_accvgpr_write_b32 a143, 0
    v_accvgpr_write_b32 a144, 0
    v_accvgpr_write_b32 a145, 0
    v_accvgpr_write_b32 a146, 0
    v_accvgpr_write_b32 a147, 0
    v_accvgpr_write_b32 a148, 0
    v_accvgpr_write_b32 a149, 0
    v_accvgpr_write_b32 a150, 0
    v_accvgpr_write_b32 a151, 0
    v_accvgpr_write_b32 a152, 0
    v_accvgpr_write_b32 a153, 0
    v_accvgpr_write_b32 a154, 0
    v_accvgpr_write_b32 a155, 0
    v_accvgpr_write_b32 a156, 0
    v_accvgpr_write_b32 a157, 0
    v_accvgpr_write_b32 a158, 0
    v_accvgpr_write_b32 a159, 0
    v_accvgpr_write_b32 a160, 0
    v_accvgpr_write_b32 a161, 0
    v_accvgpr_write_b32 a162, 0
    v_accvgpr_write_b32 a163, 0
    v_accvgpr_write_b32 a164, 0
    v_accvgpr_write_b32 a165, 0
    v_accvgpr_write_b32 a166, 0
    v_accvgpr_write_b32 a167, 0
    v_accvgpr_write_b32 a168, 0
    v_accvgpr_write_b32 a169, 0
    v_accvgpr_write_b32 a170, 0
    v_accvgpr_write_b32 a171, 0
    v_accvgpr_write_b32 a172, 0
    v_accvgpr_write_b32 a173, 0
    v_accvgpr_write_b32 a174, 0
    v_accvgpr_write_b32 a175, 0
    v_accvgpr_write_b32 a176, 0
    v_accvgpr_write_b32 a177, 0
    v_accvgpr_write_b32 a178, 0
    v_accvgpr_write_b32 a179, 0
    v_accvgpr_write_b32 a180, 0
    v_accvgpr_write_b32 a181, 0
    v_accvgpr_write_b32 a182, 0
    v_accvgpr_write_b32 a183, 0
    v_accvgpr_write_b32 a184, 0
    v_accvgpr_write_b32 a185, 0
    v_accvgpr_write_b32 a186, 0
    v_accvgpr_write_b32 a187, 0
    v_accvgpr_write_b32 a188, 0
    v_accvgpr_write_b32 a189, 0
    v_accvgpr_write_b32 a190, 0
    v_accvgpr_write_b32 a191, 0
    v_mov_b32 v120, 0
    v_mov_b32 v121, 0
    v_mov_b32 v122, 0
    v_mov_b32 v123, 0
    v_mov_b32 v124, 0
    v_mov_b32 v125, 0
    v_mov_b32 v126, 0
    v_mov_b32 v127, 0
    v_mov_b32 v128, 0
    v_mov_b32 v129, 0
    v_mov_b32 v130, 0
    v_mov_b32 v131, 0
    v_mov_b32 v132, 0
    v_mov_b32 v133, 0
    v_mov_b32 v134, 0
    v_mov_b32 v135, 0
    v_mov_b32 v136, 0
    v_mov_b32 v137, 0
    v_mov_b32 v138, 0
    v_mov_b32 v139, 0
    v_mov_b32 v140, 0
    v_mov_b32 v141, 0
    v_mov_b32 v142, 0
    v_mov_b32 v143, 0
    s_waitcnt vmcnt(4)
    s_add_u32 m0, s32, 24576
    s_add_u32 s35, s34, 4096
    buffer_load_dwordx4 v152, s[12:15], s35 offen nt lds
    buffer_load_dwordx4 v153, s[12:15], s35 offen offset:1024 nt lds
    buffer_load_dwordx4 v152, s[12:15], s35 offen offset:2048 nt lds
    buffer_load_dwordx4 v153, s[12:15], s35 offen offset:3072 nt lds
    s_waitcnt vmcnt(4)
    s_add_u32 m0, s32, 32768
    s_add_u32 s35, s34, 8192
    buffer_load_dwordx4 v152, s[12:15], s35 offen nt lds
    buffer_load_dwordx4 v153, s[12:15], s35 offen offset:1024 nt lds
    buffer_load_dwordx4 v152, s[12:15], s35 offen offset:2048 nt lds
    buffer_load_dwordx4 v153, s[12:15], s35 offen offset:3072 nt lds
    ds_read_b128 v[160:163], v72
    ds_read_b128 v[164:167], v73
    ds_read_b128 v[168:171], v74
    ds_read_b128 v[172:175], v75
    s_barrier
    ds_read_b128 a[192:195], v144
    ds_read_b128 a[196:199], v145
    ds_read_b128 a[200:203], v146
    ds_read_b128 a[204:207], v147
    ds_read_b128 a[208:211], v144 offset:4096
    ds_read_b128 a[212:215], v145 offset:4096
    ds_read_b128 a[216:219], v146 offset:4096
    ds_read_b128 a[220:223], v147 offset:4096
    s_waitcnt lgkmcnt(8)
    v_lshlrev_b32 v76, 16, v160
    v_and_b32 v77, 0xffff0000, v160
    v_lshlrev_b32 v78, 16, v161
    v_and_b32 v79, 0xffff0000, v161
    v_lshlrev_b32 v80, 16, v162
    v_and_b32 v81, 0xffff0000, v162
    v_lshlrev_b32 v82, 16, v163
    v_and_b32 v83, 0xffff0000, v163
    v_pk_mul_f32 v[76:77], v[76:77], s[38:39] op_sel_hi:[1,0]
    v_pk_mul_f32 v[78:79], v[78:79], s[38:39] op_sel_hi:[1,0]
    v_pk_mul_f32 v[80:81], v[80:81], s[38:39] op_sel_hi:[1,0]
    v_pk_mul_f32 v[82:83], v[82:83], s[38:39] op_sel_hi:[1,0]
    v_cvt_pk_bf16_f32 v160, v76, v77
    v_cvt_pk_bf16_f32 v161, v78, v79
    v_cvt_pk_bf16_f32 v162, v80, v81
    v_cvt_pk_bf16_f32 v163, v82, v83
    v_lshlrev_b32 v76, 16, v164
    v_and_b32 v77, 0xffff0000, v164
    v_lshlrev_b32 v78, 16, v165
    v_and_b32 v79, 0xffff0000, v165
    v_lshlrev_b32 v80, 16, v166
    v_and_b32 v81, 0xffff0000, v166
    v_lshlrev_b32 v82, 16, v167
    v_and_b32 v83, 0xffff0000, v167
    v_pk_mul_f32 v[76:77], v[76:77], s[38:39] op_sel_hi:[1,0]
    v_pk_mul_f32 v[78:79], v[78:79], s[38:39] op_sel_hi:[1,0]
    v_pk_mul_f32 v[80:81], v[80:81], s[38:39] op_sel_hi:[1,0]
    v_pk_mul_f32 v[82:83], v[82:83], s[38:39] op_sel_hi:[1,0]
    v_cvt_pk_bf16_f32 v164, v76, v77
    v_cvt_pk_bf16_f32 v165, v78, v79
    v_cvt_pk_bf16_f32 v166, v80, v81
    v_cvt_pk_bf16_f32 v167, v82, v83
    v_lshlrev_b32 v76, 16, v168
    v_and_b32 v77, 0xffff0000, v168
    v_lshlrev_b32 v78, 16, v169
    v_and_b32 v79, 0xffff0000, v169
    v_lshlrev_b32 v80, 16, v170
    v_and_b32 v81, 0xffff0000, v170
    v_lshlrev_b32 v82, 16, v171
    v_and_b32 v83, 0xffff0000, v171
    v_pk_mul_f32 v[76:77], v[76:77], s[38:39] op_sel_hi:[1,0]
    v_pk_mul_f32 v[78:79], v[78:79], s[38:39] op_sel_hi:[1,0]
    v_pk_mul_f32 v[80:81], v[80:81], s[38:39] op_sel_hi:[1,0]
    v_pk_mul_f32 v[82:83], v[82:83], s[38:39] op_sel_hi:[1,0]
    v_cvt_pk_bf16_f32 v168, v76, v77
    v_cvt_pk_bf16_f32 v169, v78, v79
    v_cvt_pk_bf16_f32 v170, v80, v81
    v_cvt_pk_bf16_f32 v171, v82, v83
    v_lshlrev_b32 v76, 16, v172
    v_and_b32 v77, 0xffff0000, v172
    v_lshlrev_b32 v78, 16, v173
    v_and_b32 v79, 0xffff0000, v173
    v_lshlrev_b32 v80, 16, v174
    v_and_b32 v81, 0xffff0000, v174
    v_lshlrev_b32 v82, 16, v175
    v_and_b32 v83, 0xffff0000, v175
    v_pk_mul_f32 v[76:77], v[76:77], s[38:39] op_sel_hi:[1,0]
    v_pk_mul_f32 v[78:79], v[78:79], s[38:39] op_sel_hi:[1,0]
    v_pk_mul_f32 v[80:81], v[80:81], s[38:39] op_sel_hi:[1,0]
    v_pk_mul_f32 v[82:83], v[82:83], s[38:39] op_sel_hi:[1,0]
    v_cvt_pk_bf16_f32 v172, v76, v77
    v_cvt_pk_bf16_f32 v173, v78, v79
    v_cvt_pk_bf16_f32 v174, v80, v81
    v_cvt_pk_bf16_f32 v175, v82, v83
    s_waitcnt lgkmcnt(0)
    s_nop 0
    v_mfma_f32_16x16x32_bf16 v[0:3], a[192:195], v[160:163], 0
    v_mfma_f32_16x16x32_bf16 v[0:3], a[196:199], v[164:167], v[0:3]
    v_mfma_f32_16x16x32_bf16 v[0:3], a[200:203], v[168:171], v[0:3]
    v_mfma_f32_16x16x32_bf16 v[0:3], a[204:207], v[172:175], v[0:3]
    v_mfma_f32_16x16x32_bf16 v[4:7], a[220:223], v[172:175], 0
    v_mfma_f32_16x16x32_bf16 v[4:7], a[216:219], v[168:171], v[4:7]
    v_mfma_f32_16x16x32_bf16 v[4:7], a[212:215], v[164:167], v[4:7]
    v_mfma_f32_16x16x32_bf16 v[4:7], a[208:211], v[160:163], v[4:7]
    s_waitcnt vmcnt(4)
    s_add_u32 m0, s32, 57344
    s_add_u32 s35, s34, 12288
    buffer_load_dwordx4 v152, s[12:15], s35 offen nt lds
    buffer_load_dwordx4 v153, s[12:15], s35 offen offset:1024 nt lds
    buffer_load_dwordx4 v152, s[12:15], s35 offen offset:2048 nt lds
    buffer_load_dwordx4 v153, s[12:15], s35 offen offset:3072 nt lds
    ds_read_b128 v[176:179], v72 offset:8192
    ds_read_b128 v[180:183], v73 offset:8192
    ds_read_b128 v[184:187], v74 offset:8192
    ds_read_b128 v[188:191], v75 offset:8192
    s_nop 2
    v_max3_f32 v155, v0, v1, v2
    v_max3_f32 v155, v155, v3, v4
    v_max3_f32 v155, v155, v5, v6
    v_max_f32 v155, v155, v7
    v_mov_b32 v156, v155
    s_nop 1
    v_permlane16_swap_b32 v155, v156
    v_max_f32 v155, v155, v156
    v_mov_b32 v156, v155
    s_nop 1
    v_permlane32_swap_b32 v155, v156
    v_max_f32 v155, v155, v156
    v_sub_f32 v0, v0, v155
    v_sub_f32 v1, v1, v155
    v_sub_f32 v2, v2, v155
    v_sub_f32 v3, v3, v155
    v_sub_f32 v4, v4, v155
    v_sub_f32 v5, v5, v155
    v_sub_f32 v6, v6, v155
    v_sub_f32 v7, v7, v155
    v_sub_f32 v96, 0, v155
    v_sub_f32 v97, 0, v155
    v_sub_f32 v98, 0, v155
    v_sub_f32 v99, 0, v155
    v_exp_f32 v0, v0
    v_exp_f32 v1, v1
    v_exp_f32 v2, v2
    v_exp_f32 v3, v3
    v_exp_f32 v4, v4
    v_exp_f32 v5, v5
    v_exp_f32 v6, v6
    v_exp_f32 v7, v7
    v_cvt_pk_bf16_f32 v48, v0, v1
    v_cvt_pk_bf16_f32 v49, v2, v3
    s_waitcnt lgkmcnt(0)
    v_lshlrev_b32 v76, 16, v176
    v_and_b32 v77, 0xffff0000, v176
    v_lshlrev_b32 v78, 16, v177
    v_and_b32 v79, 0xffff0000, v177
    v_lshlrev_b32 v80, 16, v178
    v_and_b32 v81, 0xffff0000, v178
    v_lshlrev_b32 v82, 16, v179
    v_and_b32 v83, 0xffff0000, v179
    v_pk_mul_f32 v[76:77], v[76:77], s[38:39] op_sel_hi:[1,0]
    v_pk_mul_f32 v[78:79], v[78:79], s[38:39] op_sel_hi:[1,0]
    v_pk_mul_f32 v[80:81], v[80:81], s[38:39] op_sel_hi:[1,0]
    v_pk_mul_f32 v[82:83], v[82:83], s[38:39] op_sel_hi:[1,0]
    v_cvt_pk_bf16_f32 v176, v76, v77
    v_cvt_pk_bf16_f32 v177, v78, v79
    v_cvt_pk_bf16_f32 v178, v80, v81
    v_cvt_pk_bf16_f32 v179, v82, v83
    v_lshlrev_b32 v76, 16, v180
    v_and_b32 v77, 0xffff0000, v180
    v_lshlrev_b32 v78, 16, v181
    v_and_b32 v79, 0xffff0000, v181
    v_lshlrev_b32 v80, 16, v182
    v_and_b32 v81, 0xffff0000, v182
    v_lshlrev_b32 v82, 16, v183
    v_and_b32 v83, 0xffff0000, v183
    v_pk_mul_f32 v[76:77], v[76:77], s[38:39] op_sel_hi:[1,0]
    v_pk_mul_f32 v[78:79], v[78:79], s[38:39] op_sel_hi:[1,0]
    v_pk_mul_f32 v[80:81], v[80:81], s[38:39] op_sel_hi:[1,0]
    v_pk_mul_f32 v[82:83], v[82:83], s[38:39] op_sel_hi:[1,0]
    v_cvt_pk_bf16_f32 v180, v76, v77
    v_cvt_pk_bf16_f32 v181, v78, v79
    v_cvt_pk_bf16_f32 v182, v80, v81
    v_cvt_pk_bf16_f32 v183, v82, v83
    v_lshlrev_b32 v76, 16, v184
    v_and_b32 v77, 0xffff0000, v184
    v_lshlrev_b32 v78, 16, v185
    v_and_b32 v79, 0xffff0000, v185
    v_lshlrev_b32 v80, 16, v186
    v_and_b32 v81, 0xffff0000, v186
    v_lshlrev_b32 v82, 16, v187
    v_and_b32 v83, 0xffff0000, v187
    v_pk_mul_f32 v[76:77], v[76:77], s[38:39] op_sel_hi:[1,0]
    v_pk_mul_f32 v[78:79], v[78:79], s[38:39] op_sel_hi:[1,0]
    v_pk_mul_f32 v[80:81], v[80:81], s[38:39] op_sel_hi:[1,0]
    v_pk_mul_f32 v[82:83], v[82:83], s[38:39] op_sel_hi:[1,0]
    v_cvt_pk_bf16_f32 v184, v76, v77
    v_cvt_pk_bf16_f32 v185, v78, v79
    v_cvt_pk_bf16_f32 v186, v80, v81
    v_cvt_pk_bf16_f32 v187, v82, v83
    v_lshlrev_b32 v76, 16, v188
    v_and_b32 v77, 0xffff0000, v188
    v_lshlrev_b32 v78, 16, v189
    v_and_b32 v79, 0xffff0000, v189
    v_lshlrev_b32 v80, 16, v190
    v_and_b32 v81, 0xffff0000, v190
    v_lshlrev_b32 v82, 16, v191
    v_and_b32 v83, 0xffff0000, v191
    v_pk_mul_f32 v[76:77], v[76:77], s[38:39] op_sel_hi:[1,0]
    v_pk_mul_f32 v[78:79], v[78:79], s[38:39] op_sel_hi:[1,0]
    v_pk_mul_f32 v[80:81], v[80:81], s[38:39] op_sel_hi:[1,0]
    v_pk_mul_f32 v[82:83], v[82:83], s[38:39] op_sel_hi:[1,0]
    v_cvt_pk_bf16_f32 v188, v76, v77
    v_cvt_pk_bf16_f32 v189, v78, v79
    v_cvt_pk_bf16_f32 v190, v80, v81
    v_cvt_pk_bf16_f32 v191, v82, v83
    s_waitcnt lgkmcnt(0)
    s_nop 0
    v_mfma_f32_16x16x32_bf16 v[8:11], a[192:195], v[176:179], 0
    v_mfma_f32_16x16x32_bf16 v[8:11], a[196:199], v[180:183], v[8:11]
    v_mfma_f32_16x16x32_bf16 v[8:11], a[200:203], v[184:187], v[8:11]
    v_mfma_f32_16x16x32_bf16 v[8:11], a[204:207], v[188:191], v[8:11]
    v_mfma_f32_16x16x32_bf16 v[12:15], a[220:223], v[188:191], 0
    v_mfma_f32_16x16x32_bf16 v[12:15], a[216:219], v[184:187], v[12:15]
    v_mfma_f32_16x16x32_bf16 v[12:15], a[212:215], v[180:183], v[12:15]
    v_mfma_f32_16x16x32_bf16 v[12:15], a[208:211], v[176:179], v[12:15]
    s_waitcnt vmcnt(4)
    s_add_u32 m0, s32, 65536
    s_add_u32 s35, s34, 16384
    buffer_load_dwordx4 v152, s[12:15], s35 offen nt lds
    buffer_load_dwordx4 v153, s[12:15], s35 offen offset:1024 nt lds
    buffer_load_dwordx4 v152, s[12:15], s35 offen offset:2048 nt lds
    buffer_load_dwordx4 v153, s[12:15], s35 offen offset:3072 nt lds
    ds_read_b128 v[192:195], v72 offset:16384
    ds_read_b128 v[196:199], v73 offset:16384
    ds_read_b128 v[200:203], v74 offset:16384
    ds_read_b128 v[204:207], v75 offset:16384
    s_nop 2
    v_max3_f32 v155, v8, v9, v10
    v_max3_f32 v155, v155, v11, v12
    v_max3_f32 v155, v155, v13, v14
    v_max_f32 v155, v155, v15
    v_mov_b32 v156, v155
    s_nop 1
    v_permlane16_swap_b32 v155, v156
    v_max_f32 v155, v155, v156
    v_mov_b32 v156, v155
    s_nop 1
    v_permlane32_swap_b32 v155, v156
    v_max_f32 v155, v155, v156
    v_sub_f32 v8, v8, v155
    v_sub_f32 v9, v9, v155
    v_sub_f32 v10, v10, v155
    v_sub_f32 v11, v11, v155
    v_sub_f32 v12, v12, v155
    v_sub_f32 v13, v13, v155
    v_sub_f32 v14, v14, v155
    v_sub_f32 v15, v15, v155
    v_sub_f32 v100, 0, v155
    v_sub_f32 v101, 0, v155
    v_sub_f32 v102, 0, v155
    v_sub_f32 v103, 0, v155
    v_exp_f32 v8, v8
    v_exp_f32 v9, v9
    v_exp_f32 v10, v10
    v_exp_f32 v11, v11
    v_exp_f32 v12, v12
    v_exp_f32 v13, v13
    v_exp_f32 v14, v14
    v_exp_f32 v15, v15
    v_cvt_pk_bf16_f32 v52, v8, v9
    v_cvt_pk_bf16_f32 v53, v10, v11
    s_waitcnt lgkmcnt(0)
    v_lshlrev_b32 v76, 16, v192
    v_and_b32 v77, 0xffff0000, v192
    v_lshlrev_b32 v78, 16, v193
    v_and_b32 v79, 0xffff0000, v193
    v_lshlrev_b32 v80, 16, v194
    v_and_b32 v81, 0xffff0000, v194
    v_lshlrev_b32 v82, 16, v195
    v_and_b32 v83, 0xffff0000, v195
    v_pk_mul_f32 v[76:77], v[76:77], s[38:39] op_sel_hi:[1,0]
    v_pk_mul_f32 v[78:79], v[78:79], s[38:39] op_sel_hi:[1,0]
    v_pk_mul_f32 v[80:81], v[80:81], s[38:39] op_sel_hi:[1,0]
    v_pk_mul_f32 v[82:83], v[82:83], s[38:39] op_sel_hi:[1,0]
    v_cvt_pk_bf16_f32 v192, v76, v77
    v_cvt_pk_bf16_f32 v193, v78, v79
    v_cvt_pk_bf16_f32 v194, v80, v81
    v_cvt_pk_bf16_f32 v195, v82, v83
    v_lshlrev_b32 v76, 16, v196
    v_and_b32 v77, 0xffff0000, v196
    v_lshlrev_b32 v78, 16, v197
    v_and_b32 v79, 0xffff0000, v197
    v_lshlrev_b32 v80, 16, v198
    v_and_b32 v81, 0xffff0000, v198
    v_lshlrev_b32 v82, 16, v199
    v_and_b32 v83, 0xffff0000, v199
    v_pk_mul_f32 v[76:77], v[76:77], s[38:39] op_sel_hi:[1,0]
    v_pk_mul_f32 v[78:79], v[78:79], s[38:39] op_sel_hi:[1,0]
    v_pk_mul_f32 v[80:81], v[80:81], s[38:39] op_sel_hi:[1,0]
    v_pk_mul_f32 v[82:83], v[82:83], s[38:39] op_sel_hi:[1,0]
    v_cvt_pk_bf16_f32 v196, v76, v77
    v_cvt_pk_bf16_f32 v197, v78, v79
    v_cvt_pk_bf16_f32 v198, v80, v81
    v_cvt_pk_bf16_f32 v199, v82, v83
    v_lshlrev_b32 v76, 16, v200
    v_and_b32 v77, 0xffff0000, v200
    v_lshlrev_b32 v78, 16, v201
    v_and_b32 v79, 0xffff0000, v201
    v_lshlrev_b32 v80, 16, v202
    v_and_b32 v81, 0xffff0000, v202
    v_lshlrev_b32 v82, 16, v203
    v_and_b32 v83, 0xffff0000, v203
    v_pk_mul_f32 v[76:77], v[76:77], s[38:39] op_sel_hi:[1,0]
    v_pk_mul_f32 v[78:79], v[78:79], s[38:39] op_sel_hi:[1,0]
    v_pk_mul_f32 v[80:81], v[80:81], s[38:39] op_sel_hi:[1,0]
    v_pk_mul_f32 v[82:83], v[82:83], s[38:39] op_sel_hi:[1,0]
    v_cvt_pk_bf16_f32 v200, v76, v77
    v_cvt_pk_bf16_f32 v201, v78, v79
    v_cvt_pk_bf16_f32 v202, v80, v81
    v_cvt_pk_bf16_f32 v203, v82, v83
    v_lshlrev_b32 v76, 16, v204
    v_and_b32 v77, 0xffff0000, v204
    v_lshlrev_b32 v78, 16, v205
    v_and_b32 v79, 0xffff0000, v205
    v_lshlrev_b32 v80, 16, v206
    v_and_b32 v81, 0xffff0000, v206
    v_lshlrev_b32 v82, 16, v207
    v_and_b32 v83, 0xffff0000, v207
    v_pk_mul_f32 v[76:77], v[76:77], s[38:39] op_sel_hi:[1,0]
    v_pk_mul_f32 v[78:79], v[78:79], s[38:39] op_sel_hi:[1,0]
    v_pk_mul_f32 v[80:81], v[80:81], s[38:39] op_sel_hi:[1,0]
    v_pk_mul_f32 v[82:83], v[82:83], s[38:39] op_sel_hi:[1,0]
    v_cvt_pk_bf16_f32 v204, v76, v77
    v_cvt_pk_bf16_f32 v205, v78, v79
    v_cvt_pk_bf16_f32 v206, v80, v81
    v_cvt_pk_bf16_f32 v207, v82, v83
    s_waitcnt lgkmcnt(0)
    s_nop 0
    v_mfma_f32_16x16x32_bf16 v[16:19], a[192:195], v[192:195], 0
    v_mfma_f32_16x16x32_bf16 v[16:19], a[196:199], v[196:199], v[16:19]
    v_mfma_f32_16x16x32_bf16 v[16:19], a[200:203], v[200:203], v[16:19]
    v_mfma_f32_16x16x32_bf16 v[16:19], a[204:207], v[204:207], v[16:19]
    v_mfma_f32_16x16x32_bf16 v[20:23], a[220:223], v[204:207], 0
    v_mfma_f32_16x16x32_bf16 v[20:23], a[216:219], v[200:203], v[20:23]
    v_mfma_f32_16x16x32_bf16 v[20:23], a[212:215], v[196:199], v[20:23]
    v_mfma_f32_16x16x32_bf16 v[20:23], a[208:211], v[192:195], v[20:23]
    s_waitcnt vmcnt(4)
    s_add_u32 m0, s32, 73728
    s_add_u32 s35, s34, 20480
    buffer_load_dwordx4 v152, s[12:15], s35 offen nt lds
    buffer_load_dwordx4 v153, s[12:15], s35 offen offset:1024 nt lds
    buffer_load_dwordx4 v152, s[12:15], s35 offen offset:2048 nt lds
    buffer_load_dwordx4 v153, s[12:15], s35 offen offset:3072 nt lds
    ds_read_b128 v[208:211], v72 offset:40960
    ds_read_b128 v[212:215], v73 offset:40960
    ds_read_b128 v[216:219], v74 offset:40960
    ds_read_b128 v[220:223], v75 offset:40960
    s_nop 2
    v_max3_f32 v155, v16, v17, v18
    v_max3_f32 v155, v155, v19, v20
    v_max3_f32 v155, v155, v21, v22
    v_max_f32 v155, v155, v23
    v_mov_b32 v156, v155
    s_nop 1
    v_permlane16_swap_b32 v155, v156
    v_max_f32 v155, v155, v156
    v_mov_b32 v156, v155
    s_nop 1
    v_permlane32_swap_b32 v155, v156
    v_max_f32 v155, v155, v156
    v_sub_f32 v16, v16, v155
    v_sub_f32 v17, v17, v155
    v_sub_f32 v18, v18, v155
    v_sub_f32 v19, v19, v155
    v_sub_f32 v20, v20, v155
    v_sub_f32 v21, v21, v155
    v_sub_f32 v22, v22, v155
    v_sub_f32 v23, v23, v155
    v_sub_f32 v104, 0, v155
    v_sub_f32 v105, 0, v155
    v_sub_f32 v106, 0, v155
    v_sub_f32 v107, 0, v155
    v_exp_f32 v16, v16
    v_exp_f32 v17, v17
    v_exp_f32 v18, v18
    v_exp_f32 v19, v19
    v_exp_f32 v20, v20
    v_exp_f32 v21, v21
    v_exp_f32 v22, v22
    v_exp_f32 v23, v23
    v_cvt_pk_bf16_f32 v56, v16, v17
    v_cvt_pk_bf16_f32 v57, v18, v19
    s_waitcnt lgkmcnt(0)
    v_lshlrev_b32 v76, 16, v208
    v_and_b32 v77, 0xffff0000, v208
    v_lshlrev_b32 v78, 16, v209
    v_and_b32 v79, 0xffff0000, v209
    v_lshlrev_b32 v80, 16, v210
    v_and_b32 v81, 0xffff0000, v210
    v_lshlrev_b32 v82, 16, v211
    v_and_b32 v83, 0xffff0000, v211
    v_pk_mul_f32 v[76:77], v[76:77], s[38:39] op_sel_hi:[1,0]
    v_pk_mul_f32 v[78:79], v[78:79], s[38:39] op_sel_hi:[1,0]
    v_pk_mul_f32 v[80:81], v[80:81], s[38:39] op_sel_hi:[1,0]
    v_pk_mul_f32 v[82:83], v[82:83], s[38:39] op_sel_hi:[1,0]
    v_cvt_pk_bf16_f32 v208, v76, v77
    v_cvt_pk_bf16_f32 v209, v78, v79
    v_cvt_pk_bf16_f32 v210, v80, v81
    v_cvt_pk_bf16_f32 v211, v82, v83
    v_lshlrev_b32 v76, 16, v212
    v_and_b32 v77, 0xffff0000, v212
    v_lshlrev_b32 v78, 16, v213
    v_and_b32 v79, 0xffff0000, v213
    v_lshlrev_b32 v80, 16, v214
    v_and_b32 v81, 0xffff0000, v214
    v_lshlrev_b32 v82, 16, v215
    v_and_b32 v83, 0xffff0000, v215
    v_pk_mul_f32 v[76:77], v[76:77], s[38:39] op_sel_hi:[1,0]
    v_pk_mul_f32 v[78:79], v[78:79], s[38:39] op_sel_hi:[1,0]
    v_pk_mul_f32 v[80:81], v[80:81], s[38:39] op_sel_hi:[1,0]
    v_pk_mul_f32 v[82:83], v[82:83], s[38:39] op_sel_hi:[1,0]
    v_cvt_pk_bf16_f32 v212, v76, v77
    v_cvt_pk_bf16_f32 v213, v78, v79
    v_cvt_pk_bf16_f32 v214, v80, v81
    v_cvt_pk_bf16_f32 v215, v82, v83
    v_lshlrev_b32 v76, 16, v216
    v_and_b32 v77, 0xffff0000, v216
    v_lshlrev_b32 v78, 16, v217
    v_and_b32 v79, 0xffff0000, v217
    v_lshlrev_b32 v80, 16, v218
    v_and_b32 v81, 0xffff0000, v218
    v_lshlrev_b32 v82, 16, v219
    v_and_b32 v83, 0xffff0000, v219
    v_pk_mul_f32 v[76:77], v[76:77], s[38:39] op_sel_hi:[1,0]
    v_pk_mul_f32 v[78:79], v[78:79], s[38:39] op_sel_hi:[1,0]
    v_pk_mul_f32 v[80:81], v[80:81], s[38:39] op_sel_hi:[1,0]
    v_pk_mul_f32 v[82:83], v[82:83], s[38:39] op_sel_hi:[1,0]
    v_cvt_pk_bf16_f32 v216, v76, v77
    v_cvt_pk_bf16_f32 v217, v78, v79
    v_cvt_pk_bf16_f32 v218, v80, v81
    v_cvt_pk_bf16_f32 v219, v82, v83
    v_lshlrev_b32 v76, 16, v220
    v_and_b32 v77, 0xffff0000, v220
    v_lshlrev_b32 v78, 16, v221
    v_and_b32 v79, 0xffff0000, v221
    v_lshlrev_b32 v80, 16, v222
    v_and_b32 v81, 0xffff0000, v222
    v_lshlrev_b32 v82, 16, v223
    v_and_b32 v83, 0xffff0000, v223
    v_pk_mul_f32 v[76:77], v[76:77], s[38:39] op_sel_hi:[1,0]
    v_pk_mul_f32 v[78:79], v[78:79], s[38:39] op_sel_hi:[1,0]
    v_pk_mul_f32 v[80:81], v[80:81], s[38:39] op_sel_hi:[1,0]
    v_pk_mul_f32 v[82:83], v[82:83], s[38:39] op_sel_hi:[1,0]
    v_cvt_pk_bf16_f32 v220, v76, v77
    v_cvt_pk_bf16_f32 v221, v78, v79
    v_cvt_pk_bf16_f32 v222, v80, v81
    v_cvt_pk_bf16_f32 v223, v82, v83
    s_waitcnt lgkmcnt(0)
    s_nop 0
    v_mfma_f32_16x16x32_bf16 v[24:27], a[192:195], v[208:211], 0
    v_mfma_f32_16x16x32_bf16 v[24:27], a[196:199], v[212:215], v[24:27]
    v_mfma_f32_16x16x32_bf16 v[24:27], a[200:203], v[216:219], v[24:27]
    v_mfma_f32_16x16x32_bf16 v[24:27], a[204:207], v[220:223], v[24:27]
    v_mfma_f32_16x16x32_bf16 v[28:31], a[220:223], v[220:223], 0
    v_mfma_f32_16x16x32_bf16 v[28:31], a[216:219], v[216:219], v[28:31]
    v_mfma_f32_16x16x32_bf16 v[28:31], a[212:215], v[212:215], v[28:31]
    v_mfma_f32_16x16x32_bf16 v[28:31], a[208:211], v[208:211], v[28:31]
    s_waitcnt vmcnt(4)
    s_add_u32 m0, s32, 8192
    s_nop 0
    buffer_load_dwordx4 v152, s[16:19], s30 offen nt lds
    buffer_load_dwordx4 v153, s[16:19], s30 offen offset:1024 nt lds
    buffer_load_dwordx4 v152, s[16:19], s30 offen offset:2048 nt lds
    buffer_load_dwordx4 v153, s[16:19], s30 offen offset:3072 nt lds
    s_add_u32 s30, s30, 8192
    ds_read_b128 v[224:227], v72 offset:49152
    ds_read_b128 v[228:231], v73 offset:49152
    ds_read_b128 v[232:235], v74 offset:49152
    ds_read_b128 v[236:239], v75 offset:49152
    s_nop 2
    v_max3_f32 v155, v24, v25, v26
    v_max3_f32 v155, v155, v27, v28
    v_max3_f32 v155, v155, v29, v30
    v_max_f32 v155, v155, v31
    v_mov_b32 v156, v155
    s_nop 1
    v_permlane16_swap_b32 v155, v156
    v_max_f32 v155, v155, v156
    v_mov_b32 v156, v155
    s_nop 1
    v_permlane32_swap_b32 v155, v156
    v_max_f32 v155, v155, v156
    v_sub_f32 v24, v24, v155
    v_sub_f32 v25, v25, v155
    v_sub_f32 v26, v26, v155
    v_sub_f32 v27, v27, v155
    v_sub_f32 v28, v28, v155
    v_sub_f32 v29, v29, v155
    v_sub_f32 v30, v30, v155
    v_sub_f32 v31, v31, v155
    v_sub_f32 v108, 0, v155
    v_sub_f32 v109, 0, v155
    v_sub_f32 v110, 0, v155
    v_sub_f32 v111, 0, v155
    v_exp_f32 v24, v24
    v_exp_f32 v25, v25
    v_exp_f32 v26, v26
    v_exp_f32 v27, v27
    v_exp_f32 v28, v28
    v_exp_f32 v29, v29
    v_exp_f32 v30, v30
    v_exp_f32 v31, v31
    v_cvt_pk_bf16_f32 v60, v24, v25
    v_cvt_pk_bf16_f32 v61, v26, v27
    s_waitcnt lgkmcnt(0)
    v_lshlrev_b32 v76, 16, v224
    v_and_b32 v77, 0xffff0000, v224
    v_lshlrev_b32 v78, 16, v225
    v_and_b32 v79, 0xffff0000, v225
    v_lshlrev_b32 v80, 16, v226
    v_and_b32 v81, 0xffff0000, v226
    v_lshlrev_b32 v82, 16, v227
    v_and_b32 v83, 0xffff0000, v227
    v_pk_mul_f32 v[76:77], v[76:77], s[38:39] op_sel_hi:[1,0]
    v_pk_mul_f32 v[78:79], v[78:79], s[38:39] op_sel_hi:[1,0]
    v_pk_mul_f32 v[80:81], v[80:81], s[38:39] op_sel_hi:[1,0]
    v_pk_mul_f32 v[82:83], v[82:83], s[38:39] op_sel_hi:[1,0]
    v_cvt_pk_bf16_f32 v224, v76, v77
    v_cvt_pk_bf16_f32 v225, v78, v79
    v_cvt_pk_bf16_f32 v226, v80, v81
    v_cvt_pk_bf16_f32 v227, v82, v83
    v_lshlrev_b32 v76, 16, v228
    v_and_b32 v77, 0xffff0000, v228
    v_lshlrev_b32 v78, 16, v229
    v_and_b32 v79, 0xffff0000, v229
    v_lshlrev_b32 v80, 16, v230
    v_and_b32 v81, 0xffff0000, v230
    v_lshlrev_b32 v82, 16, v231
    v_and_b32 v83, 0xffff0000, v231
    v_pk_mul_f32 v[76:77], v[76:77], s[38:39] op_sel_hi:[1,0]
    v_pk_mul_f32 v[78:79], v[78:79], s[38:39] op_sel_hi:[1,0]
    v_pk_mul_f32 v[80:81], v[80:81], s[38:39] op_sel_hi:[1,0]
    v_pk_mul_f32 v[82:83], v[82:83], s[38:39] op_sel_hi:[1,0]
    v_cvt_pk_bf16_f32 v228, v76, v77
    v_cvt_pk_bf16_f32 v229, v78, v79
    v_cvt_pk_bf16_f32 v230, v80, v81
    v_cvt_pk_bf16_f32 v231, v82, v83
    v_lshlrev_b32 v76, 16, v232
    v_and_b32 v77, 0xffff0000, v232
    v_lshlrev_b32 v78, 16, v233
    v_and_b32 v79, 0xffff0000, v233
    v_lshlrev_b32 v80, 16, v234
    v_and_b32 v81, 0xffff0000, v234
    v_lshlrev_b32 v82, 16, v235
    v_and_b32 v83, 0xffff0000, v235
    v_pk_mul_f32 v[76:77], v[76:77], s[38:39] op_sel_hi:[1,0]
    v_pk_mul_f32 v[78:79], v[78:79], s[38:39] op_sel_hi:[1,0]
    v_pk_mul_f32 v[80:81], v[80:81], s[38:39] op_sel_hi:[1,0]
    v_pk_mul_f32 v[82:83], v[82:83], s[38:39] op_sel_hi:[1,0]
    v_cvt_pk_bf16_f32 v232, v76, v77
    v_cvt_pk_bf16_f32 v233, v78, v79
    v_cvt_pk_bf16_f32 v234, v80, v81
    v_cvt_pk_bf16_f32 v235, v82, v83
    v_lshlrev_b32 v76, 16, v236
    v_and_b32 v77, 0xffff0000, v236
    v_lshlrev_b32 v78, 16, v237
    v_and_b32 v79, 0xffff0000, v237
    v_lshlrev_b32 v80, 16, v238
    v_and_b32 v81, 0xffff0000, v238
    v_lshlrev_b32 v82, 16, v239
    v_and_b32 v83, 0xffff0000, v239
    v_pk_mul_f32 v[76:77], v[76:77], s[38:39] op_sel_hi:[1,0]
    v_pk_mul_f32 v[78:79], v[78:79], s[38:39] op_sel_hi:[1,0]
    v_pk_mul_f32 v[80:81], v[80:81], s[38:39] op_sel_hi:[1,0]
    v_pk_mul_f32 v[82:83], v[82:83], s[38:39] op_sel_hi:[1,0]
    v_cvt_pk_bf16_f32 v236, v76, v77
    v_cvt_pk_bf16_f32 v237, v78, v79
    v_cvt_pk_bf16_f32 v238, v80, v81
    v_cvt_pk_bf16_f32 v239, v82, v83
    s_waitcnt lgkmcnt(0)
    s_nop 0
    v_mfma_f32_16x16x32_bf16 v[32:35], a[192:195], v[224:227], 0
    v_mfma_f32_16x16x32_bf16 v[32:35], a[196:199], v[228:231], v[32:35]
    v_mfma_f32_16x16x32_bf16 v[32:35], a[200:203], v[232:235], v[32:35]
    v_mfma_f32_16x16x32_bf16 v[32:35], a[204:207], v[236:239], v[32:35]
    v_mfma_f32_16x16x32_bf16 v[36:39], a[220:223], v[236:239], 0
    v_mfma_f32_16x16x32_bf16 v[36:39], a[216:219], v[232:235], v[36:39]
    v_mfma_f32_16x16x32_bf16 v[36:39], a[212:215], v[228:231], v[36:39]
    v_mfma_f32_16x16x32_bf16 v[36:39], a[208:211], v[224:227], v[36:39]
    s_waitcnt vmcnt(4)
    s_add_u32 m0, s32, 16384
    s_nop 0
    buffer_load_dwordx4 v152, s[16:19], s30 offen nt lds
    buffer_load_dwordx4 v153, s[16:19], s30 offen offset:1024 nt lds
    buffer_load_dwordx4 v152, s[16:19], s30 offen offset:2048 nt lds
    buffer_load_dwordx4 v153, s[16:19], s30 offen offset:3072 nt lds
    s_add_u32 s30, s30, 8192
    ds_read_b128 v[240:243], v72 offset:57344
    ds_read_b128 v[244:247], v73 offset:57344
    ds_read_b128 v[248:251], v74 offset:57344
    ds_read_b128 v[252:255], v75 offset:57344
    s_nop 2
    v_max3_f32 v155, v32, v33, v34
    v_max3_f32 v155, v155, v35, v36
    v_max3_f32 v155, v155, v37, v38
    v_max_f32 v155, v155, v39
    v_mov_b32 v156, v155
    s_nop 1
    v_permlane16_swap_b32 v155, v156
    v_max_f32 v155, v155, v156
    v_mov_b32 v156, v155
    s_nop 1
    v_permlane32_swap_b32 v155, v156
    v_max_f32 v155, v155, v156
    v_sub_f32 v32, v32, v155
    v_sub_f32 v33, v33, v155
    v_sub_f32 v34, v34, v155
    v_sub_f32 v35, v35, v155
    v_sub_f32 v36, v36, v155
    v_sub_f32 v37, v37, v155
    v_sub_f32 v38, v38, v155
    v_sub_f32 v39, v39, v155
    v_sub_f32 v112, 0, v155
    v_sub_f32 v113, 0, v155
    v_sub_f32 v114, 0, v155
    v_sub_f32 v115, 0, v155
    v_exp_f32 v32, v32
    v_exp_f32 v33, v33
    v_exp_f32 v34, v34
    v_exp_f32 v35, v35
    v_exp_f32 v36, v36
    v_exp_f32 v37, v37
    v_exp_f32 v38, v38
    v_exp_f32 v39, v39
    v_cvt_pk_bf16_f32 v64, v32, v33
    v_cvt_pk_bf16_f32 v65, v34, v35
    s_waitcnt lgkmcnt(0)
    v_lshlrev_b32 v76, 16, v240
    v_and_b32 v77, 0xffff0000, v240
    v_lshlrev_b32 v78, 16, v241
    v_and_b32 v79, 0xffff0000, v241
    v_lshlrev_b32 v80, 16, v242
    v_and_b32 v81, 0xffff0000, v242
    v_lshlrev_b32 v82, 16, v243
    v_and_b32 v83, 0xffff0000, v243
    v_pk_mul_f32 v[76:77], v[76:77], s[38:39] op_sel_hi:[1,0]
    v_pk_mul_f32 v[78:79], v[78:79], s[38:39] op_sel_hi:[1,0]
    v_pk_mul_f32 v[80:81], v[80:81], s[38:39] op_sel_hi:[1,0]
    v_pk_mul_f32 v[82:83], v[82:83], s[38:39] op_sel_hi:[1,0]
    v_cvt_pk_bf16_f32 v240, v76, v77
    v_cvt_pk_bf16_f32 v241, v78, v79
    v_cvt_pk_bf16_f32 v242, v80, v81
    v_cvt_pk_bf16_f32 v243, v82, v83
    v_lshlrev_b32 v76, 16, v244
    v_and_b32 v77, 0xffff0000, v244
    v_lshlrev_b32 v78, 16, v245
    v_and_b32 v79, 0xffff0000, v245
    v_lshlrev_b32 v80, 16, v246
    v_and_b32 v81, 0xffff0000, v246
    v_lshlrev_b32 v82, 16, v247
    v_and_b32 v83, 0xffff0000, v247
    v_pk_mul_f32 v[76:77], v[76:77], s[38:39] op_sel_hi:[1,0]
    v_pk_mul_f32 v[78:79], v[78:79], s[38:39] op_sel_hi:[1,0]
    v_pk_mul_f32 v[80:81], v[80:81], s[38:39] op_sel_hi:[1,0]
    v_pk_mul_f32 v[82:83], v[82:83], s[38:39] op_sel_hi:[1,0]
    v_cvt_pk_bf16_f32 v244, v76, v77
    v_cvt_pk_bf16_f32 v245, v78, v79
    v_cvt_pk_bf16_f32 v246, v80, v81
    v_cvt_pk_bf16_f32 v247, v82, v83
    v_lshlrev_b32 v76, 16, v248
    v_and_b32 v77, 0xffff0000, v248
    v_lshlrev_b32 v78, 16, v249
    v_and_b32 v79, 0xffff0000, v249
    v_lshlrev_b32 v80, 16, v250
    v_and_b32 v81, 0xffff0000, v250
    v_lshlrev_b32 v82, 16, v251
    v_and_b32 v83, 0xffff0000, v251
    v_pk_mul_f32 v[76:77], v[76:77], s[38:39] op_sel_hi:[1,0]
    v_pk_mul_f32 v[78:79], v[78:79], s[38:39] op_sel_hi:[1,0]
    v_pk_mul_f32 v[80:81], v[80:81], s[38:39] op_sel_hi:[1,0]
    v_pk_mul_f32 v[82:83], v[82:83], s[38:39] op_sel_hi:[1,0]
    v_cvt_pk_bf16_f32 v248, v76, v77
    v_cvt_pk_bf16_f32 v249, v78, v79
    v_cvt_pk_bf16_f32 v250, v80, v81
    v_cvt_pk_bf16_f32 v251, v82, v83
    v_lshlrev_b32 v76, 16, v252
    v_and_b32 v77, 0xffff0000, v252
    v_lshlrev_b32 v78, 16, v253
    v_and_b32 v79, 0xffff0000, v253
    v_lshlrev_b32 v80, 16, v254
    v_and_b32 v81, 0xffff0000, v254
    v_lshlrev_b32 v82, 16, v255
    v_and_b32 v83, 0xffff0000, v255
    v_pk_mul_f32 v[76:77], v[76:77], s[38:39] op_sel_hi:[1,0]
    v_pk_mul_f32 v[78:79], v[78:79], s[38:39] op_sel_hi:[1,0]
    v_pk_mul_f32 v[80:81], v[80:81], s[38:39] op_sel_hi:[1,0]
    v_pk_mul_f32 v[82:83], v[82:83], s[38:39] op_sel_hi:[1,0]
    v_cvt_pk_bf16_f32 v252, v76, v77
    v_cvt_pk_bf16_f32 v253, v78, v79
    v_cvt_pk_bf16_f32 v254, v80, v81
    v_cvt_pk_bf16_f32 v255, v82, v83
    s_waitcnt lgkmcnt(0)
    s_nop 0
    v_mfma_f32_16x16x32_bf16 v[40:43], a[192:195], v[240:243], 0
    v_mfma_f32_16x16x32_bf16 v[40:43], a[196:199], v[244:247], v[40:43]
    v_mfma_f32_16x16x32_bf16 v[40:43], a[200:203], v[248:251], v[40:43]
    v_mfma_f32_16x16x32_bf16 v[40:43], a[204:207], v[252:255], v[40:43]
    v_mfma_f32_16x16x32_bf16 v[44:47], a[220:223], v[252:255], 0
    v_mfma_f32_16x16x32_bf16 v[44:47], a[216:219], v[248:251], v[44:47]
    v_mfma_f32_16x16x32_bf16 v[44:47], a[212:215], v[244:247], v[44:47]
    v_mfma_f32_16x16x32_bf16 v[44:47], a[208:211], v[240:243], v[44:47]
    s_waitcnt vmcnt(4)
    s_add_u32 m0, s32, 40960
    s_nop 0
    buffer_load_dwordx4 v154, s[20:23], s31 offen nt lds
    buffer_load_dwordx4 v154, s[20:23], s31 offen offset:1024 nt lds
    buffer_load_dwordx4 v154, s[20:23], s31 offen offset:2048 nt lds
    buffer_load_dwordx4 v154, s[20:23], s31 offen offset:3072 nt lds
    s_add_u32 s31, s31, 8192
    s_barrier
    ds_read_b128 a[192:195], v144 offset:8192
    ds_read_b128 a[196:199], v145 offset:8192
    ds_read_b128 a[200:203], v146 offset:8192
    ds_read_b128 a[204:207], v147 offset:8192
    ds_read_b128 a[208:211], v144 offset:12288
    ds_read_b128 a[212:215], v145 offset:12288
    ds_read_b128 a[216:219], v146 offset:12288
    ds_read_b128 a[220:223], v147 offset:12288
    v_max3_f32 v155, v40, v41, v42
    v_max3_f32 v155, v155, v43, v44
    v_max3_f32 v155, v155, v45, v46
    v_max_f32 v155, v155, v47
    v_mov_b32 v156, v155
    s_nop 1
    v_permlane16_swap_b32 v155, v156
    v_max_f32 v155, v155, v156
    v_mov_b32 v156, v155
    s_nop 1
    v_permlane32_swap_b32 v155, v156
    v_max_f32 v155, v155, v156
    v_sub_f32 v40, v40, v155
    v_sub_f32 v41, v41, v155
    v_sub_f32 v42, v42, v155
    v_sub_f32 v43, v43, v155
    v_sub_f32 v44, v44, v155
    v_sub_f32 v45, v45, v155
    v_sub_f32 v46, v46, v155
    v_sub_f32 v47, v47, v155
    v_sub_f32 v116, 0, v155
    v_sub_f32 v117, 0, v155
    v_sub_f32 v118, 0, v155
    v_sub_f32 v119, 0, v155
    v_exp_f32 v40, v40
    v_exp_f32 v41, v41
    v_exp_f32 v42, v42
    v_exp_f32 v43, v43
    v_exp_f32 v44, v44
    v_exp_f32 v45, v45
    v_exp_f32 v46, v46
    v_exp_f32 v47, v47
    v_cvt_pk_bf16_f32 v68, v40, v41
    v_cvt_pk_bf16_f32 v69, v42, v43
    s_waitcnt lgkmcnt(0)
    s_nop 0
.p2align 6
L_loopF:
    v_mfma_f32_16x16x32_bf16 v[0:3], a[192:195], v[160:163], v[96:99]
    v_cvt_pk_bf16_f32 v70, v44, v45
    v_cvt_pk_bf16_f32 v71, v46, v47
    v_mfma_f32_16x16x32_bf16 v[0:3], a[196:199], v[164:167], v[0:3]
    v_cvt_pk_bf16_f32 v66, v36, v37
    v_cvt_pk_bf16_f32 v67, v38, v39
    v_mfma_f32_16x16x32_bf16 v[0:3], a[200:203], v[168:171], v[0:3]
    v_cvt_pk_bf16_f32 v62, v28, v29
    v_cvt_pk_bf16_f32 v63, v30, v31
    v_mfma_f32_16x16x32_bf16 v[0:3], a[204:207], v[172:175], v[0:3]
    v_cvt_pk_bf16_f32 v58, v20, v21
    v_cvt_pk_bf16_f32 v59, v22, v23
    v_mfma_f32_16x16x32_bf16 v[8:11], a[204:207], v[188:191], v[100:103]
    v_cvt_pk_bf16_f32 v54, v12, v13
    v_cvt_pk_bf16_f32 v55, v14, v15
    v_mfma_f32_16x16x32_bf16 v[8:11], a[200:203], v[184:187], v[8:11]
    v_cvt_pk_bf16_f32 v50, v4, v5
    v_cvt_pk_bf16_f32 v51, v6, v7
    v_mfma_f32_16x16x32_bf16 v[8:11], a[196:199], v[180:183], v[8:11]
    v_mfma_f32_16x16x32_bf16 v[8:11], a[192:195], v[176:179], v[8:11]
    v_mfma_f32_16x16x32_bf16 v[16:19], a[192:195], v[192:195], v[104:107]
    v_mfma_f32_16x16x32_bf16 v[16:19], a[196:199], v[196:199], v[16:19]
    v_mfma_f32_16x16x32_bf16 v[16:19], a[200:203], v[200:203], v[16:19]
    v_mfma_f32_16x16x32_bf16 v[16:19], a[204:207], v[204:207], v[16:19]
    v_exp_f32 v0, v0
    v_mfma_f32_16x16x32_bf16 v[24:27], a[204:207], v[220:223], v[108:111]
    v_exp_f32 v1, v1
    v_mfma_f32_16x16x32_bf16 v[24:27], a[200:203], v[216:219], v[24:27]
    v_exp_f32 v2, v2
    v_mfma_f32_16x16x32_bf16 v[24:27], a[196:199], v[212:215], v[24:27]
    s_add_u32 m0, s32, 49152
    v_cvt_pk_bf16_f32 v72, v0, v1
    v_mfma_f32_16x16x32_bf16 v[24:27], a[192:195], v[208:211], v[24:27]
    v_exp_f32 v8, v8
    v_mfma_f32_16x16x32_bf16 v[32:35], a[192:195], v[224:227], v[112:115]
    v_exp_f32 v9, v9
    v_mfma_f32_16x16x32_bf16 v[32:35], a[196:199], v[228:231], v[32:35]
    v_exp_f32 v3, v3
    v_mfma_f32_16x16x32_bf16 v[32:35], a[200:203], v[232:235], v[32:35]
    v_cvt_pk_bf16_f32 v73, v2, v3
    v_mfma_f32_16x16x32_bf16 v[32:35], a[204:207], v[236:239], v[32:35]
    v_exp_f32 v16, v16
    v_mfma_f32_16x16x32_bf16 v[40:43], a[204:207], v[252:255], v[116:119]
    v_exp_f32 v10, v10
    v_mfma_f32_16x16x32_bf16 v[40:43], a[200:203], v[248:251], v[40:43]
    v_cvt_pk_bf16_f32 v76, v8, v9
    v_mfma_f32_16x16x32_bf16 v[40:43], a[196:199], v[244:247], v[40:43]
    v_exp_f32 v11, v11
    v_mfma_f32_16x16x32_bf16 v[40:43], a[192:195], v[240:243], v[40:43]
    v_exp_f32 v24, v24
    v_mfma_f32_16x16x32_bf16 v[44:47], a[208:211], v[240:243], v[116:119]
    v_cvt_pk_bf16_f32 v77, v10, v11
    v_mfma_f32_16x16x32_bf16 v[44:47], a[212:215], v[244:247], v[44:47]
    v_exp_f32 v17, v17
    v_mfma_f32_16x16x32_bf16 v[44:47], a[216:219], v[248:251], v[44:47]
    buffer_load_dwordx4 v154, s[20:23], s31 offen nt lds
    v_mfma_f32_16x16x32_bf16 v[44:47], a[220:223], v[252:255], v[44:47]
    buffer_load_dwordx4 v154, s[20:23], s31 offen offset:1024 nt lds
    v_mfma_f32_16x16x32_bf16 v[36:39], a[220:223], v[236:239], v[112:115]
    buffer_load_dwordx4 v154, s[20:23], s31 offen offset:2048 nt lds
    v_mfma_f32_16x16x32_bf16 v[36:39], a[216:219], v[232:235], v[36:39]
    buffer_load_dwordx4 v154, s[20:23], s31 offen offset:3072 nt lds
    v_mfma_f32_16x16x32_bf16 v[36:39], a[212:215], v[228:231], v[36:39]
    s_add_u32 s31, s31, 8192
    s_add_u32 m0, s32, 24576
    v_mfma_f32_16x16x32_bf16 v[36:39], a[208:211], v[224:227], v[36:39]
    v_exp_f32 v40, v40
    v_mfma_f32_16x16x32_bf16 v[28:31], a[208:211], v[208:211], v[108:111]
    v_exp_f32 v41, v41
    v_mfma_f32_16x16x32_bf16 v[28:31], a[212:215], v[212:215], v[28:31]
    v_exp_f32 v42, v42
    v_mfma_f32_16x16x32_bf16 v[28:31], a[216:219], v[216:219], v[28:31]
    v_exp_f32 v32, v32
    v_mfma_f32_16x16x32_bf16 v[28:31], a[220:223], v[220:223], v[28:31]
    v_exp_f32 v44, v44
    v_mfma_f32_16x16x32_bf16 v[20:23], a[220:223], v[204:207], v[104:107]
    s_waitcnt vmcnt(4)
    s_barrier
    v_mfma_f32_16x16x32_bf16 v[20:23], a[216:219], v[200:203], v[20:23]
    ds_read_b128 a[192:195], v144 offset:16384
    ds_read_b128 a[196:199], v145 offset:16384
    v_mfma_f32_16x16x32_bf16 v[20:23], a[212:215], v[196:199], v[20:23]
    ds_read_b128 a[200:203], v146 offset:16384
    ds_read_b128 a[204:207], v147 offset:16384
    v_mfma_f32_16x16x32_bf16 v[20:23], a[208:211], v[192:195], v[20:23]
    v_exp_f32 v36, v36
    v_mfma_f32_16x16x32_bf16 v[12:15], a[208:211], v[176:179], v[100:103]
    buffer_load_dwordx4 v152, s[16:19], s30 offen nt lds
    v_mfma_f32_16x16x32_bf16 v[12:15], a[212:215], v[180:183], v[12:15]
    v_exp_f32 v18, v18
    v_mfma_f32_16x16x32_bf16 v[12:15], a[216:219], v[184:187], v[12:15]
    buffer_load_dwordx4 v153, s[16:19], s30 offen offset:1024 nt lds
    v_mfma_f32_16x16x32_bf16 v[12:15], a[220:223], v[188:191], v[12:15]
    v_exp_f32 v28, v28
    v_mfma_f32_16x16x32_bf16 v[4:7], a[220:223], v[172:175], v[96:99]
    buffer_load_dwordx4 v152, s[16:19], s30 offen offset:2048 nt lds
    v_mfma_f32_16x16x32_bf16 v[4:7], a[216:219], v[168:171], v[4:7]
    v_exp_f32 v29, v29
    v_mfma_f32_16x16x32_bf16 v[4:7], a[212:215], v[164:167], v[4:7]
    buffer_load_dwordx4 v153, s[16:19], s30 offen offset:3072 nt lds
    v_mfma_f32_16x16x32_bf16 v[4:7], a[208:211], v[160:163], v[4:7]
    s_add_u32 s30, s30, 8192
    v_cvt_pk_bf16_f32 v80, v16, v17
    s_waitcnt lgkmcnt(0)
    v_mfma_f32_16x16x32_bf16 v[0:3], a[192:195], v[160:163], v[96:99]
    ds_read_b128 a[208:211], v144 offset:20480
    ds_read_b128 a[212:215], v145 offset:20480
    v_mfma_f32_16x16x32_bf16 v[0:3], a[196:199], v[164:167], v[0:3]
    v_exp_f32 v19, v19
    v_mfma_f32_16x16x32_bf16 v[0:3], a[200:203], v[168:171], v[0:3]
    v_cvt_pk_bf16_f32 v81, v18, v19
    ds_read_b128 a[216:219], v146 offset:20480
    v_mfma_f32_16x16x32_bf16 v[0:3], a[204:207], v[172:175], v[0:3]
    v_exp_f32 v12, v12
    v_mfma_f32_16x16x32_bf16 v[8:11], a[204:207], v[188:191], v[100:103]
    v_exp_f32 v25, v25
    v_mfma_f32_16x16x32_bf16 v[8:11], a[200:203], v[184:187], v[8:11]
    v_exp_f32 v26, v26
    v_mfma_f32_16x16x32_bf16 v[8:11], a[196:199], v[180:183], v[8:11]
    v_cvt_pk_bf16_f32 v84, v24, v25
    ds_read_b128 a[220:223], v147 offset:20480
    v_mfma_f32_16x16x32_bf16 v[8:11], a[192:195], v[176:179], v[8:11]
    v_exp_f32 v27, v27
    v_mfma_f32_16x16x32_bf16 v[16:19], a[192:195], v[192:195], v[104:107]
    v_cvt_pk_bf16_f32 v85, v26, v27
    v_cvt_pk_bf16_f32 v92, v40, v41
    v_mfma_f32_16x16x32_bf16 v[16:19], a[196:199], v[196:199], v[16:19]
    v_exp_f32 v33, v33
    v_mfma_f32_16x16x32_bf16 v[16:19], a[200:203], v[200:203], v[16:19]
    v_exp_f32 v34, v34
    v_mfma_f32_16x16x32_bf16 v[16:19], a[204:207], v[204:207], v[16:19]
    v_cvt_pk_bf16_f32 v88, v32, v33
    v_mfma_f32_16x16x32_bf16 v[24:27], a[204:207], v[220:223], v[108:111]
    v_exp_f32 v35, v35
    v_mfma_f32_16x16x32_bf16 v[24:27], a[200:203], v[216:219], v[24:27]
    v_cvt_pk_bf16_f32 v89, v34, v35
    v_mfma_f32_16x16x32_bf16 v[24:27], a[196:199], v[212:215], v[24:27]
    v_exp_f32 v4, v4
    v_mfma_f32_16x16x32_bf16 v[24:27], a[192:195], v[208:211], v[24:27]
    v_exp_f32 v20, v20
    v_mfma_f32_16x16x32_bf16 v[32:35], a[192:195], v[224:227], v[112:115]
    v_exp_f32 v43, v43
    v_mfma_f32_16x16x32_bf16 v[32:35], a[196:199], v[228:231], v[32:35]
    v_cvt_pk_bf16_f32 v93, v42, v43
    v_mfma_f32_16x16x32_bf16 v[32:35], a[200:203], v[232:235], v[32:35]
    v_exp_f32 v45, v45
    v_mfma_f32_16x16x32_bf16 v[32:35], a[204:207], v[236:239], v[32:35]
    v_exp_f32 v46, v46
    v_mfma_f32_16x16x32_bf16 v[40:43], a[204:207], v[252:255], v[116:119]
    v_cvt_pk_bf16_f32 v94, v44, v45
    v_mfma_f32_16x16x32_bf16 v[40:43], a[200:203], v[248:251], v[40:43]
    v_exp_f32 v47, v47
    v_mfma_f32_16x16x32_bf16 v[40:43], a[196:199], v[244:247], v[40:43]
    v_cvt_pk_bf16_f32 v95, v46, v47
    v_mfma_f32_16x16x32_bf16 v[40:43], a[192:195], v[240:243], v[40:43]
    v_exp_f32 v37, v37
    s_waitcnt lgkmcnt(0)
    v_mfma_f32_16x16x32_bf16 v[44:47], a[208:211], v[240:243], v[116:119]
    v_exp_f32 v38, v38
    v_mfma_f32_16x16x32_bf16 v[44:47], a[212:215], v[244:247], v[44:47]
    v_cvt_pk_bf16_f32 v90, v36, v37
    v_mfma_f32_16x16x32_bf16 v[44:47], a[216:219], v[248:251], v[44:47]
    v_exp_f32 v39, v39
    v_mfma_f32_16x16x32_bf16 v[44:47], a[220:223], v[252:255], v[44:47]
    v_cvt_pk_bf16_f32 v91, v38, v39
    v_mfma_f32_16x16x32_bf16 v[36:39], a[220:223], v[236:239], v[112:115]
    v_exp_f32 v30, v30
    v_mfma_f32_16x16x32_bf16 v[36:39], a[216:219], v[232:235], v[36:39]
    v_cvt_pk_bf16_f32 v86, v28, v29
    v_mfma_f32_16x16x32_bf16 v[36:39], a[212:215], v[228:231], v[36:39]
    v_exp_f32 v31, v31
    v_exp_f32 v21, v21
    v_mfma_f32_16x16x32_bf16 v[36:39], a[208:211], v[224:227], v[36:39]
    v_cvt_pk_bf16_f32 v87, v30, v31
    s_waitcnt vmcnt(4)
    s_barrier
    v_mfma_f32_16x16x32_bf16 v[28:31], a[208:211], v[208:211], v[108:111]
    v_exp_f32 v22, v22
    v_mfma_f32_16x16x32_bf16 v[28:31], a[212:215], v[212:215], v[28:31]
    v_cvt_pk_bf16_f32 v82, v20, v21
    ds_read_b64_tr_b16 a[224:225], v148
    v_mfma_f32_16x16x32_bf16 v[28:31], a[216:219], v[216:219], v[28:31]
    v_exp_f32 v23, v23
    v_mfma_f32_16x16x32_bf16 v[28:31], a[220:223], v[220:223], v[28:31]
    v_cvt_pk_bf16_f32 v83, v22, v23
    ds_read_b64_tr_b16 a[226:227], v148 offset:4096
    v_mfma_f32_16x16x32_bf16 v[20:23], a[220:223], v[204:207], v[104:107]
    v_exp_f32 v13, v13
    v_mfma_f32_16x16x32_bf16 v[20:23], a[216:219], v[200:203], v[20:23]
    v_exp_f32 v14, v14
    v_mfma_f32_16x16x32_bf16 v[20:23], a[212:215], v[196:199], v[20:23]
    v_cvt_pk_bf16_f32 v78, v12, v13
    ds_read_b64_tr_b16 a[228:229], v148 offset:8192
    v_exp_f32 v15, v15
    v_mfma_f32_16x16x32_bf16 v[20:23], a[208:211], v[192:195], v[20:23]
    v_cvt_pk_bf16_f32 v79, v14, v15
    ds_read_b64_tr_b16 a[230:231], v148 offset:12288
    v_mfma_f32_16x16x32_bf16 v[12:15], a[208:211], v[176:179], v[100:103]
    v_exp_f32 v5, v5
    v_mfma_f32_16x16x32_bf16 v[12:15], a[212:215], v[180:183], v[12:15]
    v_exp_f32 v6, v6
    v_mfma_f32_16x16x32_bf16 v[12:15], a[216:219], v[184:187], v[12:15]
    v_cvt_pk_bf16_f32 v74, v4, v5
    ds_read_b64_tr_b16 a[232:233], v148 offset:32
    v_exp_f32 v7, v7
    v_mfma_f32_16x16x32_bf16 v[12:15], a[220:223], v[188:191], v[12:15]
    v_cvt_pk_bf16_f32 v75, v6, v7
    ds_read_b64_tr_b16 a[234:235], v148 offset:4128
    v_mfma_f32_16x16x32_bf16 v[4:7], a[220:223], v[172:175], v[96:99]
    ds_read_b64_tr_b16 a[236:237], v148 offset:8224
    ds_read_b64_tr_b16 a[238:239], v148 offset:12320
    v_mfma_f32_16x16x32_bf16 v[4:7], a[216:219], v[168:171], v[4:7]
    v_exp_f32 v0, v0
    v_mfma_f32_16x16x32_bf16 v[4:7], a[212:215], v[164:167], v[4:7]
    v_exp_f32 v1, v1
    v_mfma_f32_16x16x32_bf16 v[4:7], a[208:211], v[160:163], v[4:7]
    v_exp_f32 v2, v2
    v_mfma_f32_16x16x32_bf16 v[140:143], a[248:251], v[68:71], v[140:143]
    v_exp_f32 v3, v3
    v_mfma_f32_16x16x32_bf16 v[140:143], a[248:251], v[92:95], v[140:143]
    v_exp_f32 v8, v8
    v_mfma_f32_16x16x32_bf16 v[136:139], a[248:251], v[64:67], v[136:139]
    v_exp_f32 v9, v9
    v_mfma_f32_16x16x32_bf16 v[136:139], a[248:251], v[88:91], v[136:139]
    v_exp_f32 v10, v10
    v_mfma_f32_16x16x32_bf16 v[132:135], a[248:251], v[60:63], v[132:135]
    v_exp_f32 v11, v11
    v_mfma_f32_16x16x32_bf16 v[132:135], a[248:251], v[84:87], v[132:135]
    ds_read_b64_tr_b16 a[240:241], v149
    ds_read_b64_tr_b16 a[242:243], v149 offset:4096
    v_mfma_f32_16x16x32_bf16 v[128:131], a[248:251], v[56:59], v[128:131]
    ds_read_b64_tr_b16 a[244:245], v149 offset:8192
    ds_read_b64_tr_b16 a[246:247], v149 offset:12288
    v_mfma_f32_16x16x32_bf16 v[128:131], a[248:251], v[80:83], v[128:131]
    v_exp_f32 v16, v16
    v_mfma_f32_16x16x32_bf16 v[124:127], a[248:251], v[52:55], v[124:127]
    v_exp_f32 v17, v17
    v_mfma_f32_16x16x32_bf16 v[124:127], a[248:251], v[76:79], v[124:127]
    v_exp_f32 v18, v18
    v_mfma_f32_16x16x32_bf16 v[120:123], a[248:251], v[48:51], v[120:123]
    v_exp_f32 v19, v19
    v_mfma_f32_16x16x32_bf16 v[120:123], a[248:251], v[72:75], v[120:123]
    v_exp_f32 v24, v24
    s_waitcnt lgkmcnt(4)
    v_mfma_f32_16x16x32_bf16 a[160:163], a[224:227], v[68:71], a[160:163]
    v_exp_f32 v25, v25
    v_mfma_f32_16x16x32_bf16 a[160:163], a[228:231], v[92:95], a[160:163]
    v_exp_f32 v26, v26
    v_mfma_f32_16x16x32_bf16 a[128:131], a[228:231], v[88:91], a[128:131]
    v_exp_f32 v27, v27
    v_mfma_f32_16x16x32_bf16 a[128:131], a[224:227], v[64:67], a[128:131]
    v_exp_f32 v32, v32
    v_mfma_f32_16x16x32_bf16 a[96:99], a[224:227], v[60:63], a[96:99]
    v_exp_f32 v33, v33
    v_mfma_f32_16x16x32_bf16 a[96:99], a[228:231], v[84:87], a[96:99]
    v_exp_f32 v34, v34
    v_mfma_f32_16x16x32_bf16 a[64:67], a[228:231], v[80:83], a[64:67]
    v_exp_f32 v35, v35
    v_mfma_f32_16x16x32_bf16 a[64:67], a[224:227], v[56:59], a[64:67]
    v_exp_f32 v40, v40
    v_mfma_f32_16x16x32_bf16 a[32:35], a[224:227], v[52:55], a[32:35]
    s_add_u32 m0, s32, 57344
    v_mfma_f32_16x16x32_bf16 a[32:35], a[228:231], v[76:79], a[32:35]
    v_exp_f32 v41, v41
    v_mfma_f32_16x16x32_bf16 a[0:3], a[228:231], v[72:75], a[0:3]
    v_exp_f32 v42, v42
    v_mfma_f32_16x16x32_bf16 a[0:3], a[224:227], v[48:51], a[0:3]
    ds_read_b64_tr_b16 a[224:225], v149 offset:32
    ds_read_b64_tr_b16 a[226:227], v149 offset:4128
    v_mfma_f32_16x16x32_bf16 a[4:7], a[232:235], v[48:51], a[4:7]
    ds_read_b64_tr_b16 a[228:229], v149 offset:8224
    ds_read_b64_tr_b16 a[230:231], v149 offset:12320
    v_mfma_f32_16x16x32_bf16 a[4:7], a[236:239], v[72:75], a[4:7]
    v_exp_f32 v43, v43
    v_mfma_f32_16x16x32_bf16 a[36:39], a[236:239], v[76:79], a[36:39]
    v_exp_f32 v44, v44
    v_mfma_f32_16x16x32_bf16 a[36:39], a[232:235], v[52:55], a[36:39]
    v_exp_f32 v45, v45
    v_mfma_f32_16x16x32_bf16 a[68:71], a[232:235], v[56:59], a[68:71]
    v_exp_f32 v46, v46
    v_mfma_f32_16x16x32_bf16 a[68:71], a[236:239], v[80:83], a[68:71]
    v_exp_f32 v47, v47
    v_mfma_f32_16x16x32_bf16 a[100:103], a[236:239], v[84:87], a[100:103]
    v_exp_f32 v36, v36
    v_mfma_f32_16x16x32_bf16 a[100:103], a[232:235], v[60:63], a[100:103]
    v_exp_f32 v37, v37
    v_mfma_f32_16x16x32_bf16 a[132:135], a[232:235], v[64:67], a[132:135]
    buffer_load_dwordx4 v154, s[20:23], s31 offen nt lds
    v_mfma_f32_16x16x32_bf16 a[132:135], a[236:239], v[88:91], a[132:135]
    buffer_load_dwordx4 v154, s[20:23], s31 offen offset:1024 nt lds
    v_mfma_f32_16x16x32_bf16 a[164:167], a[236:239], v[92:95], a[164:167]
    buffer_load_dwordx4 v154, s[20:23], s31 offen offset:2048 nt lds
    v_mfma_f32_16x16x32_bf16 a[164:167], a[232:235], v[68:71], a[164:167]
    buffer_load_dwordx4 v154, s[20:23], s31 offen offset:3072 nt lds
    s_waitcnt lgkmcnt(0)
    v_mfma_f32_16x16x32_bf16 a[168:171], a[240:243], v[68:71], a[168:171]
    s_add_u32 s31, s31, 8192
    s_add_u32 m0, s32, 0
    v_mfma_f32_16x16x32_bf16 a[168:171], a[244:247], v[92:95], a[168:171]
    ds_read_b64_tr_b16 a[232:233], v150
    ds_read_b64_tr_b16 a[234:235], v150 offset:4096
    v_mfma_f32_16x16x32_bf16 a[136:139], a[244:247], v[88:91], a[136:139]
    ds_read_b64_tr_b16 a[236:237], v150 offset:8192
    ds_read_b64_tr_b16 a[238:239], v150 offset:12288
    v_mfma_f32_16x16x32_bf16 a[136:139], a[240:243], v[64:67], a[136:139]
    v_exp_f32 v38, v38
    v_mfma_f32_16x16x32_bf16 a[104:107], a[240:243], v[60:63], a[104:107]
    buffer_load_dwordx4 v152, s[16:19], s30 offen nt lds
    v_mfma_f32_16x16x32_bf16 a[104:107], a[244:247], v[84:87], a[104:107]
    v_exp_f32 v39, v39
    v_mfma_f32_16x16x32_bf16 a[72:75], a[244:247], v[80:83], a[72:75]
    buffer_load_dwordx4 v153, s[16:19], s30 offen offset:1024 nt lds
    v_mfma_f32_16x16x32_bf16 a[72:75], a[240:243], v[56:59], a[72:75]
    v_exp_f32 v28, v28
    v_mfma_f32_16x16x32_bf16 a[40:43], a[240:243], v[52:55], a[40:43]
    buffer_load_dwordx4 v152, s[16:19], s30 offen offset:2048 nt lds
    v_mfma_f32_16x16x32_bf16 a[40:43], a[244:247], v[76:79], a[40:43]
    v_exp_f32 v29, v29
    v_mfma_f32_16x16x32_bf16 a[8:11], a[244:247], v[72:75], a[8:11]
    buffer_load_dwordx4 v153, s[16:19], s30 offen offset:3072 nt lds
    v_mfma_f32_16x16x32_bf16 a[8:11], a[240:243], v[48:51], a[8:11]
    s_add_u32 s30, s30, 8192
    ds_read_b64_tr_b16 a[240:241], v150 offset:32
    v_mfma_f32_16x16x32_bf16 a[12:15], a[224:227], v[48:51], a[12:15]
    ds_read_b64_tr_b16 a[242:243], v150 offset:4128
    ds_read_b64_tr_b16 a[244:245], v150 offset:8224
    v_mfma_f32_16x16x32_bf16 a[12:15], a[228:231], v[72:75], a[12:15]
    ds_read_b64_tr_b16 a[246:247], v150 offset:12320
    v_mfma_f32_16x16x32_bf16 a[44:47], a[228:231], v[76:79], a[44:47]
    v_exp_f32 v30, v30
    v_mfma_f32_16x16x32_bf16 a[44:47], a[224:227], v[52:55], a[44:47]
    v_exp_f32 v31, v31
    v_mfma_f32_16x16x32_bf16 a[76:79], a[224:227], v[56:59], a[76:79]
    v_exp_f32 v20, v20
    v_mfma_f32_16x16x32_bf16 a[76:79], a[228:231], v[80:83], a[76:79]
    v_exp_f32 v21, v21
    v_mfma_f32_16x16x32_bf16 a[108:111], a[228:231], v[84:87], a[108:111]
    v_exp_f32 v22, v22
    v_mfma_f32_16x16x32_bf16 a[108:111], a[224:227], v[60:63], a[108:111]
    v_exp_f32 v23, v23
    v_mfma_f32_16x16x32_bf16 a[140:143], a[224:227], v[64:67], a[140:143]
    v_exp_f32 v12, v12
    v_mfma_f32_16x16x32_bf16 a[140:143], a[228:231], v[88:91], a[140:143]
    v_exp_f32 v13, v13
    v_mfma_f32_16x16x32_bf16 a[172:175], a[228:231], v[92:95], a[172:175]
    v_exp_f32 v14, v14
    v_mfma_f32_16x16x32_bf16 a[172:175], a[224:227], v[68:71], a[172:175]
    ds_read_b64_tr_b16 a[224:225], v151
    ds_read_b64_tr_b16 a[226:227], v151 offset:4096
    s_waitcnt lgkmcnt(2)
    v_mfma_f32_16x16x32_bf16 a[176:179], a[232:235], v[68:71], a[176:179]
    ds_read_b64_tr_b16 a[228:229], v151 offset:8192
    ds_read_b64_tr_b16 a[230:231], v151 offset:12288
    v_mfma_f32_16x16x32_bf16 a[176:179], a[236:239], v[92:95], a[176:179]
    s_waitcnt vmcnt(8)
    s_barrier
    v_mfma_f32_16x16x32_bf16 a[144:147], a[236:239], v[88:91], a[144:147]
    v_exp_f32 v15, v15
    v_mfma_f32_16x16x32_bf16 a[144:147], a[232:235], v[64:67], a[144:147]
    v_exp_f32 v4, v4
    v_mfma_f32_16x16x32_bf16 a[112:115], a[232:235], v[60:63], a[112:115]
    v_exp_f32 v5, v5
    v_mfma_f32_16x16x32_bf16 a[112:115], a[236:239], v[84:87], a[112:115]
    ds_read_b128 a[192:195], v144 offset:24576
    ds_read_b128 a[196:199], v145 offset:24576
    v_mfma_f32_16x16x32_bf16 a[80:83], a[236:239], v[80:83], a[80:83]
    ds_read_b128 a[200:203], v146 offset:24576
    ds_read_b128 a[204:207], v147 offset:24576
    v_mfma_f32_16x16x32_bf16 a[80:83], a[232:235], v[56:59], a[80:83]
    ds_read_b128 a[208:211], v144 offset:28672
    ds_read_b128 a[212:215], v145 offset:28672
    v_mfma_f32_16x16x32_bf16 a[48:51], a[232:235], v[52:55], a[48:51]
    ds_read_b128 a[216:219], v146 offset:28672
    ds_read_b128 a[220:223], v147 offset:28672
    v_mfma_f32_16x16x32_bf16 a[48:51], a[236:239], v[76:79], a[48:51]
    v_exp_f32 v6, v6
    v_mfma_f32_16x16x32_bf16 a[16:19], a[236:239], v[72:75], a[16:19]
    v_exp_f32 v7, v7
    v_mfma_f32_16x16x32_bf16 a[16:19], a[232:235], v[48:51], a[16:19]
    ds_read_b64_tr_b16 a[232:233], v151 offset:32
    ds_read_b64_tr_b16 a[234:235], v151 offset:4128
    v_mfma_f32_16x16x32_bf16 a[20:23], a[240:243], v[48:51], a[20:23]
    ds_read_b64_tr_b16 a[236:237], v151 offset:8224
    s_waitcnt lgkmcnt(9)
    ds_read_b64_tr_b16 a[238:239], v151 offset:12320
    v_mfma_f32_16x16x32_bf16 a[20:23], a[244:247], v[72:75], a[20:23]
    v_mfma_f32_16x16x32_bf16 a[52:55], a[244:247], v[76:79], a[52:55]
    v_mfma_f32_16x16x32_bf16 a[52:55], a[240:243], v[52:55], a[52:55]
    v_mfma_f32_16x16x32_bf16 a[84:87], a[240:243], v[56:59], a[84:87]
    v_mfma_f32_16x16x32_bf16 a[84:87], a[244:247], v[80:83], a[84:87]
    v_mfma_f32_16x16x32_bf16 a[116:119], a[244:247], v[84:87], a[116:119]
    v_mfma_f32_16x16x32_bf16 a[116:119], a[240:243], v[60:63], a[116:119]
    v_mfma_f32_16x16x32_bf16 a[148:151], a[240:243], v[64:67], a[148:151]
    v_mfma_f32_16x16x32_bf16 a[148:151], a[244:247], v[88:91], a[148:151]
    v_mfma_f32_16x16x32_bf16 a[180:183], a[244:247], v[92:95], a[180:183]
    v_mfma_f32_16x16x32_bf16 a[180:183], a[240:243], v[68:71], a[180:183]
    v_mfma_f32_16x16x32_bf16 a[184:187], a[224:227], v[68:71], a[184:187]
    v_mfma_f32_16x16x32_bf16 a[184:187], a[228:231], v[92:95], a[184:187]
    s_waitcnt vmcnt(4)
    v_mfma_f32_16x16x32_bf16 a[152:155], a[228:231], v[88:91], a[152:155]
    v_mfma_f32_16x16x32_bf16 a[152:155], a[224:227], v[64:67], a[152:155]
    v_mfma_f32_16x16x32_bf16 a[120:123], a[224:227], v[60:63], a[120:123]
    v_mfma_f32_16x16x32_bf16 a[120:123], a[228:231], v[84:87], a[120:123]
    v_mfma_f32_16x16x32_bf16 a[88:91], a[228:231], v[80:83], a[88:91]
    v_mfma_f32_16x16x32_bf16 a[88:91], a[224:227], v[56:59], a[88:91]
    v_mfma_f32_16x16x32_bf16 a[56:59], a[224:227], v[52:55], a[56:59]
    v_mfma_f32_16x16x32_bf16 a[56:59], a[228:231], v[76:79], a[56:59]
    v_mfma_f32_16x16x32_bf16 a[24:27], a[228:231], v[72:75], a[24:27]
    v_mfma_f32_16x16x32_bf16 a[24:27], a[224:227], v[48:51], a[24:27]
    s_waitcnt lgkmcnt(0)
    v_mfma_f32_16x16x32_bf16 a[28:31], a[232:235], v[48:51], a[28:31]
    v_mfma_f32_16x16x32_bf16 a[28:31], a[236:239], v[72:75], a[28:31]
    v_cvt_pk_bf16_f32 v48, v0, v1
    v_cvt_pk_bf16_f32 v49, v2, v3
    v_mfma_f32_16x16x32_bf16 a[60:63], a[236:239], v[76:79], a[60:63]
    v_mfma_f32_16x16x32_bf16 a[60:63], a[232:235], v[52:55], a[60:63]
    v_cvt_pk_bf16_f32 v52, v8, v9
    v_cvt_pk_bf16_f32 v53, v10, v11
    v_mfma_f32_16x16x32_bf16 a[92:95], a[232:235], v[56:59], a[92:95]
    v_mfma_f32_16x16x32_bf16 a[92:95], a[236:239], v[80:83], a[92:95]
    v_cvt_pk_bf16_f32 v56, v16, v17
    v_cvt_pk_bf16_f32 v57, v18, v19
    v_mfma_f32_16x16x32_bf16 a[124:127], a[236:239], v[84:87], a[124:127]
    v_mfma_f32_16x16x32_bf16 a[124:127], a[232:235], v[60:63], a[124:127]
    v_cvt_pk_bf16_f32 v60, v24, v25
    v_cvt_pk_bf16_f32 v61, v26, v27
    v_mfma_f32_16x16x32_bf16 a[156:159], a[232:235], v[64:67], a[156:159]
    v_mfma_f32_16x16x32_bf16 a[156:159], a[236:239], v[88:91], a[156:159]
    v_cvt_pk_bf16_f32 v64, v32, v33
    v_cvt_pk_bf16_f32 v65, v34, v35
    v_mfma_f32_16x16x32_bf16 a[188:191], a[236:239], v[92:95], a[188:191]
    v_mfma_f32_16x16x32_bf16 a[188:191], a[232:235], v[68:71], a[188:191]
    v_cvt_pk_bf16_f32 v68, v40, v41
    v_cvt_pk_bf16_f32 v69, v42, v43
    v_mfma_f32_16x16x32_bf16 v[0:3], a[192:195], v[160:163], v[96:99]
    v_cvt_pk_bf16_f32 v70, v44, v45
    v_cvt_pk_bf16_f32 v71, v46, v47
    v_mfma_f32_16x16x32_bf16 v[0:3], a[196:199], v[164:167], v[0:3]
    v_cvt_pk_bf16_f32 v66, v36, v37
    v_cvt_pk_bf16_f32 v67, v38, v39
    v_mfma_f32_16x16x32_bf16 v[0:3], a[200:203], v[168:171], v[0:3]
    v_cvt_pk_bf16_f32 v62, v28, v29
    v_cvt_pk_bf16_f32 v63, v30, v31
    v_mfma_f32_16x16x32_bf16 v[0:3], a[204:207], v[172:175], v[0:3]
    v_cvt_pk_bf16_f32 v58, v20, v21
    v_cvt_pk_bf16_f32 v59, v22, v23
    v_mfma_f32_16x16x32_bf16 v[8:11], a[204:207], v[188:191], v[100:103]
    v_cvt_pk_bf16_f32 v54, v12, v13
    v_cvt_pk_bf16_f32 v55, v14, v15
    v_mfma_f32_16x16x32_bf16 v[8:11], a[200:203], v[184:187], v[8:11]
    v_cvt_pk_bf16_f32 v50, v4, v5
    v_cvt_pk_bf16_f32 v51, v6, v7
    v_mfma_f32_16x16x32_bf16 v[8:11], a[196:199], v[180:183], v[8:11]
    v_mfma_f32_16x16x32_bf16 v[8:11], a[192:195], v[176:179], v[8:11]
    v_mfma_f32_16x16x32_bf16 v[16:19], a[192:195], v[192:195], v[104:107]
    v_mfma_f32_16x16x32_bf16 v[16:19], a[196:199], v[196:199], v[16:19]
    v_mfma_f32_16x16x32_bf16 v[16:19], a[200:203], v[200:203], v[16:19]
    v_mfma_f32_16x16x32_bf16 v[16:19], a[204:207], v[204:207], v[16:19]
    v_exp_f32 v0, v0
    v_mfma_f32_16x16x32_bf16 v[24:27], a[204:207], v[220:223], v[108:111]
    v_exp_f32 v1, v1
    v_mfma_f32_16x16x32_bf16 v[24:27], a[200:203], v[216:219], v[24:27]
    v_exp_f32 v2, v2
    v_mfma_f32_16x16x32_bf16 v[24:27], a[196:199], v[212:215], v[24:27]
    s_add_u32 m0, s32, 65536
    v_cvt_pk_bf16_f32 v72, v0, v1
    v_mfma_f32_16x16x32_bf16 v[24:27], a[192:195], v[208:211], v[24:27]
    v_exp_f32 v8, v8
    v_mfma_f32_16x16x32_bf16 v[32:35], a[192:195], v[224:227], v[112:115]
    v_exp_f32 v9, v9
    v_mfma_f32_16x16x32_bf16 v[32:35], a[196:199], v[228:231], v[32:35]
    v_exp_f32 v3, v3
    v_mfma_f32_16x16x32_bf16 v[32:35], a[200:203], v[232:235], v[32:35]
    v_cvt_pk_bf16_f32 v73, v2, v3
    v_mfma_f32_16x16x32_bf16 v[32:35], a[204:207], v[236:239], v[32:35]
    v_exp_f32 v16, v16
    v_mfma_f32_16x16x32_bf16 v[40:43], a[204:207], v[252:255], v[116:119]
    v_exp_f32 v10, v10
    v_mfma_f32_16x16x32_bf16 v[40:43], a[200:203], v[248:251], v[40:43]
    v_cvt_pk_bf16_f32 v76, v8, v9
    v_mfma_f32_16x16x32_bf16 v[40:43], a[196:199], v[244:247], v[40:43]
    v_exp_f32 v11, v11
    v_mfma_f32_16x16x32_bf16 v[40:43], a[192:195], v[240:243], v[40:43]
    v_exp_f32 v24, v24
    v_mfma_f32_16x16x32_bf16 v[44:47], a[208:211], v[240:243], v[116:119]
    v_cvt_pk_bf16_f32 v77, v10, v11
    v_mfma_f32_16x16x32_bf16 v[44:47], a[212:215], v[244:247], v[44:47]
    v_exp_f32 v17, v17
    v_mfma_f32_16x16x32_bf16 v[44:47], a[216:219], v[248:251], v[44:47]
    buffer_load_dwordx4 v154, s[20:23], s31 offen nt lds
    v_mfma_f32_16x16x32_bf16 v[44:47], a[220:223], v[252:255], v[44:47]
    buffer_load_dwordx4 v154, s[20:23], s31 offen offset:1024 nt lds
    v_mfma_f32_16x16x32_bf16 v[36:39], a[220:223], v[236:239], v[112:115]
    buffer_load_dwordx4 v154, s[20:23], s31 offen offset:2048 nt lds
    v_mfma_f32_16x16x32_bf16 v[36:39], a[216:219], v[232:235], v[36:39]
    buffer_load_dwordx4 v154, s[20:23], s31 offen offset:3072 nt lds
    v_mfma_f32_16x16x32_bf16 v[36:39], a[212:215], v[228:231], v[36:39]
    s_add_u32 s31, s31, 8192
    s_add_u32 m0, s32, 8192
    v_mfma_f32_16x16x32_bf16 v[36:39], a[208:211], v[224:227], v[36:39]
    v_exp_f32 v40, v40
    v_mfma_f32_16x16x32_bf16 v[28:31], a[208:211], v[208:211], v[108:111]
    v_exp_f32 v41, v41
    v_mfma_f32_16x16x32_bf16 v[28:31], a[212:215], v[212:215], v[28:31]
    v_exp_f32 v42, v42
    v_mfma_f32_16x16x32_bf16 v[28:31], a[216:219], v[216:219], v[28:31]
    v_exp_f32 v32, v32
    v_mfma_f32_16x16x32_bf16 v[28:31], a[220:223], v[220:223], v[28:31]
    v_exp_f32 v44, v44
    v_mfma_f32_16x16x32_bf16 v[20:23], a[220:223], v[204:207], v[104:107]
    s_waitcnt vmcnt(4)
    s_barrier
    v_mfma_f32_16x16x32_bf16 v[20:23], a[216:219], v[200:203], v[20:23]
    ds_read_b128 a[192:195], v144
    ds_read_b128 a[196:199], v145
    v_mfma_f32_16x16x32_bf16 v[20:23], a[212:215], v[196:199], v[20:23]
    ds_read_b128 a[200:203], v146
    ds_read_b128 a[204:207], v147
    v_mfma_f32_16x16x32_bf16 v[20:23], a[208:211], v[192:195], v[20:23]
    v_exp_f32 v36, v36
    v_mfma_f32_16x16x32_bf16 v[12:15], a[208:211], v[176:179], v[100:103]
    buffer_load_dwordx4 v152, s[16:19], s30 offen nt lds
    v_mfma_f32_16x16x32_bf16 v[12:15], a[212:215], v[180:183], v[12:15]
    v_exp_f32 v18, v18
    v_mfma_f32_16x16x32_bf16 v[12:15], a[216:219], v[184:187], v[12:15]
    buffer_load_dwordx4 v153, s[16:19], s30 offen offset:1024 nt lds
    v_mfma_f32_16x16x32_bf16 v[12:15], a[220:223], v[188:191], v[12:15]
    v_exp_f32 v28, v28
    v_mfma_f32_16x16x32_bf16 v[4:7], a[220:223], v[172:175], v[96:99]
    buffer_load_dwordx4 v152, s[16:19], s30 offen offset:2048 nt lds
    v_mfma_f32_16x16x32_bf16 v[4:7], a[216:219], v[168:171], v[4:7]
    v_exp_f32 v29, v29
    v_mfma_f32_16x16x32_bf16 v[4:7], a[212:215], v[164:167], v[4:7]
    buffer_load_dwordx4 v153, s[16:19], s30 offen offset:3072 nt lds
    v_mfma_f32_16x16x32_bf16 v[4:7], a[208:211], v[160:163], v[4:7]
    s_add_u32 s30, s30, 8192
    v_cvt_pk_bf16_f32 v80, v16, v17
    s_waitcnt lgkmcnt(0)
    v_mfma_f32_16x16x32_bf16 v[0:3], a[192:195], v[160:163], v[96:99]
    ds_read_b128 a[208:211], v144 offset:4096
    ds_read_b128 a[212:215], v145 offset:4096
    v_mfma_f32_16x16x32_bf16 v[0:3], a[196:199], v[164:167], v[0:3]
    v_exp_f32 v19, v19
    v_mfma_f32_16x16x32_bf16 v[0:3], a[200:203], v[168:171], v[0:3]
    v_cvt_pk_bf16_f32 v81, v18, v19
    ds_read_b128 a[216:219], v146 offset:4096
    v_mfma_f32_16x16x32_bf16 v[0:3], a[204:207], v[172:175], v[0:3]
    v_exp_f32 v12, v12
    v_mfma_f32_16x16x32_bf16 v[8:11], a[204:207], v[188:191], v[100:103]
    v_exp_f32 v25, v25
    v_mfma_f32_16x16x32_bf16 v[8:11], a[200:203], v[184:187], v[8:11]
    v_exp_f32 v26, v26
    v_mfma_f32_16x16x32_bf16 v[8:11], a[196:199], v[180:183], v[8:11]
    v_cvt_pk_bf16_f32 v84, v24, v25
    ds_read_b128 a[220:223], v147 offset:4096
    v_mfma_f32_16x16x32_bf16 v[8:11], a[192:195], v[176:179], v[8:11]
    v_exp_f32 v27, v27
    v_mfma_f32_16x16x32_bf16 v[16:19], a[192:195], v[192:195], v[104:107]
    v_cvt_pk_bf16_f32 v85, v26, v27
    v_cvt_pk_bf16_f32 v92, v40, v41
    v_mfma_f32_16x16x32_bf16 v[16:19], a[196:199], v[196:199], v[16:19]
    v_exp_f32 v33, v33
    v_mfma_f32_16x16x32_bf16 v[16:19], a[200:203], v[200:203], v[16:19]
    v_exp_f32 v34, v34
    v_mfma_f32_16x16x32_bf16 v[16:19], a[204:207], v[204:207], v[16:19]
    v_cvt_pk_bf16_f32 v88, v32, v33
    v_mfma_f32_16x16x32_bf16 v[24:27], a[204:207], v[220:223], v[108:111]
    v_exp_f32 v35, v35
    v_mfma_f32_16x16x32_bf16 v[24:27], a[200:203], v[216:219], v[24:27]
    v_cvt_pk_bf16_f32 v89, v34, v35
    v_mfma_f32_16x16x32_bf16 v[24:27], a[196:199], v[212:215], v[24:27]
    v_exp_f32 v4, v4
    v_mfma_f32_16x16x32_bf16 v[24:27], a[192:195], v[208:211], v[24:27]
    v_exp_f32 v20, v20
    v_mfma_f32_16x16x32_bf16 v[32:35], a[192:195], v[224:227], v[112:115]
    v_exp_f32 v43, v43
    v_mfma_f32_16x16x32_bf16 v[32:35], a[196:199], v[228:231], v[32:35]
    v_cvt_pk_bf16_f32 v93, v42, v43
    v_mfma_f32_16x16x32_bf16 v[32:35], a[200:203], v[232:235], v[32:35]
    v_exp_f32 v45, v45
    v_mfma_f32_16x16x32_bf16 v[32:35], a[204:207], v[236:239], v[32:35]
    v_exp_f32 v46, v46
    v_mfma_f32_16x16x32_bf16 v[40:43], a[204:207], v[252:255], v[116:119]
    v_cvt_pk_bf16_f32 v94, v44, v45
    v_mfma_f32_16x16x32_bf16 v[40:43], a[200:203], v[248:251], v[40:43]
    v_exp_f32 v47, v47
    v_mfma_f32_16x16x32_bf16 v[40:43], a[196:199], v[244:247], v[40:43]
    v_cvt_pk_bf16_f32 v95, v46, v47
    v_mfma_f32_16x16x32_bf16 v[40:43], a[192:195], v[240:243], v[40:43]
    v_exp_f32 v37, v37
    s_waitcnt lgkmcnt(0)
    v_mfma_f32_16x16x32_bf16 v[44:47], a[208:211], v[240:243], v[116:119]
    v_exp_f32 v38, v38
    v_mfma_f32_16x16x32_bf16 v[44:47], a[212:215], v[244:247], v[44:47]
    v_cvt_pk_bf16_f32 v90, v36, v37
    v_mfma_f32_16x16x32_bf16 v[44:47], a[216:219], v[248:251], v[44:47]
    v_exp_f32 v39, v39
    v_mfma_f32_16x16x32_bf16 v[44:47], a[220:223], v[252:255], v[44:47]
    v_cvt_pk_bf16_f32 v91, v38, v39
    v_mfma_f32_16x16x32_bf16 v[36:39], a[220:223], v[236:239], v[112:115]
    v_exp_f32 v30, v30
    v_mfma_f32_16x16x32_bf16 v[36:39], a[216:219], v[232:235], v[36:39]
    v_cvt_pk_bf16_f32 v86, v28, v29
    v_mfma_f32_16x16x32_bf16 v[36:39], a[212:215], v[228:231], v[36:39]
    v_exp_f32 v31, v31
    v_exp_f32 v21, v21
    v_mfma_f32_16x16x32_bf16 v[36:39], a[208:211], v[224:227], v[36:39]
    v_cvt_pk_bf16_f32 v87, v30, v31
    s_waitcnt vmcnt(4)
    s_barrier
    v_mfma_f32_16x16x32_bf16 v[28:31], a[208:211], v[208:211], v[108:111]
    v_exp_f32 v22, v22
    v_mfma_f32_16x16x32_bf16 v[28:31], a[212:215], v[212:215], v[28:31]
    v_cvt_pk_bf16_f32 v82, v20, v21
    ds_read_b64_tr_b16 a[224:225], v148 offset:16384
    v_mfma_f32_16x16x32_bf16 v[28:31], a[216:219], v[216:219], v[28:31]
    v_exp_f32 v23, v23
    v_mfma_f32_16x16x32_bf16 v[28:31], a[220:223], v[220:223], v[28:31]
    v_cvt_pk_bf16_f32 v83, v22, v23
    ds_read_b64_tr_b16 a[226:227], v148 offset:20480
    v_mfma_f32_16x16x32_bf16 v[20:23], a[220:223], v[204:207], v[104:107]
    v_exp_f32 v13, v13
    v_mfma_f32_16x16x32_bf16 v[20:23], a[216:219], v[200:203], v[20:23]
    v_exp_f32 v14, v14
    v_mfma_f32_16x16x32_bf16 v[20:23], a[212:215], v[196:199], v[20:23]
    v_cvt_pk_bf16_f32 v78, v12, v13
    ds_read_b64_tr_b16 a[228:229], v148 offset:24576
    v_exp_f32 v15, v15
    v_mfma_f32_16x16x32_bf16 v[20:23], a[208:211], v[192:195], v[20:23]
    v_cvt_pk_bf16_f32 v79, v14, v15
    ds_read_b64_tr_b16 a[230:231], v148 offset:28672
    v_mfma_f32_16x16x32_bf16 v[12:15], a[208:211], v[176:179], v[100:103]
    v_exp_f32 v5, v5
    v_mfma_f32_16x16x32_bf16 v[12:15], a[212:215], v[180:183], v[12:15]
    v_exp_f32 v6, v6
    v_mfma_f32_16x16x32_bf16 v[12:15], a[216:219], v[184:187], v[12:15]
    v_cvt_pk_bf16_f32 v74, v4, v5
    ds_read_b64_tr_b16 a[232:233], v148 offset:16416
    v_exp_f32 v7, v7
    v_mfma_f32_16x16x32_bf16 v[12:15], a[220:223], v[188:191], v[12:15]
    v_cvt_pk_bf16_f32 v75, v6, v7
    ds_read_b64_tr_b16 a[234:235], v148 offset:20512
    v_mfma_f32_16x16x32_bf16 v[4:7], a[220:223], v[172:175], v[96:99]
    ds_read_b64_tr_b16 a[236:237], v148 offset:24608
    ds_read_b64_tr_b16 a[238:239], v148 offset:28704
    v_mfma_f32_16x16x32_bf16 v[4:7], a[216:219], v[168:171], v[4:7]
    v_exp_f32 v0, v0
    v_mfma_f32_16x16x32_bf16 v[4:7], a[212:215], v[164:167], v[4:7]
    v_exp_f32 v1, v1
    v_mfma_f32_16x16x32_bf16 v[4:7], a[208:211], v[160:163], v[4:7]
    v_exp_f32 v2, v2
    v_mfma_f32_16x16x32_bf16 v[140:143], a[248:251], v[68:71], v[140:143]
    v_exp_f32 v3, v3
    v_mfma_f32_16x16x32_bf16 v[140:143], a[248:251], v[92:95], v[140:143]
    v_exp_f32 v8, v8
    v_mfma_f32_16x16x32_bf16 v[136:139], a[248:251], v[64:67], v[136:139]
    v_exp_f32 v9, v9
    v_mfma_f32_16x16x32_bf16 v[136:139], a[248:251], v[88:91], v[136:139]
    v_exp_f32 v10, v10
    v_mfma_f32_16x16x32_bf16 v[132:135], a[248:251], v[60:63], v[132:135]
    v_exp_f32 v11, v11
    v_mfma_f32_16x16x32_bf16 v[132:135], a[248:251], v[84:87], v[132:135]
    ds_read_b64_tr_b16 a[240:241], v149 offset:16384
    ds_read_b64_tr_b16 a[242:243], v149 offset:20480
    v_mfma_f32_16x16x32_bf16 v[128:131], a[248:251], v[56:59], v[128:131]
    ds_read_b64_tr_b16 a[244:245], v149 offset:24576
    ds_read_b64_tr_b16 a[246:247], v149 offset:28672
    v_mfma_f32_16x16x32_bf16 v[128:131], a[248:251], v[80:83], v[128:131]
    v_exp_f32 v16, v16
    v_mfma_f32_16x16x32_bf16 v[124:127], a[248:251], v[52:55], v[124:127]
    v_exp_f32 v17, v17
    v_mfma_f32_16x16x32_bf16 v[124:127], a[248:251], v[76:79], v[124:127]
    v_exp_f32 v18, v18
    v_mfma_f32_16x16x32_bf16 v[120:123], a[248:251], v[48:51], v[120:123]
    v_exp_f32 v19, v19
    v_mfma_f32_16x16x32_bf16 v[120:123], a[248:251], v[72:75], v[120:123]
    v_exp_f32 v24, v24
    s_waitcnt lgkmcnt(4)
    v_mfma_f32_16x16x32_bf16 a[160:163], a[224:227], v[68:71], a[160:163]
    v_exp_f32 v25, v25
    v_mfma_f32_16x16x32_bf16 a[160:163], a[228:231], v[92:95], a[160:163]
    v_exp_f32 v26, v26
    v_mfma_f32_16x16x32_bf16 a[128:131], a[228:231], v[88:91], a[128:131]
    v_exp_f32 v27, v27
    v_mfma_f32_16x16x32_bf16 a[128:131], a[224:227], v[64:67], a[128:131]
    v_exp_f32 v32, v32
    v_mfma_f32_16x16x32_bf16 a[96:99], a[224:227], v[60:63], a[96:99]
    v_exp_f32 v33, v33
    v_mfma_f32_16x16x32_bf16 a[96:99], a[228:231], v[84:87], a[96:99]
    v_exp_f32 v34, v34
    v_mfma_f32_16x16x32_bf16 a[64:67], a[228:231], v[80:83], a[64:67]
    v_exp_f32 v35, v35
    v_mfma_f32_16x16x32_bf16 a[64:67], a[224:227], v[56:59], a[64:67]
    v_exp_f32 v40, v40
    v_mfma_f32_16x16x32_bf16 a[32:35], a[224:227], v[52:55], a[32:35]
    s_add_u32 m0, s32, 40960
    v_mfma_f32_16x16x32_bf16 a[32:35], a[228:231], v[76:79], a[32:35]
    v_exp_f32 v41, v41
    v_mfma_f32_16x16x32_bf16 a[0:3], a[228:231], v[72:75], a[0:3]
    v_exp_f32 v42, v42
    v_mfma_f32_16x16x32_bf16 a[0:3], a[224:227], v[48:51], a[0:3]
    ds_read_b64_tr_b16 a[224:225], v149 offset:16416
    ds_read_b64_tr_b16 a[226:227], v149 offset:20512
    v_mfma_f32_16x16x32_bf16 a[4:7], a[232:235], v[48:51], a[4:7]
    ds_read_b64_tr_b16 a[228:229], v149 offset:24608
    ds_read_b64_tr_b16 a[230:231], v149 offset:28704
    v_mfma_f32_16x16x32_bf16 a[4:7], a[236:239], v[72:75], a[4:7]
    v_exp_f32 v43, v43
    v_mfma_f32_16x16x32_bf16 a[36:39], a[236:239], v[76:79], a[36:39]
    v_exp_f32 v44, v44
    v_mfma_f32_16x16x32_bf16 a[36:39], a[232:235], v[52:55], a[36:39]
    v_exp_f32 v45, v45
    v_mfma_f32_16x16x32_bf16 a[68:71], a[232:235], v[56:59], a[68:71]
    v_exp_f32 v46, v46
    v_mfma_f32_16x16x32_bf16 a[68:71], a[236:239], v[80:83], a[68:71]
    v_exp_f32 v47, v47
    v_mfma_f32_16x16x32_bf16 a[100:103], a[236:239], v[84:87], a[100:103]
    v_exp_f32 v36, v36
    v_mfma_f32_16x16x32_bf16 a[100:103], a[232:235], v[60:63], a[100:103]
    v_exp_f32 v37, v37
    v_mfma_f32_16x16x32_bf16 a[132:135], a[232:235], v[64:67], a[132:135]
    buffer_load_dwordx4 v154, s[20:23], s31 offen nt lds
    v_mfma_f32_16x16x32_bf16 a[132:135], a[236:239], v[88:91], a[132:135]
    buffer_load_dwordx4 v154, s[20:23], s31 offen offset:1024 nt lds
    v_mfma_f32_16x16x32_bf16 a[164:167], a[236:239], v[92:95], a[164:167]
    buffer_load_dwordx4 v154, s[20:23], s31 offen offset:2048 nt lds
    v_mfma_f32_16x16x32_bf16 a[164:167], a[232:235], v[68:71], a[164:167]
    buffer_load_dwordx4 v154, s[20:23], s31 offen offset:3072 nt lds
    s_waitcnt lgkmcnt(0)
    v_mfma_f32_16x16x32_bf16 a[168:171], a[240:243], v[68:71], a[168:171]
    s_add_u32 s31, s31, 8192
    s_add_u32 m0, s32, 16384
    v_mfma_f32_16x16x32_bf16 a[168:171], a[244:247], v[92:95], a[168:171]
    ds_read_b64_tr_b16 a[232:233], v150 offset:16384
    ds_read_b64_tr_b16 a[234:235], v150 offset:20480
    v_mfma_f32_16x16x32_bf16 a[136:139], a[244:247], v[88:91], a[136:139]
    ds_read_b64_tr_b16 a[236:237], v150 offset:24576
    ds_read_b64_tr_b16 a[238:239], v150 offset:28672
    v_mfma_f32_16x16x32_bf16 a[136:139], a[240:243], v[64:67], a[136:139]
    v_exp_f32 v38, v38
    v_mfma_f32_16x16x32_bf16 a[104:107], a[240:243], v[60:63], a[104:107]
    buffer_load_dwordx4 v152, s[16:19], s30 offen nt lds
    v_mfma_f32_16x16x32_bf16 a[104:107], a[244:247], v[84:87], a[104:107]
    v_exp_f32 v39, v39
    v_mfma_f32_16x16x32_bf16 a[72:75], a[244:247], v[80:83], a[72:75]
    buffer_load_dwordx4 v153, s[16:19], s30 offen offset:1024 nt lds
    v_mfma_f32_16x16x32_bf16 a[72:75], a[240:243], v[56:59], a[72:75]
    v_exp_f32 v28, v28
    v_mfma_f32_16x16x32_bf16 a[40:43], a[240:243], v[52:55], a[40:43]
    buffer_load_dwordx4 v152, s[16:19], s30 offen offset:2048 nt lds
    v_mfma_f32_16x16x32_bf16 a[40:43], a[244:247], v[76:79], a[40:43]
    v_exp_f32 v29, v29
    v_mfma_f32_16x16x32_bf16 a[8:11], a[244:247], v[72:75], a[8:11]
    buffer_load_dwordx4 v153, s[16:19], s30 offen offset:3072 nt lds
    v_mfma_f32_16x16x32_bf16 a[8:11], a[240:243], v[48:51], a[8:11]
    s_add_u32 s30, s30, 8192
    ds_read_b64_tr_b16 a[240:241], v150 offset:16416
    v_mfma_f32_16x16x32_bf16 a[12:15], a[224:227], v[48:51], a[12:15]
    ds_read_b64_tr_b16 a[242:243], v150 offset:20512
    ds_read_b64_tr_b16 a[244:245], v150 offset:24608
    v_mfma_f32_16x16x32_bf16 a[12:15], a[228:231], v[72:75], a[12:15]
    ds_read_b64_tr_b16 a[246:247], v150 offset:28704
    v_mfma_f32_16x16x32_bf16 a[44:47], a[228:231], v[76:79], a[44:47]
    v_exp_f32 v30, v30
    v_mfma_f32_16x16x32_bf16 a[44:47], a[224:227], v[52:55], a[44:47]
    v_exp_f32 v31, v31
    v_mfma_f32_16x16x32_bf16 a[76:79], a[224:227], v[56:59], a[76:79]
    v_exp_f32 v20, v20
    v_mfma_f32_16x16x32_bf16 a[76:79], a[228:231], v[80:83], a[76:79]
    v_exp_f32 v21, v21
    v_mfma_f32_16x16x32_bf16 a[108:111], a[228:231], v[84:87], a[108:111]
    v_exp_f32 v22, v22
    v_mfma_f32_16x16x32_bf16 a[108:111], a[224:227], v[60:63], a[108:111]
    v_exp_f32 v23, v23
    v_mfma_f32_16x16x32_bf16 a[140:143], a[224:227], v[64:67], a[140:143]
    v_exp_f32 v12, v12
    v_mfma_f32_16x16x32_bf16 a[140:143], a[228:231], v[88:91], a[140:143]
    v_exp_f32 v13, v13
    v_mfma_f32_16x16x32_bf16 a[172:175], a[228:231], v[92:95], a[172:175]
    v_exp_f32 v14, v14
    v_mfma_f32_16x16x32_bf16 a[172:175], a[224:227], v[68:71], a[172:175]
    ds_read_b64_tr_b16 a[224:225], v151 offset:16384
    ds_read_b64_tr_b16 a[226:227], v151 offset:20480
    s_waitcnt lgkmcnt(2)
    v_mfma_f32_16x16x32_bf16 a[176:179], a[232:235], v[68:71], a[176:179]
    ds_read_b64_tr_b16 a[228:229], v151 offset:24576
    ds_read_b64_tr_b16 a[230:231], v151 offset:28672
    v_mfma_f32_16x16x32_bf16 a[176:179], a[236:239], v[92:95], a[176:179]
    s_waitcnt vmcnt(8)
    s_barrier
    v_mfma_f32_16x16x32_bf16 a[144:147], a[236:239], v[88:91], a[144:147]
    v_exp_f32 v15, v15
    v_mfma_f32_16x16x32_bf16 a[144:147], a[232:235], v[64:67], a[144:147]
    v_exp_f32 v4, v4
    v_mfma_f32_16x16x32_bf16 a[112:115], a[232:235], v[60:63], a[112:115]
    v_exp_f32 v5, v5
    v_mfma_f32_16x16x32_bf16 a[112:115], a[236:239], v[84:87], a[112:115]
    ds_read_b128 a[192:195], v144 offset:8192
    ds_read_b128 a[196:199], v145 offset:8192
    v_mfma_f32_16x16x32_bf16 a[80:83], a[236:239], v[80:83], a[80:83]
    ds_read_b128 a[200:203], v146 offset:8192
    ds_read_b128 a[204:207], v147 offset:8192
    v_mfma_f32_16x16x32_bf16 a[80:83], a[232:235], v[56:59], a[80:83]
    ds_read_b128 a[208:211], v144 offset:12288
    ds_read_b128 a[212:215], v145 offset:12288
    v_mfma_f32_16x16x32_bf16 a[48:51], a[232:235], v[52:55], a[48:51]
    ds_read_b128 a[216:219], v146 offset:12288
    ds_read_b128 a[220:223], v147 offset:12288
    v_mfma_f32_16x16x32_bf16 a[48:51], a[236:239], v[76:79], a[48:51]
    v_exp_f32 v6, v6
    v_mfma_f32_16x16x32_bf16 a[16:19], a[236:239], v[72:75], a[16:19]
    v_exp_f32 v7, v7
    v_mfma_f32_16x16x32_bf16 a[16:19], a[232:235], v[48:51], a[16:19]
    ds_read_b64_tr_b16 a[232:233], v151 offset:16416
    ds_read_b64_tr_b16 a[234:235], v151 offset:20512
    v_mfma_f32_16x16x32_bf16 a[20:23], a[240:243], v[48:51], a[20:23]
    ds_read_b64_tr_b16 a[236:237], v151 offset:24608
    s_waitcnt lgkmcnt(9)
    ds_read_b64_tr_b16 a[238:239], v151 offset:28704
    v_mfma_f32_16x16x32_bf16 a[20:23], a[244:247], v[72:75], a[20:23]
    v_mfma_f32_16x16x32_bf16 a[52:55], a[244:247], v[76:79], a[52:55]
    v_mfma_f32_16x16x32_bf16 a[52:55], a[240:243], v[52:55], a[52:55]
    v_mfma_f32_16x16x32_bf16 a[84:87], a[240:243], v[56:59], a[84:87]
    v_mfma_f32_16x16x32_bf16 a[84:87], a[244:247], v[80:83], a[84:87]
    v_mfma_f32_16x16x32_bf16 a[116:119], a[244:247], v[84:87], a[116:119]
    v_mfma_f32_16x16x32_bf16 a[116:119], a[240:243], v[60:63], a[116:119]
    v_mfma_f32_16x16x32_bf16 a[148:151], a[240:243], v[64:67], a[148:151]
    v_mfma_f32_16x16x32_bf16 a[148:151], a[244:247], v[88:91], a[148:151]
    v_mfma_f32_16x16x32_bf16 a[180:183], a[244:247], v[92:95], a[180:183]
    v_mfma_f32_16x16x32_bf16 a[180:183], a[240:243], v[68:71], a[180:183]
    v_mfma_f32_16x16x32_bf16 a[184:187], a[224:227], v[68:71], a[184:187]
    v_mfma_f32_16x16x32_bf16 a[184:187], a[228:231], v[92:95], a[184:187]
    s_waitcnt vmcnt(4)
    v_mfma_f32_16x16x32_bf16 a[152:155], a[228:231], v[88:91], a[152:155]
    v_mfma_f32_16x16x32_bf16 a[152:155], a[224:227], v[64:67], a[152:155]
    v_mfma_f32_16x16x32_bf16 a[120:123], a[224:227], v[60:63], a[120:123]
    v_mfma_f32_16x16x32_bf16 a[120:123], a[228:231], v[84:87], a[120:123]
    v_mfma_f32_16x16x32_bf16 a[88:91], a[228:231], v[80:83], a[88:91]
    v_mfma_f32_16x16x32_bf16 a[88:91], a[224:227], v[56:59], a[88:91]
    v_mfma_f32_16x16x32_bf16 a[56:59], a[224:227], v[52:55], a[56:59]
    v_mfma_f32_16x16x32_bf16 a[56:59], a[228:231], v[76:79], a[56:59]
    v_mfma_f32_16x16x32_bf16 a[24:27], a[228:231], v[72:75], a[24:27]
    v_mfma_f32_16x16x32_bf16 a[24:27], a[224:227], v[48:51], a[24:27]
    s_waitcnt lgkmcnt(0)
    v_mfma_f32_16x16x32_bf16 a[28:31], a[232:235], v[48:51], a[28:31]
    v_mfma_f32_16x16x32_bf16 a[28:31], a[236:239], v[72:75], a[28:31]
    v_cvt_pk_bf16_f32 v48, v0, v1
    v_cvt_pk_bf16_f32 v49, v2, v3
    v_mfma_f32_16x16x32_bf16 a[60:63], a[236:239], v[76:79], a[60:63]
    v_mfma_f32_16x16x32_bf16 a[60:63], a[232:235], v[52:55], a[60:63]
    v_cvt_pk_bf16_f32 v52, v8, v9
    v_cvt_pk_bf16_f32 v53, v10, v11
    v_mfma_f32_16x16x32_bf16 a[92:95], a[232:235], v[56:59], a[92:95]
    v_mfma_f32_16x16x32_bf16 a[92:95], a[236:239], v[80:83], a[92:95]
    v_cvt_pk_bf16_f32 v56, v16, v17
    v_cvt_pk_bf16_f32 v57, v18, v19
    v_mfma_f32_16x16x32_bf16 a[124:127], a[236:239], v[84:87], a[124:127]
    v_mfma_f32_16x16x32_bf16 a[124:127], a[232:235], v[60:63], a[124:127]
    v_cvt_pk_bf16_f32 v60, v24, v25
    v_cvt_pk_bf16_f32 v61, v26, v27
    v_mfma_f32_16x16x32_bf16 a[156:159], a[232:235], v[64:67], a[156:159]
    s_add_u32 s29, s29, 4
    v_mfma_f32_16x16x32_bf16 a[156:159], a[236:239], v[88:91], a[156:159]
    v_cvt_pk_bf16_f32 v64, v32, v33
    v_cvt_pk_bf16_f32 v65, v34, v35
    v_mfma_f32_16x16x32_bf16 a[188:191], a[236:239], v[92:95], a[188:191]
    v_mfma_f32_16x16x32_bf16 a[188:191], a[232:235], v[68:71], a[188:191]
    v_cvt_pk_bf16_f32 v68, v40, v41
    v_cvt_pk_bf16_f32 v69, v42, v43
    s_cmp_lt_u32 s29, 28
    s_cbranch_scc1 L_loopF
L_tailF:
    v_mfma_f32_16x16x32_bf16 v[0:3], a[192:195], v[160:163], v[96:99]
    s_add_u32 m0, s32, 49152
    v_cvt_pk_bf16_f32 v70, v44, v45
    v_mfma_f32_16x16x32_bf16 v[0:3], a[196:199], v[164:167], v[0:3]
    v_cvt_pk_bf16_f32 v71, v46, v47
    v_cvt_pk_bf16_f32 v66, v36, v37
    v_mfma_f32_16x16x32_bf16 v[0:3], a[200:203], v[168:171], v[0:3]
    v_cvt_pk_bf16_f32 v67, v38, v39
    v_cvt_pk_bf16_f32 v62, v28, v29
    v_mfma_f32_16x16x32_bf16 v[0:3], a[204:207], v[172:175], v[0:3]
    v_cvt_pk_bf16_f32 v63, v30, v31
    v_cvt_pk_bf16_f32 v58, v20, v21
    v_mfma_f32_16x16x32_bf16 v[8:11], a[204:207], v[188:191], v[100:103]
    v_cvt_pk_bf16_f32 v59, v22, v23
    v_cvt_pk_bf16_f32 v54, v12, v13
    v_mfma_f32_16x16x32_bf16 v[8:11], a[200:203], v[184:187], v[8:11]
    v_cvt_pk_bf16_f32 v55, v14, v15
    v_cvt_pk_bf16_f32 v50, v4, v5
    v_mfma_f32_16x16x32_bf16 v[8:11], a[196:199], v[180:183], v[8:11]
    v_cvt_pk_bf16_f32 v51, v6, v7
    v_mfma_f32_16x16x32_bf16 v[8:11], a[192:195], v[176:179], v[8:11]
    v_mfma_f32_16x16x32_bf16 v[16:19], a[192:195], v[192:195], v[104:107]
    v_mfma_f32_16x16x32_bf16 v[16:19], a[196:199], v[196:199], v[16:19]
    v_mfma_f32_16x16x32_bf16 v[16:19], a[200:203], v[200:203], v[16:19]
    buffer_load_dwordx4 v154, s[20:23], s31 offen nt lds
    v_mfma_f32_16x16x32_bf16 v[16:19], a[204:207], v[204:207], v[16:19]
    v_exp_f32 v0, v0
    v_mfma_f32_16x16x32_bf16 v[24:27], a[204:207], v[220:223], v[108:111]
    buffer_load_dwordx4 v154, s[20:23], s31 offen offset:1024 nt lds
    v_mfma_f32_16x16x32_bf16 v[24:27], a[200:203], v[216:219], v[24:27]
    v_exp_f32 v1, v1
    v_mfma_f32_16x16x32_bf16 v[24:27], a[196:199], v[212:215], v[24:27]
    buffer_load_dwordx4 v154, s[20:23], s31 offen offset:2048 nt lds
    v_mfma_f32_16x16x32_bf16 v[24:27], a[192:195], v[208:211], v[24:27]
    v_exp_f32 v8, v8
    v_mfma_f32_16x16x32_bf16 v[32:35], a[192:195], v[224:227], v[112:115]
    buffer_load_dwordx4 v154, s[20:23], s31 offen offset:3072 nt lds
    v_mfma_f32_16x16x32_bf16 v[32:35], a[196:199], v[228:231], v[32:35]
    s_add_u32 s31, s31, 8192
    v_mfma_f32_16x16x32_bf16 v[32:35], a[200:203], v[232:235], v[32:35]
    v_exp_f32 v9, v9
    v_mfma_f32_16x16x32_bf16 v[32:35], a[204:207], v[236:239], v[32:35]
    v_exp_f32 v16, v16
    v_mfma_f32_16x16x32_bf16 v[40:43], a[204:207], v[252:255], v[116:119]
    v_exp_f32 v17, v17
    v_mfma_f32_16x16x32_bf16 v[40:43], a[200:203], v[248:251], v[40:43]
    v_exp_f32 v2, v2
    v_mfma_f32_16x16x32_bf16 v[40:43], a[196:199], v[244:247], v[40:43]
    v_cvt_pk_bf16_f32 v72, v0, v1
    v_mfma_f32_16x16x32_bf16 v[40:43], a[192:195], v[240:243], v[40:43]
    v_exp_f32 v24, v24
    v_mfma_f32_16x16x32_bf16 v[44:47], a[208:211], v[240:243], v[116:119]
    v_exp_f32 v25, v25
    v_mfma_f32_16x16x32_bf16 v[44:47], a[212:215], v[244:247], v[44:47]
    v_exp_f32 v3, v3
    v_mfma_f32_16x16x32_bf16 v[44:47], a[216:219], v[248:251], v[44:47]
    v_cvt_pk_bf16_f32 v73, v2, v3
    v_mfma_f32_16x16x32_bf16 v[44:47], a[220:223], v[252:255], v[44:47]
    v_exp_f32 v32, v32
    v_mfma_f32_16x16x32_bf16 v[36:39], a[220:223], v[236:239], v[112:115]
    v_exp_f32 v10, v10
    v_mfma_f32_16x16x32_bf16 v[36:39], a[216:219], v[232:235], v[36:39]
    v_cvt_pk_bf16_f32 v76, v8, v9
    v_mfma_f32_16x16x32_bf16 v[36:39], a[212:215], v[228:231], v[36:39]
    v_exp_f32 v11, v11
    v_mfma_f32_16x16x32_bf16 v[36:39], a[208:211], v[224:227], v[36:39]
    v_exp_f32 v40, v40
    v_mfma_f32_16x16x32_bf16 v[28:31], a[208:211], v[208:211], v[108:111]
    s_add_u32 m0, s32, 24576
    v_cvt_pk_bf16_f32 v77, v10, v11
    v_mfma_f32_16x16x32_bf16 v[28:31], a[212:215], v[212:215], v[28:31]
    v_exp_f32 v41, v41
    v_mfma_f32_16x16x32_bf16 v[28:31], a[216:219], v[216:219], v[28:31]
    v_exp_f32 v42, v42
    v_mfma_f32_16x16x32_bf16 v[28:31], a[220:223], v[220:223], v[28:31]
    v_exp_f32 v44, v44
    v_mfma_f32_16x16x32_bf16 v[20:23], a[220:223], v[204:207], v[104:107]
    s_waitcnt vmcnt(4)
    s_barrier
    v_mfma_f32_16x16x32_bf16 v[20:23], a[216:219], v[200:203], v[20:23]
    ds_read_b128 a[192:195], v144 offset:16384
    ds_read_b128 a[196:199], v145 offset:16384
    v_mfma_f32_16x16x32_bf16 v[20:23], a[212:215], v[196:199], v[20:23]
    ds_read_b128 a[200:203], v146 offset:16384
    ds_read_b128 a[204:207], v147 offset:16384
    v_mfma_f32_16x16x32_bf16 v[20:23], a[208:211], v[192:195], v[20:23]
    v_exp_f32 v36, v36
    v_mfma_f32_16x16x32_bf16 v[12:15], a[208:211], v[176:179], v[100:103]
    v_exp_f32 v18, v18
    v_mfma_f32_16x16x32_bf16 v[12:15], a[212:215], v[180:183], v[12:15]
    v_cvt_pk_bf16_f32 v80, v16, v17
    v_cvt_pk_bf16_f32 v92, v40, v41
    v_mfma_f32_16x16x32_bf16 v[12:15], a[216:219], v[184:187], v[12:15]
    v_exp_f32 v19, v19
    v_mfma_f32_16x16x32_bf16 v[12:15], a[220:223], v[188:191], v[12:15]
    v_exp_f32 v28, v28
    v_mfma_f32_16x16x32_bf16 v[4:7], a[220:223], v[172:175], v[96:99]
    buffer_load_dwordx4 v152, s[16:19], s30 offen nt lds
    v_mfma_f32_16x16x32_bf16 v[4:7], a[216:219], v[168:171], v[4:7]
    v_cvt_pk_bf16_f32 v81, v18, v19
    v_mfma_f32_16x16x32_bf16 v[4:7], a[212:215], v[164:167], v[4:7]
    buffer_load_dwordx4 v153, s[16:19], s30 offen offset:1024 nt lds
    v_mfma_f32_16x16x32_bf16 v[4:7], a[208:211], v[160:163], v[4:7]
    v_exp_f32 v20, v20
    s_waitcnt lgkmcnt(0)
    v_mfma_f32_16x16x32_bf16 v[0:3], a[192:195], v[160:163], v[96:99]
    ds_read_b128 a[208:211], v144 offset:20480
    ds_read_b128 a[212:215], v145 offset:20480
    v_mfma_f32_16x16x32_bf16 v[0:3], a[196:199], v[164:167], v[0:3]
    v_exp_f32 v26, v26
    v_mfma_f32_16x16x32_bf16 v[0:3], a[200:203], v[168:171], v[0:3]
    buffer_load_dwordx4 v152, s[16:19], s30 offen offset:2048 nt lds
    v_mfma_f32_16x16x32_bf16 v[0:3], a[204:207], v[172:175], v[0:3]
    v_exp_f32 v12, v12
    v_mfma_f32_16x16x32_bf16 v[8:11], a[204:207], v[188:191], v[100:103]
    buffer_load_dwordx4 v153, s[16:19], s30 offen offset:3072 nt lds
    v_mfma_f32_16x16x32_bf16 v[8:11], a[200:203], v[184:187], v[8:11]
    s_add_u32 s30, s30, 8192
    v_cvt_pk_bf16_f32 v84, v24, v25
    v_mfma_f32_16x16x32_bf16 v[8:11], a[196:199], v[180:183], v[8:11]
    v_exp_f32 v27, v27
    v_mfma_f32_16x16x32_bf16 v[8:11], a[192:195], v[176:179], v[8:11]
    v_exp_f32 v4, v4
    v_mfma_f32_16x16x32_bf16 v[16:19], a[192:195], v[192:195], v[104:107]
    v_exp_f32 v5, v5
    v_mfma_f32_16x16x32_bf16 v[16:19], a[196:199], v[196:199], v[16:19]
    v_cvt_pk_bf16_f32 v85, v26, v27
    ds_read_b128 a[216:219], v146 offset:20480
    v_mfma_f32_16x16x32_bf16 v[16:19], a[200:203], v[200:203], v[16:19]
    v_exp_f32 v33, v33
    v_mfma_f32_16x16x32_bf16 v[16:19], a[204:207], v[204:207], v[16:19]
    v_exp_f32 v34, v34
    v_mfma_f32_16x16x32_bf16 v[24:27], a[204:207], v[220:223], v[108:111]
    v_cvt_pk_bf16_f32 v88, v32, v33
    ds_read_b128 a[220:223], v147 offset:20480
    v_mfma_f32_16x16x32_bf16 v[24:27], a[200:203], v[216:219], v[24:27]
    v_exp_f32 v35, v35
    v_mfma_f32_16x16x32_bf16 v[24:27], a[196:199], v[212:215], v[24:27]
    v_cvt_pk_bf16_f32 v89, v34, v35
    v_mfma_f32_16x16x32_bf16 v[24:27], a[192:195], v[208:211], v[24:27]
    v_exp_f32 v6, v6
    v_mfma_f32_16x16x32_bf16 v[32:35], a[192:195], v[224:227], v[112:115]
    v_exp_f32 v29, v29
    v_mfma_f32_16x16x32_bf16 v[32:35], a[196:199], v[228:231], v[32:35]
    v_exp_f32 v43, v43
    v_mfma_f32_16x16x32_bf16 v[32:35], a[200:203], v[232:235], v[32:35]
    v_cvt_pk_bf16_f32 v93, v42, v43
    v_cvt_pk_bf16_f32 v74, v4, v5
    v_mfma_f32_16x16x32_bf16 v[32:35], a[204:207], v[236:239], v[32:35]
    v_exp_f32 v45, v45
    v_mfma_f32_16x16x32_bf16 v[40:43], a[204:207], v[252:255], v[116:119]
    v_exp_f32 v46, v46
    v_mfma_f32_16x16x32_bf16 v[40:43], a[200:203], v[248:251], v[40:43]
    v_cvt_pk_bf16_f32 v94, v44, v45
    v_mfma_f32_16x16x32_bf16 v[40:43], a[196:199], v[244:247], v[40:43]
    v_exp_f32 v47, v47
    v_mfma_f32_16x16x32_bf16 v[40:43], a[192:195], v[240:243], v[40:43]
    v_cvt_pk_bf16_f32 v95, v46, v47
    s_waitcnt lgkmcnt(0)
    v_mfma_f32_16x16x32_bf16 v[44:47], a[208:211], v[240:243], v[116:119]
    v_exp_f32 v37, v37
    v_mfma_f32_16x16x32_bf16 v[44:47], a[212:215], v[244:247], v[44:47]
    v_exp_f32 v38, v38
    v_mfma_f32_16x16x32_bf16 v[44:47], a[216:219], v[248:251], v[44:47]
    v_cvt_pk_bf16_f32 v90, v36, v37
    v_mfma_f32_16x16x32_bf16 v[44:47], a[220:223], v[252:255], v[44:47]
    v_exp_f32 v39, v39
    s_nop 0
    v_cvt_pk_bf16_f32 v91, v38, v39
    v_mfma_f32_16x16x32_bf16 v[36:39], a[220:223], v[236:239], v[112:115]
    v_exp_f32 v30, v30
    v_mfma_f32_16x16x32_bf16 v[36:39], a[216:219], v[232:235], v[36:39]
    v_cvt_pk_bf16_f32 v86, v28, v29
    v_mfma_f32_16x16x32_bf16 v[36:39], a[212:215], v[228:231], v[36:39]
    v_exp_f32 v31, v31
    v_exp_f32 v21, v21
    v_mfma_f32_16x16x32_bf16 v[36:39], a[208:211], v[224:227], v[36:39]
    v_cvt_pk_bf16_f32 v87, v30, v31
    s_waitcnt vmcnt(4)
    s_barrier
    v_mfma_f32_16x16x32_bf16 v[28:31], a[208:211], v[208:211], v[108:111]
    v_exp_f32 v22, v22
    v_mfma_f32_16x16x32_bf16 v[28:31], a[212:215], v[212:215], v[28:31]
    v_cvt_pk_bf16_f32 v82, v20, v21
    s_add_u32 m0, s32, 57344
    v_mfma_f32_16x16x32_bf16 v[28:31], a[216:219], v[216:219], v[28:31]
    v_exp_f32 v23, v23
    v_mfma_f32_16x16x32_bf16 v[28:31], a[220:223], v[220:223], v[28:31]
    v_cvt_pk_bf16_f32 v83, v22, v23
    ds_read_b64_tr_b16 a[224:225], v148
    v_mfma_f32_16x16x32_bf16 v[20:23], a[220:223], v[204:207], v[104:107]
    v_exp_f32 v13, v13
    v_mfma_f32_16x16x32_bf16 v[20:23], a[216:219], v[200:203], v[20:23]
    v_exp_f32 v14, v14
    v_mfma_f32_16x16x32_bf16 v[20:23], a[212:215], v[196:199], v[20:23]
    v_cvt_pk_bf16_f32 v78, v12, v13
    ds_read_b64_tr_b16 a[226:227], v148 offset:4096
    v_exp_f32 v15, v15
    v_mfma_f32_16x16x32_bf16 v[20:23], a[208:211], v[192:195], v[20:23]
    v_cvt_pk_bf16_f32 v79, v14, v15
    ds_read_b64_tr_b16 a[228:229], v148 offset:8192
    v_mfma_f32_16x16x32_bf16 v[12:15], a[208:211], v[176:179], v[100:103]
    v_exp_f32 v7, v7
    v_mfma_f32_16x16x32_bf16 v[12:15], a[212:215], v[180:183], v[12:15]
    v_cvt_pk_bf16_f32 v75, v6, v7
    ds_read_b64_tr_b16 a[230:231], v148 offset:12288
    v_mfma_f32_16x16x32_bf16 v[12:15], a[216:219], v[184:187], v[12:15]
    buffer_load_dwordx4 v154, s[20:23], s31 offen nt lds
    v_mfma_f32_16x16x32_bf16 v[12:15], a[220:223], v[188:191], v[12:15]
    ds_read_b64_tr_b16 a[232:233], v148 offset:32
    ds_read_b64_tr_b16 a[234:235], v148 offset:4128
    v_mfma_f32_16x16x32_bf16 v[4:7], a[220:223], v[172:175], v[96:99]
    buffer_load_dwordx4 v154, s[20:23], s31 offen offset:1024 nt lds
    v_mfma_f32_16x16x32_bf16 v[4:7], a[216:219], v[168:171], v[4:7]
    ds_read_b64_tr_b16 a[236:237], v148 offset:8224
    ds_read_b64_tr_b16 a[238:239], v148 offset:12320
    v_mfma_f32_16x16x32_bf16 v[4:7], a[212:215], v[164:167], v[4:7]
    buffer_load_dwordx4 v154, s[20:23], s31 offen offset:2048 nt lds
    v_mfma_f32_16x16x32_bf16 v[4:7], a[208:211], v[160:163], v[4:7]
    v_exp_f32 v0, v0
    v_mfma_f32_16x16x32_bf16 v[140:143], a[248:251], v[68:71], v[140:143]
    v_exp_f32 v1, v1
    v_mfma_f32_16x16x32_bf16 v[140:143], a[248:251], v[92:95], v[140:143]
    ds_read_b64_tr_b16 a[240:241], v149
    ds_read_b64_tr_b16 a[242:243], v149 offset:4096
    v_mfma_f32_16x16x32_bf16 v[136:139], a[248:251], v[64:67], v[136:139]
    buffer_load_dwordx4 v154, s[20:23], s31 offen offset:3072 nt lds
    v_mfma_f32_16x16x32_bf16 v[136:139], a[248:251], v[88:91], v[136:139]
    s_add_u32 s31, s31, 8192
    ds_read_b64_tr_b16 a[244:245], v149 offset:8192
    v_mfma_f32_16x16x32_bf16 v[132:135], a[248:251], v[60:63], v[132:135]
    ds_read_b64_tr_b16 a[246:247], v149 offset:12288
    v_mfma_f32_16x16x32_bf16 v[132:135], a[248:251], v[84:87], v[132:135]
    v_exp_f32 v2, v2
    v_mfma_f32_16x16x32_bf16 v[128:131], a[248:251], v[56:59], v[128:131]
    v_exp_f32 v3, v3
    v_mfma_f32_16x16x32_bf16 v[128:131], a[248:251], v[80:83], v[128:131]
    v_exp_f32 v8, v8
    v_mfma_f32_16x16x32_bf16 v[124:127], a[248:251], v[52:55], v[124:127]
    v_exp_f32 v9, v9
    v_mfma_f32_16x16x32_bf16 v[124:127], a[248:251], v[76:79], v[124:127]
    v_exp_f32 v10, v10
    v_mfma_f32_16x16x32_bf16 v[120:123], a[248:251], v[48:51], v[120:123]
    v_exp_f32 v11, v11
    v_mfma_f32_16x16x32_bf16 v[120:123], a[248:251], v[72:75], v[120:123]
    v_exp_f32 v16, v16
    s_waitcnt lgkmcnt(0)
    v_mfma_f32_16x16x32_bf16 a[160:163], a[224:227], v[68:71], a[160:163]
    v_exp_f32 v17, v17
    v_mfma_f32_16x16x32_bf16 a[160:163], a[228:231], v[92:95], a[160:163]
    v_exp_f32 v18, v18
    v_mfma_f32_16x16x32_bf16 a[128:131], a[228:231], v[88:91], a[128:131]
    v_exp_f32 v19, v19
    v_mfma_f32_16x16x32_bf16 a[128:131], a[224:227], v[64:67], a[128:131]
    v_exp_f32 v24, v24
    v_mfma_f32_16x16x32_bf16 a[96:99], a[224:227], v[60:63], a[96:99]
    v_exp_f32 v25, v25
    v_mfma_f32_16x16x32_bf16 a[96:99], a[228:231], v[84:87], a[96:99]
    v_exp_f32 v26, v26
    v_mfma_f32_16x16x32_bf16 a[64:67], a[228:231], v[80:83], a[64:67]
    v_exp_f32 v27, v27
    v_mfma_f32_16x16x32_bf16 a[64:67], a[224:227], v[56:59], a[64:67]
    v_exp_f32 v32, v32
    v_mfma_f32_16x16x32_bf16 a[32:35], a[224:227], v[52:55], a[32:35]
    v_exp_f32 v33, v33
    v_mfma_f32_16x16x32_bf16 a[32:35], a[228:231], v[76:79], a[32:35]
    v_exp_f32 v34, v34
    v_mfma_f32_16x16x32_bf16 a[0:3], a[228:231], v[72:75], a[0:3]
    v_exp_f32 v35, v35
    v_mfma_f32_16x16x32_bf16 a[0:3], a[224:227], v[48:51], a[0:3]
    ds_read_b64_tr_b16 a[224:225], v149 offset:32
    ds_read_b64_tr_b16 a[226:227], v149 offset:4128
    v_mfma_f32_16x16x32_bf16 a[4:7], a[232:235], v[48:51], a[4:7]
    ds_read_b64_tr_b16 a[228:229], v149 offset:8224
    ds_read_b64_tr_b16 a[230:231], v149 offset:12320
    v_mfma_f32_16x16x32_bf16 a[4:7], a[236:239], v[72:75], a[4:7]
    v_exp_f32 v40, v40
    v_mfma_f32_16x16x32_bf16 a[36:39], a[236:239], v[76:79], a[36:39]
    v_exp_f32 v41, v41
    v_mfma_f32_16x16x32_bf16 a[36:39], a[232:235], v[52:55], a[36:39]
    v_exp_f32 v42, v42
    v_mfma_f32_16x16x32_bf16 a[68:71], a[232:235], v[56:59], a[68:71]
    v_exp_f32 v43, v43
    v_mfma_f32_16x16x32_bf16 a[68:71], a[236:239], v[80:83], a[68:71]
    v_exp_f32 v44, v44
    v_mfma_f32_16x16x32_bf16 a[100:103], a[236:239], v[84:87], a[100:103]
    v_exp_f32 v45, v45
    v_mfma_f32_16x16x32_bf16 a[100:103], a[232:235], v[60:63], a[100:103]
    v_exp_f32 v46, v46
    v_mfma_f32_16x16x32_bf16 a[132:135], a[232:235], v[64:67], a[132:135]
    s_add_u32 m0, s32, 65536
    v_mfma_f32_16x16x32_bf16 a[132:135], a[236:239], v[88:91], a[132:135]
    v_exp_f32 v47, v47
    v_mfma_f32_16x16x32_bf16 a[164:167], a[236:239], v[92:95], a[164:167]
    v_exp_f32 v36, v36
    v_mfma_f32_16x16x32_bf16 a[164:167], a[232:235], v[68:71], a[164:167]
    ds_read_b64_tr_b16 a[232:233], v150
    ds_read_b64_tr_b16 a[234:235], v150 offset:4096
    v_mfma_f32_16x16x32_bf16 a[168:171], a[240:243], v[68:71], a[168:171]
    ds_read_b64_tr_b16 a[236:237], v150 offset:8192
    ds_read_b64_tr_b16 a[238:239], v150 offset:12288
    v_mfma_f32_16x16x32_bf16 a[168:171], a[244:247], v[92:95], a[168:171]
    v_exp_f32 v37, v37
    v_mfma_f32_16x16x32_bf16 a[136:139], a[244:247], v[88:91], a[136:139]
    v_exp_f32 v38, v38
    v_mfma_f32_16x16x32_bf16 a[136:139], a[240:243], v[64:67], a[136:139]
    v_exp_f32 v39, v39
    v_mfma_f32_16x16x32_bf16 a[104:107], a[240:243], v[60:63], a[104:107]
    v_exp_f32 v28, v28
    v_mfma_f32_16x16x32_bf16 a[104:107], a[244:247], v[84:87], a[104:107]
    v_exp_f32 v29, v29
    v_mfma_f32_16x16x32_bf16 a[72:75], a[244:247], v[80:83], a[72:75]
    v_exp_f32 v30, v30
    v_mfma_f32_16x16x32_bf16 a[72:75], a[240:243], v[56:59], a[72:75]
    v_exp_f32 v31, v31
    v_mfma_f32_16x16x32_bf16 a[40:43], a[240:243], v[52:55], a[40:43]
    buffer_load_dwordx4 v154, s[20:23], s31 offen nt lds
    v_mfma_f32_16x16x32_bf16 a[40:43], a[244:247], v[76:79], a[40:43]
    v_exp_f32 v20, v20
    v_mfma_f32_16x16x32_bf16 a[8:11], a[244:247], v[72:75], a[8:11]
    buffer_load_dwordx4 v154, s[20:23], s31 offen offset:1024 nt lds
    v_mfma_f32_16x16x32_bf16 a[8:11], a[240:243], v[48:51], a[8:11]
    ds_read_b64_tr_b16 a[240:241], v150 offset:32
    ds_read_b64_tr_b16 a[242:243], v150 offset:4128
    s_waitcnt lgkmcnt(2)
    v_mfma_f32_16x16x32_bf16 a[12:15], a[224:227], v[48:51], a[12:15]
    buffer_load_dwordx4 v154, s[20:23], s31 offen offset:2048 nt lds
    v_mfma_f32_16x16x32_bf16 a[12:15], a[228:231], v[72:75], a[12:15]
    ds_read_b64_tr_b16 a[244:245], v150 offset:8224
    ds_read_b64_tr_b16 a[246:247], v150 offset:12320
    v_mfma_f32_16x16x32_bf16 a[44:47], a[228:231], v[76:79], a[44:47]
    buffer_load_dwordx4 v154, s[20:23], s31 offen offset:3072 nt lds
    v_mfma_f32_16x16x32_bf16 a[44:47], a[224:227], v[52:55], a[44:47]
    s_add_u32 s31, s31, 8192
    v_mfma_f32_16x16x32_bf16 a[76:79], a[224:227], v[56:59], a[76:79]
    v_exp_f32 v21, v21
    v_mfma_f32_16x16x32_bf16 a[76:79], a[228:231], v[80:83], a[76:79]
    v_exp_f32 v22, v22
    v_mfma_f32_16x16x32_bf16 a[108:111], a[228:231], v[84:87], a[108:111]
    v_exp_f32 v23, v23
    v_mfma_f32_16x16x32_bf16 a[108:111], a[224:227], v[60:63], a[108:111]
    v_exp_f32 v12, v12
    v_mfma_f32_16x16x32_bf16 a[140:143], a[224:227], v[64:67], a[140:143]
    v_exp_f32 v13, v13
    v_mfma_f32_16x16x32_bf16 a[140:143], a[228:231], v[88:91], a[140:143]
    v_exp_f32 v14, v14
    v_mfma_f32_16x16x32_bf16 a[172:175], a[228:231], v[92:95], a[172:175]
    v_exp_f32 v15, v15
    v_mfma_f32_16x16x32_bf16 a[172:175], a[224:227], v[68:71], a[172:175]
    ds_read_b64_tr_b16 a[224:225], v151
    ds_read_b64_tr_b16 a[226:227], v151 offset:4096
    v_mfma_f32_16x16x32_bf16 a[176:179], a[232:235], v[68:71], a[176:179]
    ds_read_b64_tr_b16 a[228:229], v151 offset:8192
    ds_read_b64_tr_b16 a[230:231], v151 offset:12288
    v_mfma_f32_16x16x32_bf16 a[176:179], a[236:239], v[92:95], a[176:179]
    s_waitcnt vmcnt(8)
    s_barrier
    v_mfma_f32_16x16x32_bf16 a[144:147], a[236:239], v[88:91], a[144:147]
    v_exp_f32 v4, v4
    v_mfma_f32_16x16x32_bf16 a[144:147], a[232:235], v[64:67], a[144:147]
    v_exp_f32 v5, v5
    v_mfma_f32_16x16x32_bf16 a[112:115], a[232:235], v[60:63], a[112:115]
    ds_read_b128 a[192:195], v144 offset:24576
    ds_read_b128 a[196:199], v145 offset:24576
    v_mfma_f32_16x16x32_bf16 a[112:115], a[236:239], v[84:87], a[112:115]
    ds_read_b128 a[200:203], v146 offset:24576
    ds_read_b128 a[204:207], v147 offset:24576
    v_mfma_f32_16x16x32_bf16 a[80:83], a[236:239], v[80:83], a[80:83]
    ds_read_b128 a[208:211], v144 offset:28672
    ds_read_b128 a[212:215], v145 offset:28672
    v_mfma_f32_16x16x32_bf16 a[80:83], a[232:235], v[56:59], a[80:83]
    ds_read_b128 a[216:219], v146 offset:28672
    s_waitcnt lgkmcnt(7)
    ds_read_b128 a[220:223], v147 offset:28672
    v_mfma_f32_16x16x32_bf16 a[48:51], a[232:235], v[52:55], a[48:51]
    v_exp_f32 v6, v6
    v_mfma_f32_16x16x32_bf16 a[48:51], a[236:239], v[76:79], a[48:51]
    v_exp_f32 v7, v7
    v_mfma_f32_16x16x32_bf16 a[16:19], a[236:239], v[72:75], a[16:19]
    v_mfma_f32_16x16x32_bf16 a[16:19], a[232:235], v[48:51], a[16:19]
    ds_read_b64_tr_b16 a[232:233], v151 offset:32
    ds_read_b64_tr_b16 a[234:235], v151 offset:4128
    v_mfma_f32_16x16x32_bf16 a[20:23], a[240:243], v[48:51], a[20:23]
    ds_read_b64_tr_b16 a[236:237], v151 offset:8224
    ds_read_b64_tr_b16 a[238:239], v151 offset:12320
    v_mfma_f32_16x16x32_bf16 a[20:23], a[244:247], v[72:75], a[20:23]
    v_mfma_f32_16x16x32_bf16 a[52:55], a[244:247], v[76:79], a[52:55]
    v_mfma_f32_16x16x32_bf16 a[52:55], a[240:243], v[52:55], a[52:55]
    v_mfma_f32_16x16x32_bf16 a[84:87], a[240:243], v[56:59], a[84:87]
    v_mfma_f32_16x16x32_bf16 a[84:87], a[244:247], v[80:83], a[84:87]
    v_mfma_f32_16x16x32_bf16 a[116:119], a[244:247], v[84:87], a[116:119]
    v_mfma_f32_16x16x32_bf16 a[116:119], a[240:243], v[60:63], a[116:119]
    v_mfma_f32_16x16x32_bf16 a[148:151], a[240:243], v[64:67], a[148:151]
    v_mfma_f32_16x16x32_bf16 a[148:151], a[244:247], v[88:91], a[148:151]
    v_mfma_f32_16x16x32_bf16 a[180:183], a[244:247], v[92:95], a[180:183]
    v_mfma_f32_16x16x32_bf16 a[180:183], a[240:243], v[68:71], a[180:183]
    v_mfma_f32_16x16x32_bf16 a[184:187], a[224:227], v[68:71], a[184:187]
    v_mfma_f32_16x16x32_bf16 a[184:187], a[228:231], v[92:95], a[184:187]
    v_mfma_f32_16x16x32_bf16 a[152:155], a[228:231], v[88:91], a[152:155]
    v_mfma_f32_16x16x32_bf16 a[152:155], a[224:227], v[64:67], a[152:155]
    v_mfma_f32_16x16x32_bf16 a[120:123], a[224:227], v[60:63], a[120:123]
    v_mfma_f32_16x16x32_bf16 a[120:123], a[228:231], v[84:87], a[120:123]
    v_mfma_f32_16x16x32_bf16 a[88:91], a[228:231], v[80:83], a[88:91]
    v_mfma_f32_16x16x32_bf16 a[88:91], a[224:227], v[56:59], a[88:91]
    v_mfma_f32_16x16x32_bf16 a[56:59], a[224:227], v[52:55], a[56:59]
    v_mfma_f32_16x16x32_bf16 a[56:59], a[228:231], v[76:79], a[56:59]
    v_mfma_f32_16x16x32_bf16 a[24:27], a[228:231], v[72:75], a[24:27]
    v_mfma_f32_16x16x32_bf16 a[24:27], a[224:227], v[48:51], a[24:27]
    s_waitcnt lgkmcnt(0)
    v_mfma_f32_16x16x32_bf16 a[28:31], a[232:235], v[48:51], a[28:31]
    v_mfma_f32_16x16x32_bf16 a[28:31], a[236:239], v[72:75], a[28:31]
    v_cvt_pk_bf16_f32 v48, v0, v1
    v_cvt_pk_bf16_f32 v49, v2, v3
    v_mfma_f32_16x16x32_bf16 a[60:63], a[236:239], v[76:79], a[60:63]
    v_mfma_f32_16x16x32_bf16 a[60:63], a[232:235], v[52:55], a[60:63]
    v_cvt_pk_bf16_f32 v52, v8, v9
    v_cvt_pk_bf16_f32 v53, v10, v11
    v_mfma_f32_16x16x32_bf16 a[92:95], a[232:235], v[56:59], a[92:95]
    v_mfma_f32_16x16x32_bf16 a[92:95], a[236:239], v[80:83], a[92:95]
    v_cvt_pk_bf16_f32 v56, v16, v17
    v_cvt_pk_bf16_f32 v57, v18, v19
    v_mfma_f32_16x16x32_bf16 a[124:127], a[236:239], v[84:87], a[124:127]
    v_mfma_f32_16x16x32_bf16 a[124:127], a[232:235], v[60:63], a[124:127]
    v_cvt_pk_bf16_f32 v60, v24, v25
    v_cvt_pk_bf16_f32 v61, v26, v27
    v_mfma_f32_16x16x32_bf16 a[156:159], a[232:235], v[64:67], a[156:159]
    v_mfma_f32_16x16x32_bf16 a[156:159], a[236:239], v[88:91], a[156:159]
    v_cvt_pk_bf16_f32 v64, v32, v33
    v_cvt_pk_bf16_f32 v65, v34, v35
    v_mfma_f32_16x16x32_bf16 a[188:191], a[236:239], v[92:95], a[188:191]
    v_mfma_f32_16x16x32_bf16 a[188:191], a[232:235], v[68:71], a[188:191]
    v_cvt_pk_bf16_f32 v68, v40, v41
    v_cvt_pk_bf16_f32 v69, v42, v43
    v_mfma_f32_16x16x32_bf16 v[0:3], a[192:195], v[160:163], v[96:99]
    v_cvt_pk_bf16_f32 v70, v44, v45
    v_cvt_pk_bf16_f32 v71, v46, v47
    v_mfma_f32_16x16x32_bf16 v[0:3], a[196:199], v[164:167], v[0:3]
    v_cvt_pk_bf16_f32 v66, v36, v37
    v_cvt_pk_bf16_f32 v67, v38, v39
    v_mfma_f32_16x16x32_bf16 v[0:3], a[200:203], v[168:171], v[0:3]
    v_cvt_pk_bf16_f32 v62, v28, v29
    v_cvt_pk_bf16_f32 v63, v30, v31
    v_mfma_f32_16x16x32_bf16 v[0:3], a[204:207], v[172:175], v[0:3]
    v_cvt_pk_bf16_f32 v58, v20, v21
    v_cvt_pk_bf16_f32 v59, v22, v23
    v_mfma_f32_16x16x32_bf16 v[8:11], a[204:207], v[188:191], v[100:103]
    v_cvt_pk_bf16_f32 v54, v12, v13
    v_cvt_pk_bf16_f32 v55, v14, v15
    v_mfma_f32_16x16x32_bf16 v[8:11], a[200:203], v[184:187], v[8:11]
    v_cvt_pk_bf16_f32 v50, v4, v5
    v_cvt_pk_bf16_f32 v51, v6, v7
    v_mfma_f32_16x16x32_bf16 v[8:11], a[196:199], v[180:183], v[8:11]
    v_mfma_f32_16x16x32_bf16 v[8:11], a[192:195], v[176:179], v[8:11]
    v_mfma_f32_16x16x32_bf16 v[16:19], a[192:195], v[192:195], v[104:107]
    v_mfma_f32_16x16x32_bf16 v[16:19], a[196:199], v[196:199], v[16:19]
    v_mfma_f32_16x16x32_bf16 v[16:19], a[200:203], v[200:203], v[16:19]
    v_mfma_f32_16x16x32_bf16 v[16:19], a[204:207], v[204:207], v[16:19]
    v_exp_f32 v0, v0
    v_mfma_f32_16x16x32_bf16 v[24:27], a[204:207], v[220:223], v[108:111]
    v_exp_f32 v1, v1
    v_mfma_f32_16x16x32_bf16 v[24:27], a[200:203], v[216:219], v[24:27]
    v_exp_f32 v2, v2
    v_mfma_f32_16x16x32_bf16 v[24:27], a[196:199], v[212:215], v[24:27]
    v_cvt_pk_bf16_f32 v72, v0, v1
    v_mfma_f32_16x16x32_bf16 v[24:27], a[192:195], v[208:211], v[24:27]
    v_exp_f32 v8, v8
    v_mfma_f32_16x16x32_bf16 v[32:35], a[192:195], v[224:227], v[112:115]
    v_exp_f32 v9, v9
    v_mfma_f32_16x16x32_bf16 v[32:35], a[196:199], v[228:231], v[32:35]
    v_exp_f32 v10, v10
    v_mfma_f32_16x16x32_bf16 v[32:35], a[200:203], v[232:235], v[32:35]
    v_cvt_pk_bf16_f32 v76, v8, v9
    v_mfma_f32_16x16x32_bf16 v[32:35], a[204:207], v[236:239], v[32:35]
    v_exp_f32 v16, v16
    v_mfma_f32_16x16x32_bf16 v[40:43], a[204:207], v[252:255], v[116:119]
    v_exp_f32 v17, v17
    v_mfma_f32_16x16x32_bf16 v[40:43], a[200:203], v[248:251], v[40:43]
    v_exp_f32 v18, v18
    v_mfma_f32_16x16x32_bf16 v[40:43], a[196:199], v[244:247], v[40:43]
    v_cvt_pk_bf16_f32 v80, v16, v17
    v_mfma_f32_16x16x32_bf16 v[40:43], a[192:195], v[240:243], v[40:43]
    v_exp_f32 v24, v24
    v_mfma_f32_16x16x32_bf16 v[44:47], a[208:211], v[240:243], v[116:119]
    v_exp_f32 v25, v25
    v_mfma_f32_16x16x32_bf16 v[44:47], a[212:215], v[244:247], v[44:47]
    v_exp_f32 v26, v26
    v_mfma_f32_16x16x32_bf16 v[44:47], a[216:219], v[248:251], v[44:47]
    v_cvt_pk_bf16_f32 v84, v24, v25
    v_mfma_f32_16x16x32_bf16 v[44:47], a[220:223], v[252:255], v[44:47]
    v_exp_f32 v32, v32
    v_mfma_f32_16x16x32_bf16 v[36:39], a[220:223], v[236:239], v[112:115]
    v_exp_f32 v33, v33
    v_mfma_f32_16x16x32_bf16 v[36:39], a[216:219], v[232:235], v[36:39]
    s_waitcnt vmcnt(4)
    s_barrier
    v_mfma_f32_16x16x32_bf16 v[36:39], a[212:215], v[228:231], v[36:39]
    ds_read_b64_tr_b16 a[192:193], v148 offset:16384
    ds_read_b64_tr_b16 a[194:195], v148 offset:20480
    v_mfma_f32_16x16x32_bf16 v[36:39], a[208:211], v[224:227], v[36:39]
    ds_read_b64_tr_b16 a[196:197], v148 offset:16416
    ds_read_b64_tr_b16 a[198:199], v148 offset:20512
    v_mfma_f32_16x16x32_bf16 v[28:31], a[208:211], v[208:211], v[108:111]
    ds_read_b64_tr_b16 a[200:201], v149 offset:16384
    ds_read_b64_tr_b16 a[202:203], v149 offset:20480
    v_mfma_f32_16x16x32_bf16 v[28:31], a[212:215], v[212:215], v[28:31]
    ds_read_b64_tr_b16 a[204:205], v149 offset:16416
    ds_read_b64_tr_b16 a[206:207], v149 offset:20512
    v_mfma_f32_16x16x32_bf16 v[28:31], a[216:219], v[216:219], v[28:31]
    v_exp_f32 v40, v40
    v_mfma_f32_16x16x32_bf16 v[28:31], a[220:223], v[220:223], v[28:31]
    v_exp_f32 v44, v44
    v_mfma_f32_16x16x32_bf16 v[20:23], a[220:223], v[204:207], v[104:107]
    v_exp_f32 v45, v45
    v_mfma_f32_16x16x32_bf16 v[20:23], a[216:219], v[200:203], v[20:23]
    v_exp_f32 v46, v46
    v_mfma_f32_16x16x32_bf16 v[20:23], a[212:215], v[196:199], v[20:23]
    v_cvt_pk_bf16_f32 v94, v44, v45
    v_mfma_f32_16x16x32_bf16 v[20:23], a[208:211], v[192:195], v[20:23]
    v_exp_f32 v36, v36
    v_mfma_f32_16x16x32_bf16 v[12:15], a[208:211], v[176:179], v[100:103]
    v_exp_f32 v37, v37
    v_mfma_f32_16x16x32_bf16 v[12:15], a[212:215], v[180:183], v[12:15]
    v_exp_f32 v38, v38
    v_mfma_f32_16x16x32_bf16 v[12:15], a[216:219], v[184:187], v[12:15]
    v_cvt_pk_bf16_f32 v90, v36, v37
    v_mfma_f32_16x16x32_bf16 v[12:15], a[220:223], v[188:191], v[12:15]
    v_exp_f32 v28, v28
    v_mfma_f32_16x16x32_bf16 v[4:7], a[220:223], v[172:175], v[96:99]
    v_exp_f32 v29, v29
    v_mfma_f32_16x16x32_bf16 v[4:7], a[216:219], v[168:171], v[4:7]
    v_exp_f32 v30, v30
    v_mfma_f32_16x16x32_bf16 v[4:7], a[212:215], v[164:167], v[4:7]
    v_cvt_pk_bf16_f32 v86, v28, v29
    v_mfma_f32_16x16x32_bf16 v[4:7], a[208:211], v[160:163], v[4:7]
    ds_read_b64_tr_b16 a[208:209], v150 offset:16384
    ds_read_b64_tr_b16 a[210:211], v150 offset:20480
    v_mfma_f32_16x16x32_bf16 v[120:123], a[248:251], v[48:51], v[120:123]
    v_mbcnt_lo_u32_b32 v96, -1, 0
    v_mbcnt_hi_u32_b32 v96, -1, v96
    v_mfma_f32_16x16x32_bf16 v[124:127], a[248:251], v[52:55], v[124:127]
    s_add_u32 s35, s32, 8192
    v_and_b32 v97, 15, v96
    v_mfma_f32_16x16x32_bf16 v[128:131], a[248:251], v[56:59], v[128:131]
    v_lshrrev_b32 v98, 4, v96
    v_and_b32 v99, 7, v97
    v_mfma_f32_16x16x32_bf16 v[132:135], a[248:251], v[60:63], v[132:135]
    v_exp_f32 v12, v12
    v_mfma_f32_16x16x32_bf16 v[136:139], a[248:251], v[64:67], v[136:139]
    v_exp_f32 v13, v13
    v_mfma_f32_16x16x32_bf16 v[140:143], a[248:251], v[68:71], v[140:143]
    v_exp_f32 v14, v14
    s_waitcnt lgkmcnt(2)
    v_mfma_f32_16x16x32_bf16 a[160:163], a[192:195], v[68:71], a[160:163]
    v_cvt_pk_bf16_f32 v78, v12, v13
    ds_read_b64_tr_b16 a[212:213], v150 offset:16416
    v_mfma_f32_16x16x32_bf16 a[128:131], a[192:195], v[64:67], a[128:131]
    v_exp_f32 v4, v4
    v_mfma_f32_16x16x32_bf16 a[96:99], a[192:195], v[60:63], a[96:99]
    v_exp_f32 v5, v5
    v_mfma_f32_16x16x32_bf16 a[64:67], a[192:195], v[56:59], a[64:67]
    v_exp_f32 v6, v6
    v_mfma_f32_16x16x32_bf16 a[32:35], a[192:195], v[52:55], a[32:35]
    v_cvt_pk_bf16_f32 v74, v4, v5
    ds_read_b64_tr_b16 a[214:215], v150 offset:20512
    v_mfma_f32_16x16x32_bf16 a[0:3], a[192:195], v[48:51], a[0:3]
    v_exp_f32 v7, v7
    v_mfma_f32_16x16x32_bf16 a[4:7], a[196:199], v[48:51], a[4:7]
    v_cvt_pk_bf16_f32 v75, v6, v7
    ds_read_b64_tr_b16 a[216:217], v151 offset:16384
    v_mfma_f32_16x16x32_bf16 a[36:39], a[196:199], v[52:55], a[36:39]
    ds_read_b64_tr_b16 a[218:219], v151 offset:20480
    ds_read_b64_tr_b16 a[220:221], v151 offset:16416
    v_mfma_f32_16x16x32_bf16 a[68:71], a[196:199], v[56:59], a[68:71]
    ds_read_b64_tr_b16 a[222:223], v151 offset:20512
    v_lshrrev_b32 v100, 1, v98
    v_mfma_f32_16x16x32_bf16 a[100:103], a[196:199], v[60:63], a[100:103]
    v_exp_f32 v15, v15
    v_mfma_f32_16x16x32_bf16 a[132:135], a[196:199], v[64:67], a[132:135]
    v_cvt_pk_bf16_f32 v79, v14, v15
    v_xor_b32 v99, v99, v100
    v_mfma_f32_16x16x32_bf16 a[164:167], a[196:199], v[68:71], a[164:167]
    v_exp_f32 v20, v20
    v_mfma_f32_16x16x32_bf16 a[168:171], a[200:203], v[68:71], a[168:171]
    v_exp_f32 v21, v21
    v_mfma_f32_16x16x32_bf16 a[136:139], a[200:203], v[64:67], a[136:139]
    v_exp_f32 v22, v22
    v_mfma_f32_16x16x32_bf16 a[104:107], a[200:203], v[60:63], a[104:107]
    v_cvt_pk_bf16_f32 v82, v20, v21
    v_lshlrev_b32 v100, 8, v97
    v_mfma_f32_16x16x32_bf16 a[72:75], a[200:203], v[56:59], a[72:75]
    v_exp_f32 v23, v23
    v_mfma_f32_16x16x32_bf16 a[40:43], a[200:203], v[52:55], a[40:43]
    v_cvt_pk_bf16_f32 v83, v22, v23
    v_lshl_add_u32 v99, v99, 4, v100
    v_mfma_f32_16x16x32_bf16 a[8:11], a[200:203], v[48:51], a[8:11]
    v_exp_f32 v31, v31
    v_mfma_f32_16x16x32_bf16 a[12:15], a[204:207], v[48:51], a[12:15]
    v_cvt_pk_bf16_f32 v87, v30, v31
    v_and_b32 v100, 1, v98
    v_mfma_f32_16x16x32_bf16 a[44:47], a[204:207], v[52:55], a[44:47]
    v_exp_f32 v39, v39
    v_mfma_f32_16x16x32_bf16 a[76:79], a[204:207], v[56:59], a[76:79]
    v_cvt_pk_bf16_f32 v91, v38, v39
    v_lshl_add_u32 v99, v100, 3, v99
    v_mfma_f32_16x16x32_bf16 a[108:111], a[204:207], v[60:63], a[108:111]
    v_exp_f32 v47, v47
    v_mfma_f32_16x16x32_bf16 a[140:143], a[204:207], v[64:67], a[140:143]
    v_cvt_pk_bf16_f32 v95, v46, v47
    v_add_u32 v104, s35, v99
    v_mfma_f32_16x16x32_bf16 a[172:175], a[204:207], v[68:71], a[172:175]
    v_exp_f32 v41, v41
    s_waitcnt lgkmcnt(0)
    v_mfma_f32_16x16x32_bf16 a[176:179], a[208:211], v[68:71], a[176:179]
    v_exp_f32 v42, v42
    v_mfma_f32_16x16x32_bf16 a[144:147], a[208:211], v[64:67], a[144:147]
    v_cvt_pk_bf16_f32 v92, v40, v41
    v_xor_b32 v105, 32, v104
    v_mfma_f32_16x16x32_bf16 a[112:115], a[208:211], v[60:63], a[112:115]
    v_exp_f32 v43, v43
    v_mfma_f32_16x16x32_bf16 a[80:83], a[208:211], v[56:59], a[80:83]
    v_cvt_pk_bf16_f32 v93, v42, v43
    v_xor_b32 v106, 64, v104
    v_mfma_f32_16x16x32_bf16 a[48:51], a[208:211], v[52:55], a[48:51]
    v_exp_f32 v34, v34
    v_mfma_f32_16x16x32_bf16 a[16:19], a[208:211], v[48:51], a[16:19]
    v_cvt_pk_bf16_f32 v88, v32, v33
    v_xor_b32 v107, 96, v104
    v_exp_f32 v35, v35
    v_mfma_f32_16x16x32_bf16 a[20:23], a[212:215], v[48:51], a[20:23]
    v_cvt_pk_bf16_f32 v89, v34, v35
    v_xor_b32 v99, v97, v98
    v_mfma_f32_16x16x32_bf16 a[52:55], a[212:215], v[52:55], a[52:55]
    v_exp_f32 v27, v27
    v_mfma_f32_16x16x32_bf16 a[84:87], a[212:215], v[56:59], a[84:87]
    v_cvt_pk_bf16_f32 v85, v26, v27
    v_lshlrev_b32 v100, 8, v98
    v_exp_f32 v19, v19
    v_mfma_f32_16x16x32_bf16 a[116:119], a[212:215], v[60:63], a[116:119]
    s_waitcnt vmcnt(0)
    s_barrier
    v_mfma_f32_16x16x32_bf16 a[148:151], a[212:215], v[64:67], a[148:151]
    v_cvt_pk_bf16_f32 v81, v18, v19
    ds_read_b64_tr_b16 v[224:225], v148 offset:24576
    v_mfma_f32_16x16x32_bf16 a[180:183], a[212:215], v[68:71], a[180:183]
    v_exp_f32 v11, v11
    v_mfma_f32_16x16x32_bf16 a[184:187], a[216:219], v[68:71], a[184:187]
    ds_read_b64_tr_b16 v[226:227], v148 offset:28672
    ds_read_b64_tr_b16 v[228:229], v148 offset:24608
    v_mfma_f32_16x16x32_bf16 a[152:155], a[216:219], v[64:67], a[152:155]
    ds_read_b64_tr_b16 v[230:231], v148 offset:28704
    ds_read_b64_tr_b16 v[232:233], v149 offset:24576
    v_mfma_f32_16x16x32_bf16 a[120:123], a[216:219], v[60:63], a[120:123]
    ds_read_b64_tr_b16 v[234:235], v149 offset:28672
    ds_read_b64_tr_b16 v[236:237], v149 offset:24608
    v_mfma_f32_16x16x32_bf16 a[88:91], a[216:219], v[56:59], a[88:91]
    ds_read_b64_tr_b16 v[238:239], v149 offset:28704
    ds_read_b64_tr_b16 v[240:241], v150 offset:24576
    v_mfma_f32_16x16x32_bf16 a[56:59], a[216:219], v[52:55], a[56:59]
    ds_read_b64_tr_b16 v[242:243], v150 offset:28672
    ds_read_b64_tr_b16 v[244:245], v150 offset:24608
    v_mfma_f32_16x16x32_bf16 a[24:27], a[216:219], v[48:51], a[24:27]
    ds_read_b64_tr_b16 v[246:247], v150 offset:28704
    ds_read_b64_tr_b16 v[248:249], v151 offset:24576
    v_mfma_f32_16x16x32_bf16 a[28:31], a[220:223], v[48:51], a[28:31]
    ds_read_b64_tr_b16 v[250:251], v151 offset:28672
    ds_read_b64_tr_b16 v[252:253], v151 offset:24608
    v_mfma_f32_16x16x32_bf16 a[60:63], a[220:223], v[52:55], a[60:63]
    s_waitcnt lgkmcnt(12)
    ds_read_b64_tr_b16 v[254:255], v151 offset:28704
    v_cvt_pk_bf16_f32 v77, v10, v11
    v_mfma_f32_16x16x32_bf16 a[92:95], a[220:223], v[56:59], a[92:95]
    v_exp_f32 v3, v3
    v_mfma_f32_16x16x32_bf16 a[124:127], a[220:223], v[60:63], a[124:127]
    v_cvt_pk_bf16_f32 v73, v2, v3
    v_lshl_add_u32 v99, v99, 4, v100
    v_mfma_f32_16x16x32_bf16 a[156:159], a[220:223], v[64:67], a[156:159]
    v_add_u32 v108, s35, v99
    v_xor_b32 v109, 64, v108
    v_mfma_f32_16x16x32_bf16 a[188:191], a[220:223], v[68:71], a[188:191]
    v_lshlrev_b32 v99, 4, v96
    v_add_u32 v110, s34, v99
    v_mfma_f32_16x16x32_bf16 v[140:143], a[248:251], v[92:95], v[140:143]
    v_mfma_f32_16x16x32_bf16 a[160:163], v[224:227], v[92:95], a[160:163]
    s_waitcnt lgkmcnt(1)
    v_mfma_f32_16x16x32_bf16 a[164:167], v[228:231], v[92:95], a[164:167]
    v_mfma_f32_16x16x32_bf16 a[168:171], v[232:235], v[92:95], a[168:171]
    v_mfma_f32_16x16x32_bf16 a[172:175], v[236:239], v[92:95], a[172:175]
    v_mfma_f32_16x16x32_bf16 a[176:179], v[240:243], v[92:95], a[176:179]
    v_mfma_f32_16x16x32_bf16 a[180:183], v[244:247], v[92:95], a[180:183]
    v_mfma_f32_16x16x32_bf16 a[184:187], v[248:251], v[92:95], a[184:187]
    s_waitcnt lgkmcnt(0)
    v_mfma_f32_16x16x32_bf16 a[188:191], v[252:255], v[92:95], a[188:191]
    v_mfma_f32_16x16x32_bf16 a[0:3], v[224:227], v[72:75], a[0:3]
    v_mfma_f32_16x16x32_bf16 a[32:35], v[224:227], v[76:79], a[32:35]
    v_mfma_f32_16x16x32_bf16 a[64:67], v[224:227], v[80:83], a[64:67]
    v_mfma_f32_16x16x32_bf16 a[96:99], v[224:227], v[84:87], a[96:99]
    v_mfma_f32_16x16x32_bf16 a[128:131], v[224:227], v[88:91], a[128:131]
    v_mfma_f32_16x16x32_bf16 a[132:135], v[228:231], v[88:91], a[132:135]
    v_mfma_f32_16x16x32_bf16 a[100:103], v[228:231], v[84:87], a[100:103]
    v_mfma_f32_16x16x32_bf16 a[68:71], v[228:231], v[80:83], a[68:71]
    v_rcp_f32 v142, v140
    v_mfma_f32_16x16x32_bf16 a[36:39], v[228:231], v[76:79], a[36:39]
    v_accvgpr_read_b32 v160, a160
    v_accvgpr_read_b32 v161, a161
    v_mfma_f32_16x16x32_bf16 a[4:7], v[228:231], v[72:75], a[4:7]
    v_accvgpr_read_b32 v162, a162
    v_accvgpr_read_b32 v163, a163
    v_mfma_f32_16x16x32_bf16 a[8:11], v[232:235], v[72:75], a[8:11]
    v_accvgpr_read_b32 v164, a164
    v_accvgpr_read_b32 v165, a165
    v_mfma_f32_16x16x32_bf16 a[40:43], v[232:235], v[76:79], a[40:43]
    v_accvgpr_read_b32 v166, a166
    v_accvgpr_read_b32 v167, a167
    v_mfma_f32_16x16x32_bf16 a[72:75], v[232:235], v[80:83], a[72:75]
    v_pk_mul_f32 v[160:161], v[160:161], v[142:143] op_sel_hi:[1,0]
    v_pk_mul_f32 v[162:163], v[162:163], v[142:143] op_sel_hi:[1,0]
    v_mfma_f32_16x16x32_bf16 a[104:107], v[232:235], v[84:87], a[104:107]
    v_pk_mul_f32 v[164:165], v[164:165], v[142:143] op_sel_hi:[1,0]
    v_pk_mul_f32 v[166:167], v[166:167], v[142:143] op_sel_hi:[1,0]
    v_mfma_f32_16x16x32_bf16 a[136:139], v[232:235], v[88:91], a[136:139]
    v_cvt_pk_bf16_f32 v176, v160, v161
    v_cvt_pk_bf16_f32 v177, v162, v163
    v_mfma_f32_16x16x32_bf16 a[140:143], v[236:239], v[88:91], a[140:143]
    v_cvt_pk_bf16_f32 v178, v164, v165
    v_cvt_pk_bf16_f32 v179, v166, v167
    v_mfma_f32_16x16x32_bf16 a[108:111], v[236:239], v[84:87], a[108:111]
    ds_write_b64 v104, v[176:177]
    ds_write_b64 v105, v[178:179]
    v_mfma_f32_16x16x32_bf16 a[76:79], v[236:239], v[80:83], a[76:79]
    v_accvgpr_read_b32 v168, a168
    v_accvgpr_read_b32 v169, a169
    v_mfma_f32_16x16x32_bf16 a[44:47], v[236:239], v[76:79], a[44:47]
    v_accvgpr_read_b32 v170, a170
    v_accvgpr_read_b32 v171, a171
    v_mfma_f32_16x16x32_bf16 a[12:15], v[236:239], v[72:75], a[12:15]
    v_accvgpr_read_b32 v172, a172
    v_accvgpr_read_b32 v173, a173
    v_mfma_f32_16x16x32_bf16 a[16:19], v[240:243], v[72:75], a[16:19]
    v_accvgpr_read_b32 v174, a174
    v_accvgpr_read_b32 v175, a175
    v_mfma_f32_16x16x32_bf16 a[48:51], v[240:243], v[76:79], a[48:51]
    v_pk_mul_f32 v[168:169], v[168:169], v[142:143] op_sel_hi:[1,0]
    v_pk_mul_f32 v[170:171], v[170:171], v[142:143] op_sel_hi:[1,0]
    v_mfma_f32_16x16x32_bf16 a[80:83], v[240:243], v[80:83], a[80:83]
    v_pk_mul_f32 v[172:173], v[172:173], v[142:143] op_sel_hi:[1,0]
    v_pk_mul_f32 v[174:175], v[174:175], v[142:143] op_sel_hi:[1,0]
    v_mfma_f32_16x16x32_bf16 a[112:115], v[240:243], v[84:87], a[112:115]
    v_cvt_pk_bf16_f32 v180, v168, v169
    v_cvt_pk_bf16_f32 v181, v170, v171
    v_mfma_f32_16x16x32_bf16 a[144:147], v[240:243], v[88:91], a[144:147]
    v_cvt_pk_bf16_f32 v182, v172, v173
    v_cvt_pk_bf16_f32 v183, v174, v175
    v_mfma_f32_16x16x32_bf16 a[148:151], v[244:247], v[88:91], a[148:151]
    ds_write_b64 v106, v[180:181]
    ds_write_b64 v107, v[182:183]
    v_mfma_f32_16x16x32_bf16 a[116:119], v[244:247], v[84:87], a[116:119]
    v_accvgpr_read_b32 v160, a176
    v_accvgpr_read_b32 v161, a177
    v_mfma_f32_16x16x32_bf16 a[84:87], v[244:247], v[80:83], a[84:87]
    v_accvgpr_read_b32 v162, a178
    v_accvgpr_read_b32 v163, a179
    v_mfma_f32_16x16x32_bf16 a[52:55], v[244:247], v[76:79], a[52:55]
    v_accvgpr_read_b32 v164, a180
    v_accvgpr_read_b32 v165, a181
    v_mfma_f32_16x16x32_bf16 a[20:23], v[244:247], v[72:75], a[20:23]
    v_accvgpr_read_b32 v166, a182
    v_accvgpr_read_b32 v167, a183
    v_mfma_f32_16x16x32_bf16 a[24:27], v[248:251], v[72:75], a[24:27]
    v_pk_mul_f32 v[160:161], v[160:161], v[142:143] op_sel_hi:[1,0]
    v_pk_mul_f32 v[162:163], v[162:163], v[142:143] op_sel_hi:[1,0]
    v_mfma_f32_16x16x32_bf16 a[56:59], v[248:251], v[76:79], a[56:59]
    v_pk_mul_f32 v[164:165], v[164:165], v[142:143] op_sel_hi:[1,0]
    v_pk_mul_f32 v[166:167], v[166:167], v[142:143] op_sel_hi:[1,0]
    v_mfma_f32_16x16x32_bf16 a[88:91], v[248:251], v[80:83], a[88:91]
    v_cvt_pk_bf16_f32 v176, v160, v161
    v_cvt_pk_bf16_f32 v177, v162, v163
    v_mfma_f32_16x16x32_bf16 a[120:123], v[248:251], v[84:87], a[120:123]
    v_cvt_pk_bf16_f32 v178, v164, v165
    v_cvt_pk_bf16_f32 v179, v166, v167
    v_mfma_f32_16x16x32_bf16 a[152:155], v[248:251], v[88:91], a[152:155]
    ds_write_b64 v104, v[176:177] offset:128
    ds_write_b64 v105, v[178:179] offset:128
    v_mfma_f32_16x16x32_bf16 a[156:159], v[252:255], v[88:91], a[156:159]
    v_accvgpr_read_b32 v168, a184
    v_accvgpr_read_b32 v169, a185
    v_mfma_f32_16x16x32_bf16 a[124:127], v[252:255], v[84:87], a[124:127]
    v_accvgpr_read_b32 v170, a186
    v_accvgpr_read_b32 v171, a187
    v_mfma_f32_16x16x32_bf16 a[92:95], v[252:255], v[80:83], a[92:95]
    v_accvgpr_read_b32 v172, a188
    v_accvgpr_read_b32 v173, a189
    v_mfma_f32_16x16x32_bf16 a[60:63], v[252:255], v[76:79], a[60:63]
    v_accvgpr_read_b32 v174, a190
    v_accvgpr_read_b32 v175, a191
    v_mfma_f32_16x16x32_bf16 a[28:31], v[252:255], v[72:75], a[28:31]
    v_pk_mul_f32 v[168:169], v[168:169], v[142:143] op_sel_hi:[1,0]
    v_pk_mul_f32 v[170:171], v[170:171], v[142:143] op_sel_hi:[1,0]
    v_mfma_f32_16x16x32_bf16 v[136:139], a[248:251], v[88:91], v[136:139]
    v_pk_mul_f32 v[172:173], v[172:173], v[142:143] op_sel_hi:[1,0]
    v_pk_mul_f32 v[174:175], v[174:175], v[142:143] op_sel_hi:[1,0]
    v_mfma_f32_16x16x32_bf16 v[132:135], a[248:251], v[84:87], v[132:135]
    v_cvt_pk_bf16_f32 v180, v168, v169
    v_cvt_pk_bf16_f32 v181, v170, v171
    v_mfma_f32_16x16x32_bf16 v[128:131], a[248:251], v[80:83], v[128:131]
    v_cvt_pk_bf16_f32 v182, v172, v173
    v_cvt_pk_bf16_f32 v183, v174, v175
    v_mfma_f32_16x16x32_bf16 v[124:127], a[248:251], v[76:79], v[124:127]
    ds_write_b64 v106, v[180:181] offset:128
    ds_write_b64 v107, v[182:183] offset:128
    v_mfma_f32_16x16x32_bf16 v[120:123], a[248:251], v[72:75], v[120:123]
    ds_read_b128 v[184:187], v108
    ds_read_b128 v[188:191], v109 offset:1024
    ds_read_b128 v[192:195], v108 offset:2048
    ds_read_b128 v[196:199], v109 offset:3072
    s_nop 5
    v_rcp_f32 v138, v136
    v_accvgpr_read_b32 v160, a128
    v_accvgpr_read_b32 v161, a129
    v_accvgpr_read_b32 v162, a130
    v_accvgpr_read_b32 v163, a131
    v_accvgpr_read_b32 v164, a132
    v_accvgpr_read_b32 v165, a133
    v_accvgpr_read_b32 v166, a134
    v_accvgpr_read_b32 v167, a135
    v_pk_mul_f32 v[160:161], v[160:161], v[138:139] op_sel_hi:[1,0]
    v_pk_mul_f32 v[162:163], v[162:163], v[138:139] op_sel_hi:[1,0]
    v_pk_mul_f32 v[164:165], v[164:165], v[138:139] op_sel_hi:[1,0]
    v_pk_mul_f32 v[166:167], v[166:167], v[138:139] op_sel_hi:[1,0]
    v_cvt_pk_bf16_f32 v176, v160, v161
    v_cvt_pk_bf16_f32 v177, v162, v163
    v_cvt_pk_bf16_f32 v178, v164, v165
    v_cvt_pk_bf16_f32 v179, v166, v167
    ds_write_b64 v104, v[176:177] offset:8192
    ds_write_b64 v105, v[178:179] offset:8192
    s_mov_b32 s36, 20480
    s_waitcnt lgkmcnt(2)
    buffer_store_dwordx4 v[184:187], v110, s[24:27], s36 offen nt
    buffer_store_dwordx4 v[188:191], v110, s[24:27], s36 offen offset:1024 nt
    buffer_store_dwordx4 v[192:195], v110, s[24:27], s36 offen offset:2048 nt
    buffer_store_dwordx4 v[196:199], v110, s[24:27], s36 offen offset:3072 nt
    v_accvgpr_read_b32 v168, a136
    v_accvgpr_read_b32 v169, a137
    v_accvgpr_read_b32 v170, a138
    v_accvgpr_read_b32 v171, a139
    v_accvgpr_read_b32 v172, a140
    v_accvgpr_read_b32 v173, a141
    v_accvgpr_read_b32 v174, a142
    v_accvgpr_read_b32 v175, a143
    v_pk_mul_f32 v[168:169], v[168:169], v[138:139] op_sel_hi:[1,0]
    v_pk_mul_f32 v[170:171], v[170:171], v[138:139] op_sel_hi:[1,0]
    v_pk_mul_f32 v[172:173], v[172:173], v[138:139] op_sel_hi:[1,0]
    v_pk_mul_f32 v[174:175], v[174:175], v[138:139] op_sel_hi:[1,0]
    v_cvt_pk_bf16_f32 v180, v168, v169
    v_cvt_pk_bf16_f32 v181, v170, v171
    v_cvt_pk_bf16_f32 v182, v172, v173
    v_cvt_pk_bf16_f32 v183, v174, v175
    ds_write_b64 v106, v[180:181] offset:8192
    ds_write_b64 v107, v[182:183] offset:8192
    v_accvgpr_read_b32 v160, a144
    v_accvgpr_read_b32 v161, a145
    v_accvgpr_read_b32 v162, a146
    v_accvgpr_read_b32 v163, a147
    v_accvgpr_read_b32 v164, a148
    v_accvgpr_read_b32 v165, a149
    v_accvgpr_read_b32 v166, a150
    v_accvgpr_read_b32 v167, a151
    v_pk_mul_f32 v[160:161], v[160:161], v[138:139] op_sel_hi:[1,0]
    v_pk_mul_f32 v[162:163], v[162:163], v[138:139] op_sel_hi:[1,0]
    v_pk_mul_f32 v[164:165], v[164:165], v[138:139] op_sel_hi:[1,0]
    v_pk_mul_f32 v[166:167], v[166:167], v[138:139] op_sel_hi:[1,0]
    v_cvt_pk_bf16_f32 v176, v160, v161
    v_cvt_pk_bf16_f32 v177, v162, v163
    v_cvt_pk_bf16_f32 v178, v164, v165
    v_cvt_pk_bf16_f32 v179, v166, v167
    ds_write_b64 v104, v[176:177] offset:8320
    ds_write_b64 v105, v[178:179] offset:8320
    v_accvgpr_read_b32 v168, a152
    v_accvgpr_read_b32 v169, a153
    v_accvgpr_read_b32 v170, a154
    v_accvgpr_read_b32 v171, a155
    v_accvgpr_read_b32 v172, a156
    v_accvgpr_read_b32 v173, a157
    v_accvgpr_read_b32 v174, a158
    v_accvgpr_read_b32 v175, a159
    v_pk_mul_f32 v[168:169], v[168:169], v[138:139] op_sel_hi:[1,0]
    v_pk_mul_f32 v[170:171], v[170:171], v[138:139] op_sel_hi:[1,0]
    v_pk_mul_f32 v[172:173], v[172:173], v[138:139] op_sel_hi:[1,0]
    v_pk_mul_f32 v[174:175], v[174:175], v[138:139] op_sel_hi:[1,0]
    v_cvt_pk_bf16_f32 v180, v168, v169
    v_cvt_pk_bf16_f32 v181, v170, v171
    v_cvt_pk_bf16_f32 v182, v172, v173
    v_cvt_pk_bf16_f32 v183, v174, v175
    ds_write_b64 v106, v[180:181] offset:8320
    ds_write_b64 v107, v[182:183] offset:8320
    ds_read_b128 v[184:187], v108 offset:8192
    ds_read_b128 v[188:191], v109 offset:9216
    ds_read_b128 v[192:195], v108 offset:10240
    ds_read_b128 v[196:199], v109 offset:11264
    v_rcp_f32 v134, v132
    v_accvgpr_read_b32 v160, a96
    v_accvgpr_read_b32 v161, a97
    v_accvgpr_read_b32 v162, a98
    v_accvgpr_read_b32 v163, a99
    v_accvgpr_read_b32 v164, a100
    v_accvgpr_read_b32 v165, a101
    v_accvgpr_read_b32 v166, a102
    v_accvgpr_read_b32 v167, a103
    v_pk_mul_f32 v[160:161], v[160:161], v[134:135] op_sel_hi:[1,0]
    v_pk_mul_f32 v[162:163], v[162:163], v[134:135] op_sel_hi:[1,0]
    v_pk_mul_f32 v[164:165], v[164:165], v[134:135] op_sel_hi:[1,0]
    v_pk_mul_f32 v[166:167], v[166:167], v[134:135] op_sel_hi:[1,0]
    v_cvt_pk_bf16_f32 v176, v160, v161
    v_cvt_pk_bf16_f32 v177, v162, v163
    v_cvt_pk_bf16_f32 v178, v164, v165
    v_cvt_pk_bf16_f32 v179, v166, v167
    ds_write_b64 v104, v[176:177] offset:16384
    ds_write_b64 v105, v[178:179] offset:16384
    s_mov_b32 s36, 16384
    s_waitcnt lgkmcnt(2)
    buffer_store_dwordx4 v[184:187], v110, s[24:27], s36 offen nt
    buffer_store_dwordx4 v[188:191], v110, s[24:27], s36 offen offset:1024 nt
    buffer_store_dwordx4 v[192:195], v110, s[24:27], s36 offen offset:2048 nt
    buffer_store_dwordx4 v[196:199], v110, s[24:27], s36 offen offset:3072 nt
    v_accvgpr_read_b32 v168, a104
    v_accvgpr_read_b32 v169, a105
    v_accvgpr_read_b32 v170, a106
    v_accvgpr_read_b32 v171, a107
    v_accvgpr_read_b32 v172, a108
    v_accvgpr_read_b32 v173, a109
    v_accvgpr_read_b32 v174, a110
    v_accvgpr_read_b32 v175, a111
    v_pk_mul_f32 v[168:169], v[168:169], v[134:135] op_sel_hi:[1,0]
    v_pk_mul_f32 v[170:171], v[170:171], v[134:135] op_sel_hi:[1,0]
    v_pk_mul_f32 v[172:173], v[172:173], v[134:135] op_sel_hi:[1,0]
    v_pk_mul_f32 v[174:175], v[174:175], v[134:135] op_sel_hi:[1,0]
    v_cvt_pk_bf16_f32 v180, v168, v169
    v_cvt_pk_bf16_f32 v181, v170, v171
    v_cvt_pk_bf16_f32 v182, v172, v173
    v_cvt_pk_bf16_f32 v183, v174, v175
    ds_write_b64 v106, v[180:181] offset:16384
    ds_write_b64 v107, v[182:183] offset:16384
    v_accvgpr_read_b32 v160, a112
    v_accvgpr_read_b32 v161, a113
    v_accvgpr_read_b32 v162, a114
    v_accvgpr_read_b32 v163, a115
    v_accvgpr_read_b32 v164, a116
    v_accvgpr_read_b32 v165, a117
    v_accvgpr_read_b32 v166, a118
    v_accvgpr_read_b32 v167, a119
    v_pk_mul_f32 v[160:161], v[160:161], v[134:135] op_sel_hi:[1,0]
    v_pk_mul_f32 v[162:163], v[162:163], v[134:135] op_sel_hi:[1,0]
    v_pk_mul_f32 v[164:165], v[164:165], v[134:135] op_sel_hi:[1,0]
    v_pk_mul_f32 v[166:167], v[166:167], v[134:135] op_sel_hi:[1,0]
    v_cvt_pk_bf16_f32 v176, v160, v161
    v_cvt_pk_bf16_f32 v177, v162, v163
    v_cvt_pk_bf16_f32 v178, v164, v165
    v_cvt_pk_bf16_f32 v179, v166, v167
    ds_write_b64 v104, v[176:177] offset:16512
    ds_write_b64 v105, v[178:179] offset:16512
    v_accvgpr_read_b32 v168, a120
    v_accvgpr_read_b32 v169, a121
    v_accvgpr_read_b32 v170, a122
    v_accvgpr_read_b32 v171, a123
    v_accvgpr_read_b32 v172, a124
    v_accvgpr_read_b32 v173, a125
    v_accvgpr_read_b32 v174, a126
    v_accvgpr_read_b32 v175, a127
    v_pk_mul_f32 v[168:169], v[168:169], v[134:135] op_sel_hi:[1,0]
    v_pk_mul_f32 v[170:171], v[170:171], v[134:135] op_sel_hi:[1,0]
    v_pk_mul_f32 v[172:173], v[172:173], v[134:135] op_sel_hi:[1,0]
    v_pk_mul_f32 v[174:175], v[174:175], v[134:135] op_sel_hi:[1,0]
    v_cvt_pk_bf16_f32 v180, v168, v169
    v_cvt_pk_bf16_f32 v181, v170, v171
    v_cvt_pk_bf16_f32 v182, v172, v173
    v_cvt_pk_bf16_f32 v183, v174, v175
    ds_write_b64 v106, v[180:181] offset:16512
    ds_write_b64 v107, v[182:183] offset:16512
    ds_read_b128 v[184:187], v108 offset:16384
    ds_read_b128 v[188:191], v109 offset:17408
    ds_read_b128 v[192:195], v108 offset:18432
    ds_read_b128 v[196:199], v109 offset:19456
    v_rcp_f32 v130, v128
    v_accvgpr_read_b32 v160, a64
    v_accvgpr_read_b32 v161, a65
    v_accvgpr_read_b32 v162, a66
    v_accvgpr_read_b32 v163, a67
    v_accvgpr_read_b32 v164, a68
    v_accvgpr_read_b32 v165, a69
    v_accvgpr_read_b32 v166, a70
    v_accvgpr_read_b32 v167, a71
    v_pk_mul_f32 v[160:161], v[160:161], v[130:131] op_sel_hi:[1,0]
    v_pk_mul_f32 v[162:163], v[162:163], v[130:131] op_sel_hi:[1,0]
    v_pk_mul_f32 v[164:165], v[164:165], v[130:131] op_sel_hi:[1,0]
    v_pk_mul_f32 v[166:167], v[166:167], v[130:131] op_sel_hi:[1,0]
    v_cvt_pk_bf16_f32 v176, v160, v161
    v_cvt_pk_bf16_f32 v177, v162, v163
    v_cvt_pk_bf16_f32 v178, v164, v165
    v_cvt_pk_bf16_f32 v179, v166, v167
    ds_write_b64 v104, v[176:177] offset:24576
    ds_write_b64 v105, v[178:179] offset:24576
    s_mov_b32 s36, 12288
    s_waitcnt lgkmcnt(2)
    buffer_store_dwordx4 v[184:187], v110, s[24:27], s36 offen nt
    buffer_store_dwordx4 v[188:191], v110, s[24:27], s36 offen offset:1024 nt
    buffer_store_dwordx4 v[192:195], v110, s[24:27], s36 offen offset:2048 nt
    buffer_store_dwordx4 v[196:199], v110, s[24:27], s36 offen offset:3072 nt
    v_accvgpr_read_b32 v168, a72
    v_accvgpr_read_b32 v169, a73
    v_accvgpr_read_b32 v170, a74
    v_accvgpr_read_b32 v171, a75
    v_accvgpr_read_b32 v172, a76
    v_accvgpr_read_b32 v173, a77
    v_accvgpr_read_b32 v174, a78
    v_accvgpr_read_b32 v175, a79
    v_pk_mul_f32 v[168:169], v[168:169], v[130:131] op_sel_hi:[1,0]
    v_pk_mul_f32 v[170:171], v[170:171], v[130:131] op_sel_hi:[1,0]
    v_pk_mul_f32 v[172:173], v[172:173], v[130:131] op_sel_hi:[1,0]
    v_pk_mul_f32 v[174:175], v[174:175], v[130:131] op_sel_hi:[1,0]
    v_cvt_pk_bf16_f32 v180, v168, v169
    v_cvt_pk_bf16_f32 v181, v170, v171
    v_cvt_pk_bf16_f32 v182, v172, v173
    v_cvt_pk_bf16_f32 v183, v174, v175
    ds_write_b64 v106, v[180:181] offset:24576
    ds_write_b64 v107, v[182:183] offset:24576
    v_accvgpr_read_b32 v160, a80
    v_accvgpr_read_b32 v161, a81
    v_accvgpr_read_b32 v162, a82
    v_accvgpr_read_b32 v163, a83
    v_accvgpr_read_b32 v164, a84
    v_accvgpr_read_b32 v165, a85
    v_accvgpr_read_b32 v166, a86
    v_accvgpr_read_b32 v167, a87
    v_pk_mul_f32 v[160:161], v[160:161], v[130:131] op_sel_hi:[1,0]
    v_pk_mul_f32 v[162:163], v[162:163], v[130:131] op_sel_hi:[1,0]
    v_pk_mul_f32 v[164:165], v[164:165], v[130:131] op_sel_hi:[1,0]
    v_pk_mul_f32 v[166:167], v[166:167], v[130:131] op_sel_hi:[1,0]
    v_cvt_pk_bf16_f32 v176, v160, v161
    v_cvt_pk_bf16_f32 v177, v162, v163
    v_cvt_pk_bf16_f32 v178, v164, v165
    v_cvt_pk_bf16_f32 v179, v166, v167
    ds_write_b64 v104, v[176:177] offset:24704
    ds_write_b64 v105, v[178:179] offset:24704
    v_accvgpr_read_b32 v168, a88
    v_accvgpr_read_b32 v169, a89
    v_accvgpr_read_b32 v170, a90
    v_accvgpr_read_b32 v171, a91
    v_accvgpr_read_b32 v172, a92
    v_accvgpr_read_b32 v173, a93
    v_accvgpr_read_b32 v174, a94
    v_accvgpr_read_b32 v175, a95
    v_pk_mul_f32 v[168:169], v[168:169], v[130:131] op_sel_hi:[1,0]
    v_pk_mul_f32 v[170:171], v[170:171], v[130:131] op_sel_hi:[1,0]
    v_pk_mul_f32 v[172:173], v[172:173], v[130:131] op_sel_hi:[1,0]
    v_pk_mul_f32 v[174:175], v[174:175], v[130:131] op_sel_hi:[1,0]
    v_cvt_pk_bf16_f32 v180, v168, v169
    v_cvt_pk_bf16_f32 v181, v170, v171
    v_cvt_pk_bf16_f32 v182, v172, v173
    v_cvt_pk_bf16_f32 v183, v174, v175
    ds_write_b64 v106, v[180:181] offset:24704
    ds_write_b64 v107, v[182:183] offset:24704
    ds_read_b128 v[184:187], v108 offset:24576
    ds_read_b128 v[188:191], v109 offset:25600
    ds_read_b128 v[192:195], v108 offset:26624
    ds_read_b128 v[196:199], v109 offset:27648
    v_rcp_f32 v126, v124
    v_accvgpr_read_b32 v160, a32
    v_accvgpr_read_b32 v161, a33
    v_accvgpr_read_b32 v162, a34
    v_accvgpr_read_b32 v163, a35
    v_accvgpr_read_b32 v164, a36
    v_accvgpr_read_b32 v165, a37
    v_accvgpr_read_b32 v166, a38
    v_accvgpr_read_b32 v167, a39
    v_pk_mul_f32 v[160:161], v[160:161], v[126:127] op_sel_hi:[1,0]
    v_pk_mul_f32 v[162:163], v[162:163], v[126:127] op_sel_hi:[1,0]
    v_pk_mul_f32 v[164:165], v[164:165], v[126:127] op_sel_hi:[1,0]
    v_pk_mul_f32 v[166:167], v[166:167], v[126:127] op_sel_hi:[1,0]
    v_cvt_pk_bf16_f32 v176, v160, v161
    v_cvt_pk_bf16_f32 v177, v162, v163
    v_cvt_pk_bf16_f32 v178, v164, v165
    v_cvt_pk_bf16_f32 v179, v166, v167
    ds_write_b64 v104, v[176:177]
    ds_write_b64 v105, v[178:179]
    s_mov_b32 s36, 8192
    s_waitcnt lgkmcnt(2)
    buffer_store_dwordx4 v[184:187], v110, s[24:27], s36 offen nt
    buffer_store_dwordx4 v[188:191], v110, s[24:27], s36 offen offset:1024 nt
    buffer_store_dwordx4 v[192:195], v110, s[24:27], s36 offen offset:2048 nt
    buffer_store_dwordx4 v[196:199], v110, s[24:27], s36 offen offset:3072 nt
    v_accvgpr_read_b32 v168, a40
    v_accvgpr_read_b32 v169, a41
    v_accvgpr_read_b32 v170, a42
    v_accvgpr_read_b32 v171, a43
    v_accvgpr_read_b32 v172, a44
    v_accvgpr_read_b32 v173, a45
    v_accvgpr_read_b32 v174, a46
    v_accvgpr_read_b32 v175, a47
    v_pk_mul_f32 v[168:169], v[168:169], v[126:127] op_sel_hi:[1,0]
    v_pk_mul_f32 v[170:171], v[170:171], v[126:127] op_sel_hi:[1,0]
    v_pk_mul_f32 v[172:173], v[172:173], v[126:127] op_sel_hi:[1,0]
    v_pk_mul_f32 v[174:175], v[174:175], v[126:127] op_sel_hi:[1,0]
    v_cvt_pk_bf16_f32 v180, v168, v169
    v_cvt_pk_bf16_f32 v181, v170, v171
    v_cvt_pk_bf16_f32 v182, v172, v173
    v_cvt_pk_bf16_f32 v183, v174, v175
    ds_write_b64 v106, v[180:181]
    ds_write_b64 v107, v[182:183]
    v_accvgpr_read_b32 v160, a48
    v_accvgpr_read_b32 v161, a49
    v_accvgpr_read_b32 v162, a50
    v_accvgpr_read_b32 v163, a51
    v_accvgpr_read_b32 v164, a52
    v_accvgpr_read_b32 v165, a53
    v_accvgpr_read_b32 v166, a54
    v_accvgpr_read_b32 v167, a55
    v_pk_mul_f32 v[160:161], v[160:161], v[126:127] op_sel_hi:[1,0]
    v_pk_mul_f32 v[162:163], v[162:163], v[126:127] op_sel_hi:[1,0]
    v_pk_mul_f32 v[164:165], v[164:165], v[126:127] op_sel_hi:[1,0]
    v_pk_mul_f32 v[166:167], v[166:167], v[126:127] op_sel_hi:[1,0]
    v_cvt_pk_bf16_f32 v176, v160, v161
    v_cvt_pk_bf16_f32 v177, v162, v163
    v_cvt_pk_bf16_f32 v178, v164, v165
    v_cvt_pk_bf16_f32 v179, v166, v167
    ds_write_b64 v104, v[176:177] offset:128
    ds_write_b64 v105, v[178:179] offset:128
    v_accvgpr_read_b32 v168, a56
    v_accvgpr_read_b32 v169, a57
    v_accvgpr_read_b32 v170, a58
    v_accvgpr_read_b32 v171, a59
    v_accvgpr_read_b32 v172, a60
    v_accvgpr_read_b32 v173, a61
    v_accvgpr_read_b32 v174, a62
    v_accvgpr_read_b32 v175, a63
    v_pk_mul_f32 v[168:169], v[168:169], v[126:127] op_sel_hi:[1,0]
    v_pk_mul_f32 v[170:171], v[170:171], v[126:127] op_sel_hi:[1,0]
    v_pk_mul_f32 v[172:173], v[172:173], v[126:127] op_sel_hi:[1,0]
    v_pk_mul_f32 v[174:175], v[174:175], v[126:127] op_sel_hi:[1,0]
    v_cvt_pk_bf16_f32 v180, v168, v169
    v_cvt_pk_bf16_f32 v181, v170, v171
    v_cvt_pk_bf16_f32 v182, v172, v173
    v_cvt_pk_bf16_f32 v183, v174, v175
    ds_write_b64 v106, v[180:181] offset:128
    ds_write_b64 v107, v[182:183] offset:128
    ds_read_b128 v[184:187], v108
    ds_read_b128 v[188:191], v109 offset:1024
    ds_read_b128 v[192:195], v108 offset:2048
    ds_read_b128 v[196:199], v109 offset:3072
    v_rcp_f32 v122, v120
    v_accvgpr_read_b32 v160, a0
    v_accvgpr_read_b32 v161, a1
    v_accvgpr_read_b32 v162, a2
    v_accvgpr_read_b32 v163, a3
    v_accvgpr_read_b32 v164, a4
    v_accvgpr_read_b32 v165, a5
    v_accvgpr_read_b32 v166, a6
    v_accvgpr_read_b32 v167, a7
    v_pk_mul_f32 v[160:161], v[160:161], v[122:123] op_sel_hi:[1,0]
    v_pk_mul_f32 v[162:163], v[162:163], v[122:123] op_sel_hi:[1,0]
    v_pk_mul_f32 v[164:165], v[164:165], v[122:123] op_sel_hi:[1,0]
    v_pk_mul_f32 v[166:167], v[166:167], v[122:123] op_sel_hi:[1,0]
    v_cvt_pk_bf16_f32 v176, v160, v161
    v_cvt_pk_bf16_f32 v177, v162, v163
    v_cvt_pk_bf16_f32 v178, v164, v165
    v_cvt_pk_bf16_f32 v179, v166, v167
    ds_write_b64 v104, v[176:177] offset:8192
    ds_write_b64 v105, v[178:179] offset:8192
    s_mov_b32 s36, 4096
    s_waitcnt lgkmcnt(2)
    buffer_store_dwordx4 v[184:187], v110, s[24:27], s36 offen nt
    buffer_store_dwordx4 v[188:191], v110, s[24:27], s36 offen offset:1024 nt
    buffer_store_dwordx4 v[192:195], v110, s[24:27], s36 offen offset:2048 nt
    buffer_store_dwordx4 v[196:199], v110, s[24:27], s36 offen offset:3072 nt
    v_accvgpr_read_b32 v168, a8
    v_accvgpr_read_b32 v169, a9
    v_accvgpr_read_b32 v170, a10
    v_accvgpr_read_b32 v171, a11
    v_accvgpr_read_b32 v172, a12
    v_accvgpr_read_b32 v173, a13
    v_accvgpr_read_b32 v174, a14
    v_accvgpr_read_b32 v175, a15
    v_pk_mul_f32 v[168:169], v[168:169], v[122:123] op_sel_hi:[1,0]
    v_pk_mul_f32 v[170:171], v[170:171], v[122:123] op_sel_hi:[1,0]
    v_pk_mul_f32 v[172:173], v[172:173], v[122:123] op_sel_hi:[1,0]
    v_pk_mul_f32 v[174:175], v[174:175], v[122:123] op_sel_hi:[1,0]
    v_cvt_pk_bf16_f32 v180, v168, v169
    v_cvt_pk_bf16_f32 v181, v170, v171
    v_cvt_pk_bf16_f32 v182, v172, v173
    v_cvt_pk_bf16_f32 v183, v174, v175
    ds_write_b64 v106, v[180:181] offset:8192
    ds_write_b64 v107, v[182:183] offset:8192
    v_accvgpr_read_b32 v160, a16
    v_accvgpr_read_b32 v161, a17
    v_accvgpr_read_b32 v162, a18
    v_accvgpr_read_b32 v163, a19
    v_accvgpr_read_b32 v164, a20
    v_accvgpr_read_b32 v165, a21
    v_accvgpr_read_b32 v166, a22
    v_accvgpr_read_b32 v167, a23
    v_pk_mul_f32 v[160:161], v[160:161], v[122:123] op_sel_hi:[1,0]
    v_pk_mul_f32 v[162:163], v[162:163], v[122:123] op_sel_hi:[1,0]
    v_pk_mul_f32 v[164:165], v[164:165], v[122:123] op_sel_hi:[1,0]
    v_pk_mul_f32 v[166:167], v[166:167], v[122:123] op_sel_hi:[1,0]
    v_cvt_pk_bf16_f32 v176, v160, v161
    v_cvt_pk_bf16_f32 v177, v162, v163
    v_cvt_pk_bf16_f32 v178, v164, v165
    v_cvt_pk_bf16_f32 v179, v166, v167
    ds_write_b64 v104, v[176:177] offset:8320
    ds_write_b64 v105, v[178:179] offset:8320
    v_accvgpr_read_b32 v168, a24
    v_accvgpr_read_b32 v169, a25
    v_accvgpr_read_b32 v170, a26
    v_accvgpr_read_b32 v171, a27
    v_accvgpr_read_b32 v172, a28
    v_accvgpr_read_b32 v173, a29
    v_accvgpr_read_b32 v174, a30
    v_accvgpr_read_b32 v175, a31
    v_pk_mul_f32 v[168:169], v[168:169], v[122:123] op_sel_hi:[1,0]
    v_pk_mul_f32 v[170:171], v[170:171], v[122:123] op_sel_hi:[1,0]
    v_pk_mul_f32 v[172:173], v[172:173], v[122:123] op_sel_hi:[1,0]
    v_pk_mul_f32 v[174:175], v[174:175], v[122:123] op_sel_hi:[1,0]
    v_cvt_pk_bf16_f32 v180, v168, v169
    v_cvt_pk_bf16_f32 v181, v170, v171
    v_cvt_pk_bf16_f32 v182, v172, v173
    v_cvt_pk_bf16_f32 v183, v174, v175
    ds_write_b64 v106, v[180:181] offset:8320
    ds_write_b64 v107, v[182:183] offset:8320
    ds_read_b128 v[184:187], v108 offset:8192
    ds_read_b128 v[188:191], v109 offset:9216
    ds_read_b128 v[192:195], v108 offset:10240
    ds_read_b128 v[196:199], v109 offset:11264
    s_mov_b32 s36, 0
    s_waitcnt lgkmcnt(0)
    buffer_store_dwordx4 v[184:187], v110, s[24:27], s36 offen nt
    buffer_store_dwordx4 v[188:191], v110, s[24:27], s36 offen offset:1024 nt
    buffer_store_dwordx4 v[192:195], v110, s[24:27], s36 offen offset:2048 nt
    buffer_store_dwordx4 v[196:199], v110, s[24:27], s36 offen offset:3072 nt
    v_add_f32 v157, v120, v124
    v_add_f32 v157, v157, v128
    v_add_f32 v157, v157, v132
    v_add_f32 v157, v157, v136
    v_add_f32 v157, v157, v140
    s_mov_b32 s35, 0x5d800000
    v_cmp_ngt_f32 vcc, s35, v157
    v_mov_b32 v0, s32
    v_mbcnt_lo_u32_b32 v2, -1, 0
    v_and_b32 v3, 1, v2
    v_lshlrev_b32 v3, 12, v3
    s_cmp_lg_u64 vcc, 0
    s_cselect_b32 s36, 1, 0
    v_mov_b32 v1, s36
    ds_write_b32 v0, v1 offset:32768
    s_waitcnt lgkmcnt(0)
    s_barrier
    ds_read_b32 v2, v3 offset:32768
    s_waitcnt lgkmcnt(0)
    v_cmp_ne_u32 vcc, 0, v2
    s_nop 3
    s_cbranch_vccz L_done
    s_waitcnt vmcnt(0)
    s_barrier
    s_mov_b32 s30, s32
    s_mov_b32 s31, s32
    s_mov_b32 s18, 0x40000
    s_mov_b32 s22, 0x40000
    s_mov_b32 s29, 1
    s_add_u32 m0, s32, 0
    s_nop 0
    buffer_load_dwordx4 v152, s[16:19], s30 offen nt lds
    buffer_load_dwordx4 v153, s[16:19], s30 offen offset:1024 nt lds
    buffer_load_dwordx4 v152, s[16:19], s30 offen offset:2048 nt lds
    buffer_load_dwordx4 v153, s[16:19], s30 offen offset:3072 nt lds
    s_add_u32 s30, s30, 8192
    s_add_u32 m0, s32, 16384
    s_add_u32 s35, s34, 0
    buffer_load_dwordx4 v152, s[12:15], s35 offen nt lds
    buffer_load_dwordx4 v153, s[12:15], s35 offen offset:1024 nt lds
    buffer_load_dwordx4 v152, s[12:15], s35 offen offset:2048 nt lds
    buffer_load_dwordx4 v153, s[12:15], s35 offen offset:3072 nt lds
    v_mbcnt_lo_u32_b32 v76, -1, 0
    v_mbcnt_hi_u32_b32 v76, -1, v76
    v_and_b32 v77, 15, v76
    v_lshrrev_b32 v78, 4, v76
    v_lshlrev_b32 v81, 1, v77
    v_and_b32 v81, 15, v81
    v_xor_b32 v81, v81, v78
    v_lshlrev_b32 v82, 8, v77
    v_lshl_add_u32 v144, v81, 4, v82
    s_add_u32 s35, s32, 16384
    v_xor_b32 v145, 64, v144
    v_xor_b32 v146, 128, v144
    v_xor_b32 v147, 192, v144
    v_add_u32 v72, s35, v144
    v_add_u32 v73, s35, v145
    v_add_u32 v74, s35, v146
    v_add_u32 v75, s35, v147
    v_lshrrev_b32 v81, 2, v77
    v_lshl_add_u32 v82, v78, 2, v81
    v_lshlrev_b32 v82, 8, v82
    v_lshl_add_u32 v81, v81, 6, v82
    v_and_b32 v82, 3, v77
    v_lshl_add_u32 v81, v82, 3, v81
    v_xor_b32 v82, 0, v81
    v_add_u32 v148, 40960, v82
    v_xor_b32 v82, 64, v81
    v_add_u32 v149, 40960, v82
    v_xor_b32 v82, 128, v81
    v_add_u32 v150, 40960, v82
    v_xor_b32 v82, 192, v81
    v_add_u32 v151, 40960, v82
    v_mov_b32 v48, 0x3f803f80
    v_mov_b32 v49, 0x3f803f80
    v_mov_b32 v50, 0x3f803f80
    v_mov_b32 v51, 0x3f803f80
    s_waitcnt vmcnt(4)
    s_add_u32 m0, s32, 57344
    s_add_u32 s35, s34, 4096
    buffer_load_dwordx4 v152, s[12:15], s35 offen nt lds
    buffer_load_dwordx4 v153, s[12:15], s35 offen offset:1024 nt lds
    buffer_load_dwordx4 v152, s[12:15], s35 offen offset:2048 nt lds
    buffer_load_dwordx4 v153, s[12:15], s35 offen offset:3072 nt lds
    s_waitcnt vmcnt(4)
    s_add_u32 m0, s32, 24576
    s_add_u32 s35, s34, 8192
    buffer_load_dwordx4 v152, s[12:15], s35 offen nt lds
    buffer_load_dwordx4 v153, s[12:15], s35 offen offset:1024 nt lds
    buffer_load_dwordx4 v152, s[12:15], s35 offen offset:2048 nt lds
    buffer_load_dwordx4 v153, s[12:15], s35 offen offset:3072 nt lds
    ds_read_b128 v[160:163], v72
    ds_read_b128 v[164:167], v73
    ds_read_b128 v[168:171], v74
    ds_read_b128 v[172:175], v75
    s_barrier
    ds_read_b128 a[192:195], v144
    ds_read_b128 a[196:199], v145
    ds_read_b128 a[200:203], v146
    ds_read_b128 a[204:207], v147
    ds_read_b128 a[208:211], v144 offset:4096
    ds_read_b128 a[212:215], v145 offset:4096
    ds_read_b128 a[216:219], v146 offset:4096
    ds_read_b128 a[220:223], v147 offset:4096
    s_waitcnt lgkmcnt(8)
    v_lshlrev_b32 v76, 16, v160
    v_and_b32 v77, 0xffff0000, v160
    v_lshlrev_b32 v78, 16, v161
    v_and_b32 v79, 0xffff0000, v161
    v_lshlrev_b32 v80, 16, v162
    v_and_b32 v81, 0xffff0000, v162
    v_lshlrev_b32 v82, 16, v163
    v_and_b32 v83, 0xffff0000, v163
    v_pk_mul_f32 v[76:77], v[76:77], s[38:39] op_sel_hi:[1,0]
    v_pk_mul_f32 v[78:79], v[78:79], s[38:39] op_sel_hi:[1,0]
    v_pk_mul_f32 v[80:81], v[80:81], s[38:39] op_sel_hi:[1,0]
    v_pk_mul_f32 v[82:83], v[82:83], s[38:39] op_sel_hi:[1,0]
    v_cvt_pk_bf16_f32 v160, v76, v77
    v_cvt_pk_bf16_f32 v161, v78, v79
    v_cvt_pk_bf16_f32 v162, v80, v81
    v_cvt_pk_bf16_f32 v163, v82, v83
    v_lshlrev_b32 v76, 16, v164
    v_and_b32 v77, 0xffff0000, v164
    v_lshlrev_b32 v78, 16, v165
    v_and_b32 v79, 0xffff0000, v165
    v_lshlrev_b32 v80, 16, v166
    v_and_b32 v81, 0xffff0000, v166
    v_lshlrev_b32 v82, 16, v167
    v_and_b32 v83, 0xffff0000, v167
    v_pk_mul_f32 v[76:77], v[76:77], s[38:39] op_sel_hi:[1,0]
    v_pk_mul_f32 v[78:79], v[78:79], s[38:39] op_sel_hi:[1,0]
    v_pk_mul_f32 v[80:81], v[80:81], s[38:39] op_sel_hi:[1,0]
    v_pk_mul_f32 v[82:83], v[82:83], s[38:39] op_sel_hi:[1,0]
    v_cvt_pk_bf16_f32 v164, v76, v77
    v_cvt_pk_bf16_f32 v165, v78, v79
    v_cvt_pk_bf16_f32 v166, v80, v81
    v_cvt_pk_bf16_f32 v167, v82, v83
    v_lshlrev_b32 v76, 16, v168
    v_and_b32 v77, 0xffff0000, v168
    v_lshlrev_b32 v78, 16, v169
    v_and_b32 v79, 0xffff0000, v169
    v_lshlrev_b32 v80, 16, v170
    v_and_b32 v81, 0xffff0000, v170
    v_lshlrev_b32 v82, 16, v171
    v_and_b32 v83, 0xffff0000, v171
    v_pk_mul_f32 v[76:77], v[76:77], s[38:39] op_sel_hi:[1,0]
    v_pk_mul_f32 v[78:79], v[78:79], s[38:39] op_sel_hi:[1,0]
    v_pk_mul_f32 v[80:81], v[80:81], s[38:39] op_sel_hi:[1,0]
    v_pk_mul_f32 v[82:83], v[82:83], s[38:39] op_sel_hi:[1,0]
    v_cvt_pk_bf16_f32 v168, v76, v77
    v_cvt_pk_bf16_f32 v169, v78, v79
    v_cvt_pk_bf16_f32 v170, v80, v81
    v_cvt_pk_bf16_f32 v171, v82, v83
    v_lshlrev_b32 v76, 16, v172
    v_and_b32 v77, 0xffff0000, v172
    v_lshlrev_b32 v78, 16, v173
    v_and_b32 v79, 0xffff0000, v173
    v_lshlrev_b32 v80, 16, v174
    v_and_b32 v81, 0xffff0000, v174
    v_lshlrev_b32 v82, 16, v175
    v_and_b32 v83, 0xffff0000, v175
    v_pk_mul_f32 v[76:77], v[76:77], s[38:39] op_sel_hi:[1,0]
    v_pk_mul_f32 v[78:79], v[78:79], s[38:39] op_sel_hi:[1,0]
    v_pk_mul_f32 v[80:81], v[80:81], s[38:39] op_sel_hi:[1,0]
    v_pk_mul_f32 v[82:83], v[82:83], s[38:39] op_sel_hi:[1,0]
    v_cvt_pk_bf16_f32 v172, v76, v77
    v_cvt_pk_bf16_f32 v173, v78, v79
    v_cvt_pk_bf16_f32 v174, v80, v81
    v_cvt_pk_bf16_f32 v175, v82, v83
    s_waitcnt lgkmcnt(0)
    s_nop 0
    v_mfma_f32_16x16x32_bf16 v[0:3], a[192:195], v[160:163], 0
    v_mfma_f32_16x16x32_bf16 v[0:3], a[196:199], v[164:167], v[0:3]
    v_mfma_f32_16x16x32_bf16 v[0:3], a[200:203], v[168:171], v[0:3]
    v_mfma_f32_16x16x32_bf16 v[0:3], a[204:207], v[172:175], v[0:3]
    v_mfma_f32_16x16x32_bf16 v[4:7], a[220:223], v[172:175], 0
    v_mfma_f32_16x16x32_bf16 v[4:7], a[216:219], v[168:171], v[4:7]
    v_mfma_f32_16x16x32_bf16 v[4:7], a[212:215], v[164:167], v[4:7]
    v_mfma_f32_16x16x32_bf16 v[4:7], a[208:211], v[160:163], v[4:7]
    s_waitcnt vmcnt(4)
    s_add_u32 m0, s32, 65536
    s_add_u32 s35, s34, 12288
    buffer_load_dwordx4 v152, s[12:15], s35 offen nt lds
    buffer_load_dwordx4 v153, s[12:15], s35 offen offset:1024 nt lds
    buffer_load_dwordx4 v152, s[12:15], s35 offen offset:2048 nt lds
    buffer_load_dwordx4 v153, s[12:15], s35 offen offset:3072 nt lds
    ds_read_b128 v[176:179], v72 offset:40960
    ds_read_b128 v[180:183], v73 offset:40960
    ds_read_b128 v[184:187], v74 offset:40960
    ds_read_b128 v[188:191], v75 offset:40960
    s_nop 2
    v_max3_f32 v155, v0, v1, v2
    v_max3_f32 v155, v155, v3, v4
    v_max3_f32 v155, v155, v5, v6
    v_max_f32 v155, v155, v7
    v_mov_b32 v156, v155
    s_nop 1
    v_permlane16_swap_b32 v155, v156
    v_max_f32 v155, v155, v156
    v_mov_b32 v156, v155
    s_nop 1
    v_permlane32_swap_b32 v155, v156
    v_max_f32 v155, v155, v156
    v_sub_f32 v0, v0, v155
    v_sub_f32 v1, v1, v155
    v_sub_f32 v2, v2, v155
    v_sub_f32 v3, v3, v155
    v_sub_f32 v4, v4, v155
    v_sub_f32 v5, v5, v155
    v_sub_f32 v6, v6, v155
    v_sub_f32 v7, v7, v155
    v_sub_f32 v96, 0, v155
    v_sub_f32 v97, 0, v155
    v_sub_f32 v98, 0, v155
    v_sub_f32 v99, 0, v155
    v_exp_f32 v0, v0
    v_exp_f32 v1, v1
    v_exp_f32 v2, v2
    v_cvt_pk_bf16_f32 v0, v0, v1
    v_exp_f32 v3, v3
    v_exp_f32 v4, v4
    v_cvt_pk_bf16_f32 v1, v2, v3
    v_exp_f32 v5, v5
    v_exp_f32 v6, v6
    v_cvt_pk_bf16_f32 v2, v4, v5
    v_exp_f32 v7, v7
    s_nop 0
    v_cvt_pk_bf16_f32 v3, v6, v7
    s_waitcnt lgkmcnt(0)
    v_lshlrev_b32 v76, 16, v176
    v_and_b32 v77, 0xffff0000, v176
    v_lshlrev_b32 v78, 16, v177
    v_and_b32 v79, 0xffff0000, v177
    v_lshlrev_b32 v80, 16, v178
    v_and_b32 v81, 0xffff0000, v178
    v_lshlrev_b32 v82, 16, v179
    v_and_b32 v83, 0xffff0000, v179
    v_pk_mul_f32 v[76:77], v[76:77], s[38:39] op_sel_hi:[1,0]
    v_pk_mul_f32 v[78:79], v[78:79], s[38:39] op_sel_hi:[1,0]
    v_pk_mul_f32 v[80:81], v[80:81], s[38:39] op_sel_hi:[1,0]
    v_pk_mul_f32 v[82:83], v[82:83], s[38:39] op_sel_hi:[1,0]
    v_cvt_pk_bf16_f32 v176, v76, v77
    v_cvt_pk_bf16_f32 v177, v78, v79
    v_cvt_pk_bf16_f32 v178, v80, v81
    v_cvt_pk_bf16_f32 v179, v82, v83
    v_lshlrev_b32 v76, 16, v180
    v_and_b32 v77, 0xffff0000, v180
    v_lshlrev_b32 v78, 16, v181
    v_and_b32 v79, 0xffff0000, v181
    v_lshlrev_b32 v80, 16, v182
    v_and_b32 v81, 0xffff0000, v182
    v_lshlrev_b32 v82, 16, v183
    v_and_b32 v83, 0xffff0000, v183
    v_pk_mul_f32 v[76:77], v[76:77], s[38:39] op_sel_hi:[1,0]
    v_pk_mul_f32 v[78:79], v[78:79], s[38:39] op_sel_hi:[1,0]
    v_pk_mul_f32 v[80:81], v[80:81], s[38:39] op_sel_hi:[1,0]
    v_pk_mul_f32 v[82:83], v[82:83], s[38:39] op_sel_hi:[1,0]
    v_cvt_pk_bf16_f32 v180, v76, v77
    v_cvt_pk_bf16_f32 v181, v78, v79
    v_cvt_pk_bf16_f32 v182, v80, v81
    v_cvt_pk_bf16_f32 v183, v82, v83
    v_lshlrev_b32 v76, 16, v184
    v_and_b32 v77, 0xffff0000, v184
    v_lshlrev_b32 v78, 16, v185
    v_and_b32 v79, 0xffff0000, v185
    v_lshlrev_b32 v80, 16, v186
    v_and_b32 v81, 0xffff0000, v186
    v_lshlrev_b32 v82, 16, v187
    v_and_b32 v83, 0xffff0000, v187
    v_pk_mul_f32 v[76:77], v[76:77], s[38:39] op_sel_hi:[1,0]
    v_pk_mul_f32 v[78:79], v[78:79], s[38:39] op_sel_hi:[1,0]
    v_pk_mul_f32 v[80:81], v[80:81], s[38:39] op_sel_hi:[1,0]
    v_pk_mul_f32 v[82:83], v[82:83], s[38:39] op_sel_hi:[1,0]
    v_cvt_pk_bf16_f32 v184, v76, v77
    v_cvt_pk_bf16_f32 v185, v78, v79
    v_cvt_pk_bf16_f32 v186, v80, v81
    v_cvt_pk_bf16_f32 v187, v82, v83
    v_lshlrev_b32 v76, 16, v188
    v_and_b32 v77, 0xffff0000, v188
    v_lshlrev_b32 v78, 16, v189
    v_and_b32 v79, 0xffff0000, v189
    v_lshlrev_b32 v80, 16, v190
    v_and_b32 v81, 0xffff0000, v190
    v_lshlrev_b32 v82, 16, v191
    v_and_b32 v83, 0xffff0000, v191
    v_pk_mul_f32 v[76:77], v[76:77], s[38:39] op_sel_hi:[1,0]
    v_pk_mul_f32 v[78:79], v[78:79], s[38:39] op_sel_hi:[1,0]
    v_pk_mul_f32 v[80:81], v[80:81], s[38:39] op_sel_hi:[1,0]
    v_pk_mul_f32 v[82:83], v[82:83], s[38:39] op_sel_hi:[1,0]
    v_cvt_pk_bf16_f32 v188, v76, v77
    v_cvt_pk_bf16_f32 v189, v78, v79
    v_cvt_pk_bf16_f32 v190, v80, v81
    v_cvt_pk_bf16_f32 v191, v82, v83
    s_waitcnt lgkmcnt(0)
    s_nop 0
    v_mfma_f32_16x16x32_bf16 v[8:11], a[192:195], v[176:179], 0
    v_mfma_f32_16x16x32_bf16 v[8:11], a[196:199], v[180:183], v[8:11]
    v_mfma_f32_16x16x32_bf16 v[8:11], a[200:203], v[184:187], v[8:11]
    v_mfma_f32_16x16x32_bf16 v[8:11], a[204:207], v[188:191], v[8:11]
    v_mfma_f32_16x16x32_bf16 v[12:15], a[220:223], v[188:191], 0
    v_mfma_f32_16x16x32_bf16 v[12:15], a[216:219], v[184:187], v[12:15]
    v_mfma_f32_16x16x32_bf16 v[12:15], a[212:215], v[180:183], v[12:15]
    v_mfma_f32_16x16x32_bf16 v[12:15], a[208:211], v[176:179], v[12:15]
    s_waitcnt vmcnt(4)
    s_add_u32 m0, s32, 32768
    s_add_u32 s35, s34, 16384
    buffer_load_dwordx4 v152, s[12:15], s35 offen nt lds
    buffer_load_dwordx4 v153, s[12:15], s35 offen offset:1024 nt lds
    buffer_load_dwordx4 v152, s[12:15], s35 offen offset:2048 nt lds
    buffer_load_dwordx4 v153, s[12:15], s35 offen offset:3072 nt lds
    ds_read_b128 v[192:195], v72 offset:8192
    ds_read_b128 v[196:199], v73 offset:8192
    ds_read_b128 v[200:203], v74 offset:8192
    ds_read_b128 v[204:207], v75 offset:8192
    s_nop 2
    v_max3_f32 v155, v8, v9, v10
    v_max3_f32 v155, v155, v11, v12
    v_max3_f32 v155, v155, v13, v14
    v_max_f32 v155, v155, v15
    v_mov_b32 v156, v155
    s_nop 1
    v_permlane16_swap_b32 v155, v156
    v_max_f32 v155, v155, v156
    v_mov_b32 v156, v155
    s_nop 1
    v_permlane32_swap_b32 v155, v156
    v_max_f32 v155, v155, v156
    v_sub_f32 v8, v8, v155
    v_sub_f32 v9, v9, v155
    v_sub_f32 v10, v10, v155
    v_sub_f32 v11, v11, v155
    v_sub_f32 v12, v12, v155
    v_sub_f32 v13, v13, v155
    v_sub_f32 v14, v14, v155
    v_sub_f32 v15, v15, v155
    v_sub_f32 v100, 0, v155
    v_sub_f32 v101, 0, v155
    v_sub_f32 v102, 0, v155
    v_sub_f32 v103, 0, v155
    v_exp_f32 v8, v8
    v_exp_f32 v9, v9
    v_exp_f32 v10, v10
    v_cvt_pk_bf16_f32 v8, v8, v9
    v_exp_f32 v11, v11
    v_exp_f32 v12, v12
    v_cvt_pk_bf16_f32 v9, v10, v11
    v_exp_f32 v13, v13
    v_exp_f32 v14, v14
    v_cvt_pk_bf16_f32 v10, v12, v13
    v_exp_f32 v15, v15
    s_nop 0
    v_cvt_pk_bf16_f32 v11, v14, v15
    s_waitcnt lgkmcnt(0)
    v_lshlrev_b32 v76, 16, v192
    v_and_b32 v77, 0xffff0000, v192
    v_lshlrev_b32 v78, 16, v193
    v_and_b32 v79, 0xffff0000, v193
    v_lshlrev_b32 v80, 16, v194
    v_and_b32 v81, 0xffff0000, v194
    v_lshlrev_b32 v82, 16, v195
    v_and_b32 v83, 0xffff0000, v195
    v_pk_mul_f32 v[76:77], v[76:77], s[38:39] op_sel_hi:[1,0]
    v_pk_mul_f32 v[78:79], v[78:79], s[38:39] op_sel_hi:[1,0]
    v_pk_mul_f32 v[80:81], v[80:81], s[38:39] op_sel_hi:[1,0]
    v_pk_mul_f32 v[82:83], v[82:83], s[38:39] op_sel_hi:[1,0]
    v_cvt_pk_bf16_f32 v192, v76, v77
    v_cvt_pk_bf16_f32 v193, v78, v79
    v_cvt_pk_bf16_f32 v194, v80, v81
    v_cvt_pk_bf16_f32 v195, v82, v83
    v_lshlrev_b32 v76, 16, v196
    v_and_b32 v77, 0xffff0000, v196
    v_lshlrev_b32 v78, 16, v197
    v_and_b32 v79, 0xffff0000, v197
    v_lshlrev_b32 v80, 16, v198
    v_and_b32 v81, 0xffff0000, v198
    v_lshlrev_b32 v82, 16, v199
    v_and_b32 v83, 0xffff0000, v199
    v_pk_mul_f32 v[76:77], v[76:77], s[38:39] op_sel_hi:[1,0]
    v_pk_mul_f32 v[78:79], v[78:79], s[38:39] op_sel_hi:[1,0]
    v_pk_mul_f32 v[80:81], v[80:81], s[38:39] op_sel_hi:[1,0]
    v_pk_mul_f32 v[82:83], v[82:83], s[38:39] op_sel_hi:[1,0]
    v_cvt_pk_bf16_f32 v196, v76, v77
    v_cvt_pk_bf16_f32 v197, v78, v79
    v_cvt_pk_bf16_f32 v198, v80, v81
    v_cvt_pk_bf16_f32 v199, v82, v83
    v_lshlrev_b32 v76, 16, v200
    v_and_b32 v77, 0xffff0000, v200
    v_lshlrev_b32 v78, 16, v201
    v_and_b32 v79, 0xffff0000, v201
    v_lshlrev_b32 v80, 16, v202
    v_and_b32 v81, 0xffff0000, v202
    v_lshlrev_b32 v82, 16, v203
    v_and_b32 v83, 0xffff0000, v203
    v_pk_mul_f32 v[76:77], v[76:77], s[38:39] op_sel_hi:[1,0]
    v_pk_mul_f32 v[78:79], v[78:79], s[38:39] op_sel_hi:[1,0]
    v_pk_mul_f32 v[80:81], v[80:81], s[38:39] op_sel_hi:[1,0]
    v_pk_mul_f32 v[82:83], v[82:83], s[38:39] op_sel_hi:[1,0]
    v_cvt_pk_bf16_f32 v200, v76, v77
    v_cvt_pk_bf16_f32 v201, v78, v79
    v_cvt_pk_bf16_f32 v202, v80, v81
    v_cvt_pk_bf16_f32 v203, v82, v83
    v_lshlrev_b32 v76, 16, v204
    v_and_b32 v77, 0xffff0000, v204
    v_lshlrev_b32 v78, 16, v205
    v_and_b32 v79, 0xffff0000, v205
    v_lshlrev_b32 v80, 16, v206
    v_and_b32 v81, 0xffff0000, v206
    v_lshlrev_b32 v82, 16, v207
    v_and_b32 v83, 0xffff0000, v207
    v_pk_mul_f32 v[76:77], v[76:77], s[38:39] op_sel_hi:[1,0]
    v_pk_mul_f32 v[78:79], v[78:79], s[38:39] op_sel_hi:[1,0]
    v_pk_mul_f32 v[80:81], v[80:81], s[38:39] op_sel_hi:[1,0]
    v_pk_mul_f32 v[82:83], v[82:83], s[38:39] op_sel_hi:[1,0]
    v_cvt_pk_bf16_f32 v204, v76, v77
    v_cvt_pk_bf16_f32 v205, v78, v79
    v_cvt_pk_bf16_f32 v206, v80, v81
    v_cvt_pk_bf16_f32 v207, v82, v83
    s_waitcnt lgkmcnt(0)
    s_nop 0
    v_mfma_f32_16x16x32_bf16 v[16:19], a[192:195], v[192:195], 0
    v_mfma_f32_16x16x32_bf16 v[16:19], a[196:199], v[196:199], v[16:19]
    v_mfma_f32_16x16x32_bf16 v[16:19], a[200:203], v[200:203], v[16:19]
    v_mfma_f32_16x16x32_bf16 v[16:19], a[204:207], v[204:207], v[16:19]
    v_mfma_f32_16x16x32_bf16 v[20:23], a[220:223], v[204:207], 0
    v_mfma_f32_16x16x32_bf16 v[20:23], a[216:219], v[200:203], v[20:23]
    v_mfma_f32_16x16x32_bf16 v[20:23], a[212:215], v[196:199], v[20:23]
    v_mfma_f32_16x16x32_bf16 v[20:23], a[208:211], v[192:195], v[20:23]
    s_waitcnt vmcnt(4)
    s_add_u32 m0, s32, 73728
    s_add_u32 s35, s34, 20480
    buffer_load_dwordx4 v152, s[12:15], s35 offen nt lds
    buffer_load_dwordx4 v153, s[12:15], s35 offen offset:1024 nt lds
    buffer_load_dwordx4 v152, s[12:15], s35 offen offset:2048 nt lds
    buffer_load_dwordx4 v153, s[12:15], s35 offen offset:3072 nt lds
    ds_read_b128 v[208:211], v72 offset:49152
    ds_read_b128 v[212:215], v73 offset:49152
    ds_read_b128 v[216:219], v74 offset:49152
    ds_read_b128 v[220:223], v75 offset:49152
    s_nop 2
    v_max3_f32 v155, v16, v17, v18
    v_max3_f32 v155, v155, v19, v20
    v_max3_f32 v155, v155, v21, v22
    v_max_f32 v155, v155, v23
    v_mov_b32 v156, v155
    s_nop 1
    v_permlane16_swap_b32 v155, v156
    v_max_f32 v155, v155, v156
    v_mov_b32 v156, v155
    s_nop 1
    v_permlane32_swap_b32 v155, v156
    v_max_f32 v155, v155, v156
    v_sub_f32 v16, v16, v155
    v_sub_f32 v17, v17, v155
    v_sub_f32 v18, v18, v155
    v_sub_f32 v19, v19, v155
    v_sub_f32 v20, v20, v155
    v_sub_f32 v21, v21, v155
    v_sub_f32 v22, v22, v155
    v_sub_f32 v23, v23, v155
    v_sub_f32 v104, 0, v155
    v_sub_f32 v105, 0, v155
    v_sub_f32 v106, 0, v155
    v_sub_f32 v107, 0, v155
    v_exp_f32 v16, v16
    v_exp_f32 v17, v17
    v_exp_f32 v18, v18
    v_cvt_pk_bf16_f32 v16, v16, v17
    v_exp_f32 v19, v19
    v_exp_f32 v20, v20
    v_cvt_pk_bf16_f32 v17, v18, v19
    v_exp_f32 v21, v21
    v_exp_f32 v22, v22
    v_cvt_pk_bf16_f32 v18, v20, v21
    v_exp_f32 v23, v23
    s_nop 0
    v_cvt_pk_bf16_f32 v19, v22, v23
    s_waitcnt lgkmcnt(0)
    v_lshlrev_b32 v76, 16, v208
    v_and_b32 v77, 0xffff0000, v208
    v_lshlrev_b32 v78, 16, v209
    v_and_b32 v79, 0xffff0000, v209
    v_lshlrev_b32 v80, 16, v210
    v_and_b32 v81, 0xffff0000, v210
    v_lshlrev_b32 v82, 16, v211
    v_and_b32 v83, 0xffff0000, v211
    v_pk_mul_f32 v[76:77], v[76:77], s[38:39] op_sel_hi:[1,0]
    v_pk_mul_f32 v[78:79], v[78:79], s[38:39] op_sel_hi:[1,0]
    v_pk_mul_f32 v[80:81], v[80:81], s[38:39] op_sel_hi:[1,0]
    v_pk_mul_f32 v[82:83], v[82:83], s[38:39] op_sel_hi:[1,0]
    v_cvt_pk_bf16_f32 v208, v76, v77
    v_cvt_pk_bf16_f32 v209, v78, v79
    v_cvt_pk_bf16_f32 v210, v80, v81
    v_cvt_pk_bf16_f32 v211, v82, v83
    v_lshlrev_b32 v76, 16, v212
    v_and_b32 v77, 0xffff0000, v212
    v_lshlrev_b32 v78, 16, v213
    v_and_b32 v79, 0xffff0000, v213
    v_lshlrev_b32 v80, 16, v214
    v_and_b32 v81, 0xffff0000, v214
    v_lshlrev_b32 v82, 16, v215
    v_and_b32 v83, 0xffff0000, v215
    v_pk_mul_f32 v[76:77], v[76:77], s[38:39] op_sel_hi:[1,0]
    v_pk_mul_f32 v[78:79], v[78:79], s[38:39] op_sel_hi:[1,0]
    v_pk_mul_f32 v[80:81], v[80:81], s[38:39] op_sel_hi:[1,0]
    v_pk_mul_f32 v[82:83], v[82:83], s[38:39] op_sel_hi:[1,0]
    v_cvt_pk_bf16_f32 v212, v76, v77
    v_cvt_pk_bf16_f32 v213, v78, v79
    v_cvt_pk_bf16_f32 v214, v80, v81
    v_cvt_pk_bf16_f32 v215, v82, v83
    v_lshlrev_b32 v76, 16, v216
    v_and_b32 v77, 0xffff0000, v216
    v_lshlrev_b32 v78, 16, v217
    v_and_b32 v79, 0xffff0000, v217
    v_lshlrev_b32 v80, 16, v218
    v_and_b32 v81, 0xffff0000, v218
    v_lshlrev_b32 v82, 16, v219
    v_and_b32 v83, 0xffff0000, v219
    v_pk_mul_f32 v[76:77], v[76:77], s[38:39] op_sel_hi:[1,0]
    v_pk_mul_f32 v[78:79], v[78:79], s[38:39] op_sel_hi:[1,0]
    v_pk_mul_f32 v[80:81], v[80:81], s[38:39] op_sel_hi:[1,0]
    v_pk_mul_f32 v[82:83], v[82:83], s[38:39] op_sel_hi:[1,0]
    v_cvt_pk_bf16_f32 v216, v76, v77
    v_cvt_pk_bf16_f32 v217, v78, v79
    v_cvt_pk_bf16_f32 v218, v80, v81
    v_cvt_pk_bf16_f32 v219, v82, v83
    v_lshlrev_b32 v76, 16, v220
    v_and_b32 v77, 0xffff0000, v220
    v_lshlrev_b32 v78, 16, v221
    v_and_b32 v79, 0xffff0000, v221
    v_lshlrev_b32 v80, 16, v222
    v_and_b32 v81, 0xffff0000, v222
    v_lshlrev_b32 v82, 16, v223
    v_and_b32 v83, 0xffff0000, v223
    v_pk_mul_f32 v[76:77], v[76:77], s[38:39] op_sel_hi:[1,0]
    v_pk_mul_f32 v[78:79], v[78:79], s[38:39] op_sel_hi:[1,0]
    v_pk_mul_f32 v[80:81], v[80:81], s[38:39] op_sel_hi:[1,0]
    v_pk_mul_f32 v[82:83], v[82:83], s[38:39] op_sel_hi:[1,0]
    v_cvt_pk_bf16_f32 v220, v76, v77
    v_cvt_pk_bf16_f32 v221, v78, v79
    v_cvt_pk_bf16_f32 v222, v80, v81
    v_cvt_pk_bf16_f32 v223, v82, v83
    s_waitcnt lgkmcnt(0)
    s_nop 0
    v_mfma_f32_16x16x32_bf16 v[24:27], a[192:195], v[208:211], 0
    v_mfma_f32_16x16x32_bf16 v[24:27], a[196:199], v[212:215], v[24:27]
    v_mfma_f32_16x16x32_bf16 v[24:27], a[200:203], v[216:219], v[24:27]
    v_mfma_f32_16x16x32_bf16 v[24:27], a[204:207], v[220:223], v[24:27]
    v_mfma_f32_16x16x32_bf16 v[28:31], a[220:223], v[220:223], 0
    v_mfma_f32_16x16x32_bf16 v[28:31], a[216:219], v[216:219], v[28:31]
    v_mfma_f32_16x16x32_bf16 v[28:31], a[212:215], v[212:215], v[28:31]
    v_mfma_f32_16x16x32_bf16 v[28:31], a[208:211], v[208:211], v[28:31]
    s_waitcnt vmcnt(4)
    s_add_u32 m0, s32, 40960
    s_nop 0
    buffer_load_dwordx4 v154, s[20:23], s31 offen nt lds
    buffer_load_dwordx4 v154, s[20:23], s31 offen offset:1024 nt lds
    buffer_load_dwordx4 v154, s[20:23], s31 offen offset:2048 nt lds
    buffer_load_dwordx4 v154, s[20:23], s31 offen offset:3072 nt lds
    s_add_u32 s31, s31, 8192
    ds_read_b128 v[224:227], v72 offset:16384
    ds_read_b128 v[228:231], v73 offset:16384
    ds_read_b128 v[232:235], v74 offset:16384
    ds_read_b128 v[236:239], v75 offset:16384
    s_nop 2
    v_max3_f32 v155, v24, v25, v26
    v_max3_f32 v155, v155, v27, v28
    v_max3_f32 v155, v155, v29, v30
    v_max_f32 v155, v155, v31
    v_mov_b32 v156, v155
    s_nop 1
    v_permlane16_swap_b32 v155, v156
    v_max_f32 v155, v155, v156
    v_mov_b32 v156, v155
    s_nop 1
    v_permlane32_swap_b32 v155, v156
    v_max_f32 v155, v155, v156
    v_sub_f32 v24, v24, v155
    v_sub_f32 v25, v25, v155
    v_sub_f32 v26, v26, v155
    v_sub_f32 v27, v27, v155
    v_sub_f32 v28, v28, v155
    v_sub_f32 v29, v29, v155
    v_sub_f32 v30, v30, v155
    v_sub_f32 v31, v31, v155
    v_sub_f32 v108, 0, v155
    v_sub_f32 v109, 0, v155
    v_sub_f32 v110, 0, v155
    v_sub_f32 v111, 0, v155
    v_exp_f32 v24, v24
    v_exp_f32 v25, v25
    v_exp_f32 v26, v26
    v_cvt_pk_bf16_f32 v24, v24, v25
    v_exp_f32 v27, v27
    v_exp_f32 v28, v28
    v_cvt_pk_bf16_f32 v25, v26, v27
    v_exp_f32 v29, v29
    v_exp_f32 v30, v30
    v_cvt_pk_bf16_f32 v26, v28, v29
    v_exp_f32 v31, v31
    s_nop 0
    v_cvt_pk_bf16_f32 v27, v30, v31
    s_waitcnt lgkmcnt(0)
    v_lshlrev_b32 v76, 16, v224
    v_and_b32 v77, 0xffff0000, v224
    v_lshlrev_b32 v78, 16, v225
    v_and_b32 v79, 0xffff0000, v225
    v_lshlrev_b32 v80, 16, v226
    v_and_b32 v81, 0xffff0000, v226
    v_lshlrev_b32 v82, 16, v227
    v_and_b32 v83, 0xffff0000, v227
    v_pk_mul_f32 v[76:77], v[76:77], s[38:39] op_sel_hi:[1,0]
    v_pk_mul_f32 v[78:79], v[78:79], s[38:39] op_sel_hi:[1,0]
    v_pk_mul_f32 v[80:81], v[80:81], s[38:39] op_sel_hi:[1,0]
    v_pk_mul_f32 v[82:83], v[82:83], s[38:39] op_sel_hi:[1,0]
    v_cvt_pk_bf16_f32 v224, v76, v77
    v_cvt_pk_bf16_f32 v225, v78, v79
    v_cvt_pk_bf16_f32 v226, v80, v81
    v_cvt_pk_bf16_f32 v227, v82, v83
    v_lshlrev_b32 v76, 16, v228
    v_and_b32 v77, 0xffff0000, v228
    v_lshlrev_b32 v78, 16, v229
    v_and_b32 v79, 0xffff0000, v229
    v_lshlrev_b32 v80, 16, v230
    v_and_b32 v81, 0xffff0000, v230
    v_lshlrev_b32 v82, 16, v231
    v_and_b32 v83, 0xffff0000, v231
    v_pk_mul_f32 v[76:77], v[76:77], s[38:39] op_sel_hi:[1,0]
    v_pk_mul_f32 v[78:79], v[78:79], s[38:39] op_sel_hi:[1,0]
    v_pk_mul_f32 v[80:81], v[80:81], s[38:39] op_sel_hi:[1,0]
    v_pk_mul_f32 v[82:83], v[82:83], s[38:39] op_sel_hi:[1,0]
    v_cvt_pk_bf16_f32 v228, v76, v77
    v_cvt_pk_bf16_f32 v229, v78, v79
    v_cvt_pk_bf16_f32 v230, v80, v81
    v_cvt_pk_bf16_f32 v231, v82, v83
    v_lshlrev_b32 v76, 16, v232
    v_and_b32 v77, 0xffff0000, v232
    v_lshlrev_b32 v78, 16, v233
    v_and_b32 v79, 0xffff0000, v233
    v_lshlrev_b32 v80, 16, v234
    v_and_b32 v81, 0xffff0000, v234
    v_lshlrev_b32 v82, 16, v235
    v_and_b32 v83, 0xffff0000, v235
    v_pk_mul_f32 v[76:77], v[76:77], s[38:39] op_sel_hi:[1,0]
    v_pk_mul_f32 v[78:79], v[78:79], s[38:39] op_sel_hi:[1,0]
    v_pk_mul_f32 v[80:81], v[80:81], s[38:39] op_sel_hi:[1,0]
    v_pk_mul_f32 v[82:83], v[82:83], s[38:39] op_sel_hi:[1,0]
    v_cvt_pk_bf16_f32 v232, v76, v77
    v_cvt_pk_bf16_f32 v233, v78, v79
    v_cvt_pk_bf16_f32 v234, v80, v81
    v_cvt_pk_bf16_f32 v235, v82, v83
    v_lshlrev_b32 v76, 16, v236
    v_and_b32 v77, 0xffff0000, v236
    v_lshlrev_b32 v78, 16, v237
    v_and_b32 v79, 0xffff0000, v237
    v_lshlrev_b32 v80, 16, v238
    v_and_b32 v81, 0xffff0000, v238
    v_lshlrev_b32 v82, 16, v239
    v_and_b32 v83, 0xffff0000, v239
    v_pk_mul_f32 v[76:77], v[76:77], s[38:39] op_sel_hi:[1,0]
    v_pk_mul_f32 v[78:79], v[78:79], s[38:39] op_sel_hi:[1,0]
    v_pk_mul_f32 v[80:81], v[80:81], s[38:39] op_sel_hi:[1,0]
    v_pk_mul_f32 v[82:83], v[82:83], s[38:39] op_sel_hi:[1,0]
    v_cvt_pk_bf16_f32 v236, v76, v77
    v_cvt_pk_bf16_f32 v237, v78, v79
    v_cvt_pk_bf16_f32 v238, v80, v81
    v_cvt_pk_bf16_f32 v239, v82, v83
    s_waitcnt lgkmcnt(0)
    s_nop 0
    v_mfma_f32_16x16x32_bf16 v[32:35], a[192:195], v[224:227], 0
    v_mfma_f32_16x16x32_bf16 v[32:35], a[196:199], v[228:231], v[32:35]
    v_mfma_f32_16x16x32_bf16 v[32:35], a[200:203], v[232:235], v[32:35]
    v_mfma_f32_16x16x32_bf16 v[32:35], a[204:207], v[236:239], v[32:35]
    v_mfma_f32_16x16x32_bf16 v[36:39], a[220:223], v[236:239], 0
    v_mfma_f32_16x16x32_bf16 v[36:39], a[216:219], v[232:235], v[36:39]
    v_mfma_f32_16x16x32_bf16 v[36:39], a[212:215], v[228:231], v[36:39]
    v_mfma_f32_16x16x32_bf16 v[36:39], a[208:211], v[224:227], v[36:39]
    s_waitcnt vmcnt(4)
    s_add_u32 m0, s32, 8192
    s_nop 0
    buffer_load_dwordx4 v152, s[16:19], s30 offen nt lds
    buffer_load_dwordx4 v153, s[16:19], s30 offen offset:1024 nt lds
    buffer_load_dwordx4 v152, s[16:19], s30 offen offset:2048 nt lds
    buffer_load_dwordx4 v153, s[16:19], s30 offen offset:3072 nt lds
    s_add_u32 s30, s30, 8192
    ds_read_b128 v[240:243], v72 offset:57344
    ds_read_b128 v[244:247], v73 offset:57344
    ds_read_b128 v[248:251], v74 offset:57344
    ds_read_b128 v[252:255], v75 offset:57344
    s_nop 2
    v_max3_f32 v155, v32, v33, v34
    v_max3_f32 v155, v155, v35, v36
    v_max3_f32 v155, v155, v37, v38
    v_max_f32 v155, v155, v39
    v_mov_b32 v156, v155
    s_nop 1
    v_permlane16_swap_b32 v155, v156
    v_max_f32 v155, v155, v156
    v_mov_b32 v156, v155
    s_nop 1
    v_permlane32_swap_b32 v155, v156
    v_max_f32 v155, v155, v156
    v_sub_f32 v32, v32, v155
    v_sub_f32 v33, v33, v155
    v_sub_f32 v34, v34, v155
    v_sub_f32 v35, v35, v155
    v_sub_f32 v36, v36, v155
    v_sub_f32 v37, v37, v155
    v_sub_f32 v38, v38, v155
    v_sub_f32 v39, v39, v155
    v_sub_f32 v112, 0, v155
    v_sub_f32 v113, 0, v155
    v_sub_f32 v114, 0, v155
    v_sub_f32 v115, 0, v155
    v_exp_f32 v32, v32
    v_exp_f32 v33, v33
    v_exp_f32 v34, v34
    v_cvt_pk_bf16_f32 v32, v32, v33
    v_exp_f32 v35, v35
    v_exp_f32 v36, v36
    v_cvt_pk_bf16_f32 v33, v34, v35
    v_exp_f32 v37, v37
    v_exp_f32 v38, v38
    v_cvt_pk_bf16_f32 v34, v36, v37
    v_exp_f32 v39, v39
    s_nop 0
    v_cvt_pk_bf16_f32 v35, v38, v39
    s_waitcnt lgkmcnt(0)
    v_lshlrev_b32 v76, 16, v240
    v_and_b32 v77, 0xffff0000, v240
    v_lshlrev_b32 v78, 16, v241
    v_and_b32 v79, 0xffff0000, v241
    v_lshlrev_b32 v80, 16, v242
    v_and_b32 v81, 0xffff0000, v242
    v_lshlrev_b32 v82, 16, v243
    v_and_b32 v83, 0xffff0000, v243
    v_pk_mul_f32 v[76:77], v[76:77], s[38:39] op_sel_hi:[1,0]
    v_pk_mul_f32 v[78:79], v[78:79], s[38:39] op_sel_hi:[1,0]
    v_pk_mul_f32 v[80:81], v[80:81], s[38:39] op_sel_hi:[1,0]
    v_pk_mul_f32 v[82:83], v[82:83], s[38:39] op_sel_hi:[1,0]
    v_cvt_pk_bf16_f32 v240, v76, v77
    v_cvt_pk_bf16_f32 v241, v78, v79
    v_cvt_pk_bf16_f32 v242, v80, v81
    v_cvt_pk_bf16_f32 v243, v82, v83
    v_lshlrev_b32 v76, 16, v244
    v_and_b32 v77, 0xffff0000, v244
    v_lshlrev_b32 v78, 16, v245
    v_and_b32 v79, 0xffff0000, v245
    v_lshlrev_b32 v80, 16, v246
    v_and_b32 v81, 0xffff0000, v246
    v_lshlrev_b32 v82, 16, v247
    v_and_b32 v83, 0xffff0000, v247
    v_pk_mul_f32 v[76:77], v[76:77], s[38:39] op_sel_hi:[1,0]
    v_pk_mul_f32 v[78:79], v[78:79], s[38:39] op_sel_hi:[1,0]
    v_pk_mul_f32 v[80:81], v[80:81], s[38:39] op_sel_hi:[1,0]
    v_pk_mul_f32 v[82:83], v[82:83], s[38:39] op_sel_hi:[1,0]
    v_cvt_pk_bf16_f32 v244, v76, v77
    v_cvt_pk_bf16_f32 v245, v78, v79
    v_cvt_pk_bf16_f32 v246, v80, v81
    v_cvt_pk_bf16_f32 v247, v82, v83
    v_lshlrev_b32 v76, 16, v248
    v_and_b32 v77, 0xffff0000, v248
    v_lshlrev_b32 v78, 16, v249
    v_and_b32 v79, 0xffff0000, v249
    v_lshlrev_b32 v80, 16, v250
    v_and_b32 v81, 0xffff0000, v250
    v_lshlrev_b32 v82, 16, v251
    v_and_b32 v83, 0xffff0000, v251
    v_pk_mul_f32 v[76:77], v[76:77], s[38:39] op_sel_hi:[1,0]
    v_pk_mul_f32 v[78:79], v[78:79], s[38:39] op_sel_hi:[1,0]
    v_pk_mul_f32 v[80:81], v[80:81], s[38:39] op_sel_hi:[1,0]
    v_pk_mul_f32 v[82:83], v[82:83], s[38:39] op_sel_hi:[1,0]
    v_cvt_pk_bf16_f32 v248, v76, v77
    v_cvt_pk_bf16_f32 v249, v78, v79
    v_cvt_pk_bf16_f32 v250, v80, v81
    v_cvt_pk_bf16_f32 v251, v82, v83
    v_lshlrev_b32 v76, 16, v252
    v_and_b32 v77, 0xffff0000, v252
    v_lshlrev_b32 v78, 16, v253
    v_and_b32 v79, 0xffff0000, v253
    v_lshlrev_b32 v80, 16, v254
    v_and_b32 v81, 0xffff0000, v254
    v_lshlrev_b32 v82, 16, v255
    v_and_b32 v83, 0xffff0000, v255
    v_pk_mul_f32 v[76:77], v[76:77], s[38:39] op_sel_hi:[1,0]
    v_pk_mul_f32 v[78:79], v[78:79], s[38:39] op_sel_hi:[1,0]
    v_pk_mul_f32 v[80:81], v[80:81], s[38:39] op_sel_hi:[1,0]
    v_pk_mul_f32 v[82:83], v[82:83], s[38:39] op_sel_hi:[1,0]
    v_cvt_pk_bf16_f32 v252, v76, v77
    v_cvt_pk_bf16_f32 v253, v78, v79
    v_cvt_pk_bf16_f32 v254, v80, v81
    v_cvt_pk_bf16_f32 v255, v82, v83
    s_waitcnt lgkmcnt(0)
    s_nop 0
    v_mfma_f32_16x16x32_bf16 v[40:43], a[192:195], v[240:243], 0
    v_mfma_f32_16x16x32_bf16 v[40:43], a[196:199], v[244:247], v[40:43]
    v_mfma_f32_16x16x32_bf16 v[40:43], a[200:203], v[248:251], v[40:43]
    v_mfma_f32_16x16x32_bf16 v[40:43], a[204:207], v[252:255], v[40:43]
    v_mfma_f32_16x16x32_bf16 v[44:47], a[220:223], v[252:255], 0
    v_mfma_f32_16x16x32_bf16 v[44:47], a[216:219], v[248:251], v[44:47]
    v_mfma_f32_16x16x32_bf16 v[44:47], a[212:215], v[244:247], v[44:47]
    v_mfma_f32_16x16x32_bf16 v[44:47], a[208:211], v[240:243], v[44:47]
    s_waitcnt vmcnt(4)
    s_add_u32 m0, s32, 49152
    s_nop 0
    buffer_load_dwordx4 v154, s[20:23], s31 offen nt lds
    buffer_load_dwordx4 v154, s[20:23], s31 offen offset:1024 nt lds
    buffer_load_dwordx4 v154, s[20:23], s31 offen offset:2048 nt lds
    buffer_load_dwordx4 v154, s[20:23], s31 offen offset:3072 nt lds
    s_add_u32 s31, s31, 8192
    s_barrier
    ds_read_b64_tr_b16 a[224:225], v148
    ds_read_b64_tr_b16 a[226:227], v148 offset:4096
    ds_read_b64_tr_b16 a[228:229], v148 offset:32
    ds_read_b64_tr_b16 a[230:231], v148 offset:4128
    ds_read_b64_tr_b16 a[232:233], v149
    ds_read_b64_tr_b16 a[234:235], v149 offset:4096
    ds_read_b64_tr_b16 a[236:237], v149 offset:32
    ds_read_b64_tr_b16 a[238:239], v149 offset:4128
    ds_read_b64_tr_b16 a[240:241], v150
    ds_read_b64_tr_b16 a[242:243], v150 offset:4096
    ds_read_b64_tr_b16 a[244:245], v150 offset:32
    ds_read_b64_tr_b16 a[246:247], v150 offset:4128
    s_waitcnt lgkmcnt(6)
    ds_read_b64_tr_b16 a[248:249], v151
    ds_read_b64_tr_b16 a[250:251], v151 offset:4096
    ds_read_b64_tr_b16 a[252:253], v151 offset:32
    ds_read_b64_tr_b16 a[254:255], v151 offset:4128
    v_max3_f32 v155, v40, v41, v42
    v_max3_f32 v155, v155, v43, v44
    v_max3_f32 v155, v155, v45, v46
    v_max_f32 v155, v155, v47
    v_mov_b32 v156, v155
    s_nop 1
    v_permlane16_swap_b32 v155, v156
    v_max_f32 v155, v155, v156
    v_mov_b32 v156, v155
    s_nop 1
    v_permlane32_swap_b32 v155, v156
    v_max_f32 v155, v155, v156
    v_sub_f32 v40, v40, v155
    v_sub_f32 v41, v41, v155
    v_sub_f32 v42, v42, v155
    v_sub_f32 v43, v43, v155
    v_sub_f32 v44, v44, v155
    v_sub_f32 v45, v45, v155
    v_sub_f32 v46, v46, v155
    v_sub_f32 v47, v47, v155
    v_sub_f32 v116, 0, v155
    v_sub_f32 v117, 0, v155
    v_sub_f32 v118, 0, v155
    v_sub_f32 v119, 0, v155
    v_exp_f32 v40, v40
    v_exp_f32 v41, v41
    v_exp_f32 v42, v42
    v_cvt_pk_bf16_f32 v40, v40, v41
    v_exp_f32 v43, v43
    v_exp_f32 v44, v44
    v_cvt_pk_bf16_f32 v41, v42, v43
    v_exp_f32 v45, v45
    v_exp_f32 v46, v46
    v_cvt_pk_bf16_f32 v42, v44, v45
    v_exp_f32 v47, v47
    s_nop 0
    v_cvt_pk_bf16_f32 v43, v46, v47
    s_waitcnt lgkmcnt(0)
    s_nop 0
    v_mfma_f32_16x16x32_bf16 a[160:163], a[224:227], v[40:43], 0
    s_add_u32 m0, s32, 16384
    v_mfma_f32_16x16x32_bf16 a[128:131], a[224:227], v[32:35], 0
    v_mfma_f32_16x16x32_bf16 a[96:99], a[224:227], v[24:27], 0
    v_mfma_f32_16x16x32_bf16 a[64:67], a[224:227], v[16:19], 0
    v_mfma_f32_16x16x32_bf16 a[32:35], a[224:227], v[8:11], 0
    buffer_load_dwordx4 v152, s[16:19], s30 offen nt lds
    v_mfma_f32_16x16x32_bf16 a[0:3], a[224:227], v[0:3], 0
    v_mfma_f32_16x16x32_bf16 a[4:7], a[228:231], v[0:3], 0
    v_mfma_f32_16x16x32_bf16 a[36:39], a[228:231], v[8:11], 0
    v_mfma_f32_16x16x32_bf16 a[68:71], a[228:231], v[16:19], 0
    buffer_load_dwordx4 v153, s[16:19], s30 offen offset:1024 nt lds
    v_mfma_f32_16x16x32_bf16 a[100:103], a[228:231], v[24:27], 0
    v_mfma_f32_16x16x32_bf16 a[132:135], a[228:231], v[32:35], 0
    v_mfma_f32_16x16x32_bf16 a[164:167], a[228:231], v[40:43], 0
    v_mfma_f32_16x16x32_bf16 a[168:171], a[232:235], v[40:43], 0
    buffer_load_dwordx4 v152, s[16:19], s30 offen offset:2048 nt lds
    v_mfma_f32_16x16x32_bf16 a[136:139], a[232:235], v[32:35], 0
    v_mfma_f32_16x16x32_bf16 a[104:107], a[232:235], v[24:27], 0
    v_mfma_f32_16x16x32_bf16 a[72:75], a[232:235], v[16:19], 0
    v_mfma_f32_16x16x32_bf16 a[40:43], a[232:235], v[8:11], 0
    buffer_load_dwordx4 v153, s[16:19], s30 offen offset:3072 nt lds
    v_mfma_f32_16x16x32_bf16 a[8:11], a[232:235], v[0:3], 0
    s_add_u32 s30, s30, 8192
    v_mfma_f32_16x16x32_bf16 a[12:15], a[236:239], v[0:3], 0
    v_mfma_f32_16x16x32_bf16 a[44:47], a[236:239], v[8:11], 0
    v_mfma_f32_16x16x32_bf16 a[76:79], a[236:239], v[16:19], 0
    v_mfma_f32_16x16x32_bf16 a[108:111], a[236:239], v[24:27], 0
    v_mfma_f32_16x16x32_bf16 a[140:143], a[236:239], v[32:35], 0
    v_mfma_f32_16x16x32_bf16 a[172:175], a[236:239], v[40:43], 0
    s_waitcnt vmcnt(8)
    s_barrier
    v_mfma_f32_16x16x32_bf16 a[176:179], a[240:243], v[40:43], 0
    ds_read_b128 a[192:195], v144 offset:8192
    ds_read_b128 a[196:199], v145 offset:8192
    v_mfma_f32_16x16x32_bf16 a[144:147], a[240:243], v[32:35], 0
    ds_read_b128 a[200:203], v146 offset:8192
    ds_read_b128 a[204:207], v147 offset:8192
    v_mfma_f32_16x16x32_bf16 a[112:115], a[240:243], v[24:27], 0
    ds_read_b128 a[208:211], v144 offset:12288
    ds_read_b128 a[212:215], v145 offset:12288
    v_mfma_f32_16x16x32_bf16 a[80:83], a[240:243], v[16:19], 0
    ds_read_b128 a[216:219], v146 offset:12288
    ds_read_b128 a[220:223], v147 offset:12288
    v_mfma_f32_16x16x32_bf16 a[48:51], a[240:243], v[8:11], 0
    s_add_u32 m0, s32, 57344
    v_mfma_f32_16x16x32_bf16 a[16:19], a[240:243], v[0:3], 0
    v_mfma_f32_16x16x32_bf16 a[20:23], a[244:247], v[0:3], 0
    v_mfma_f32_16x16x32_bf16 a[52:55], a[244:247], v[8:11], 0
    v_mfma_f32_16x16x32_bf16 a[84:87], a[244:247], v[16:19], 0
    v_mfma_f32_16x16x32_bf16 a[116:119], a[244:247], v[24:27], 0
    v_mfma_f32_16x16x32_bf16 a[148:151], a[244:247], v[32:35], 0
    v_mfma_f32_16x16x32_bf16 a[180:183], a[244:247], v[40:43], 0
    v_mfma_f32_16x16x32_bf16 a[184:187], a[248:251], v[40:43], 0
    v_mfma_f32_16x16x32_bf16 a[152:155], a[248:251], v[32:35], 0
    v_mfma_f32_16x16x32_bf16 a[120:123], a[248:251], v[24:27], 0
    v_mfma_f32_16x16x32_bf16 a[88:91], a[248:251], v[16:19], 0
    v_mfma_f32_16x16x32_bf16 a[56:59], a[248:251], v[8:11], 0
    buffer_load_dwordx4 v154, s[20:23], s31 offen nt lds
    v_mfma_f32_16x16x32_bf16 a[24:27], a[248:251], v[0:3], 0
    v_mfma_f32_16x16x32_bf16 a[28:31], a[252:255], v[0:3], 0
    v_mfma_f32_16x16x32_bf16 a[60:63], a[252:255], v[8:11], 0
    v_mfma_f32_16x16x32_bf16 a[92:95], a[252:255], v[16:19], 0
    buffer_load_dwordx4 v154, s[20:23], s31 offen offset:1024 nt lds
    v_mfma_f32_16x16x32_bf16 a[124:127], a[252:255], v[24:27], 0
    v_mfma_f32_16x16x32_bf16 a[156:159], a[252:255], v[32:35], 0
    v_mfma_f32_16x16x32_bf16 a[188:191], a[252:255], v[40:43], 0
    v_mfma_f32_16x16x32_bf16 v[120:123], v[48:51], v[0:3], 0
    buffer_load_dwordx4 v154, s[20:23], s31 offen offset:2048 nt lds
    v_mfma_f32_16x16x32_bf16 v[124:127], v[48:51], v[8:11], 0
    v_mfma_f32_16x16x32_bf16 v[128:131], v[48:51], v[16:19], 0
    v_mfma_f32_16x16x32_bf16 v[132:135], v[48:51], v[24:27], 0
    v_mfma_f32_16x16x32_bf16 v[136:139], v[48:51], v[32:35], 0
    buffer_load_dwordx4 v154, s[20:23], s31 offen offset:3072 nt lds
    v_mfma_f32_16x16x32_bf16 v[140:143], v[48:51], v[40:43], 0
    s_add_u32 s31, s31, 8192
    s_waitcnt lgkmcnt(0)
    v_mfma_f32_16x16x32_bf16 v[0:3], a[192:195], v[160:163], v[96:99]
    v_mfma_f32_16x16x32_bf16 v[0:3], a[196:199], v[164:167], v[0:3]
    v_mfma_f32_16x16x32_bf16 v[0:3], a[200:203], v[168:171], v[0:3]
    v_mfma_f32_16x16x32_bf16 v[0:3], a[204:207], v[172:175], v[0:3]
    v_mfma_f32_16x16x32_bf16 v[8:11], a[204:207], v[188:191], v[100:103]
    v_mfma_f32_16x16x32_bf16 v[8:11], a[200:203], v[184:187], v[8:11]
    s_waitcnt vmcnt(8)
    s_barrier
    v_mfma_f32_16x16x32_bf16 v[8:11], a[196:199], v[180:183], v[8:11]
    ds_read_b64_tr_b16 a[224:225], v148 offset:8192
    ds_read_b64_tr_b16 a[226:227], v148 offset:12288
    v_mfma_f32_16x16x32_bf16 v[8:11], a[192:195], v[176:179], v[8:11]
    ds_read_b64_tr_b16 a[228:229], v148 offset:8224
    ds_read_b64_tr_b16 a[230:231], v148 offset:12320
    v_mfma_f32_16x16x32_bf16 v[16:19], a[192:195], v[192:195], v[104:107]
    ds_read_b64_tr_b16 a[232:233], v149 offset:8192
    ds_read_b64_tr_b16 a[234:235], v149 offset:12288
    v_mfma_f32_16x16x32_bf16 v[16:19], a[196:199], v[196:199], v[16:19]
    ds_read_b64_tr_b16 a[236:237], v149 offset:8224
    ds_read_b64_tr_b16 a[238:239], v149 offset:12320
    v_mfma_f32_16x16x32_bf16 v[16:19], a[200:203], v[200:203], v[16:19]
    ds_read_b64_tr_b16 a[240:241], v150 offset:8192
    ds_read_b64_tr_b16 a[242:243], v150 offset:12288
    v_mfma_f32_16x16x32_bf16 v[16:19], a[204:207], v[204:207], v[16:19]
    ds_read_b64_tr_b16 a[244:245], v150 offset:8224
    ds_read_b64_tr_b16 a[246:247], v150 offset:12320
    v_mfma_f32_16x16x32_bf16 v[24:27], a[204:207], v[220:223], v[108:111]
    ds_read_b64_tr_b16 a[248:249], v151 offset:8192
    ds_read_b64_tr_b16 a[250:251], v151 offset:12288
    v_mfma_f32_16x16x32_bf16 v[24:27], a[200:203], v[216:219], v[24:27]
    ds_read_b64_tr_b16 a[252:253], v151 offset:8224
    s_waitcnt lgkmcnt(13)
    ds_read_b64_tr_b16 a[254:255], v151 offset:12320
    v_mfma_f32_16x16x32_bf16 v[24:27], a[196:199], v[212:215], v[24:27]
    v_mfma_f32_16x16x32_bf16 v[24:27], a[192:195], v[208:211], v[24:27]
    v_mfma_f32_16x16x32_bf16 v[32:35], a[192:195], v[224:227], v[112:115]
    v_mfma_f32_16x16x32_bf16 v[32:35], a[196:199], v[228:231], v[32:35]
    v_mfma_f32_16x16x32_bf16 v[32:35], a[200:203], v[232:235], v[32:35]
    v_mfma_f32_16x16x32_bf16 v[32:35], a[204:207], v[236:239], v[32:35]
    v_mfma_f32_16x16x32_bf16 v[40:43], a[204:207], v[252:255], v[116:119]
    v_mfma_f32_16x16x32_bf16 v[40:43], a[200:203], v[248:251], v[40:43]
    v_mfma_f32_16x16x32_bf16 v[40:43], a[196:199], v[244:247], v[40:43]
    v_mfma_f32_16x16x32_bf16 v[40:43], a[192:195], v[240:243], v[40:43]
    v_mfma_f32_16x16x32_bf16 v[44:47], a[208:211], v[240:243], v[116:119]
    v_mfma_f32_16x16x32_bf16 v[44:47], a[212:215], v[244:247], v[44:47]
    v_mfma_f32_16x16x32_bf16 v[44:47], a[216:219], v[248:251], v[44:47]
    v_mfma_f32_16x16x32_bf16 v[44:47], a[220:223], v[252:255], v[44:47]
    v_mfma_f32_16x16x32_bf16 v[36:39], a[220:223], v[236:239], v[112:115]
    v_mfma_f32_16x16x32_bf16 v[36:39], a[216:219], v[232:235], v[36:39]
    v_mfma_f32_16x16x32_bf16 v[36:39], a[212:215], v[228:231], v[36:39]
    v_mfma_f32_16x16x32_bf16 v[36:39], a[208:211], v[224:227], v[36:39]
    v_mfma_f32_16x16x32_bf16 v[28:31], a[208:211], v[208:211], v[108:111]
    v_mfma_f32_16x16x32_bf16 v[28:31], a[212:215], v[212:215], v[28:31]
    v_mfma_f32_16x16x32_bf16 v[28:31], a[216:219], v[216:219], v[28:31]
    v_mfma_f32_16x16x32_bf16 v[28:31], a[220:223], v[220:223], v[28:31]
    v_mfma_f32_16x16x32_bf16 v[20:23], a[220:223], v[204:207], v[104:107]
    v_mfma_f32_16x16x32_bf16 v[20:23], a[216:219], v[200:203], v[20:23]
    v_mfma_f32_16x16x32_bf16 v[20:23], a[212:215], v[196:199], v[20:23]
    v_mfma_f32_16x16x32_bf16 v[20:23], a[208:211], v[192:195], v[20:23]
    v_mfma_f32_16x16x32_bf16 v[12:15], a[208:211], v[176:179], v[100:103]
    v_mfma_f32_16x16x32_bf16 v[12:15], a[212:215], v[180:183], v[12:15]
    v_mfma_f32_16x16x32_bf16 v[12:15], a[216:219], v[184:187], v[12:15]
    v_mfma_f32_16x16x32_bf16 v[12:15], a[220:223], v[188:191], v[12:15]
    v_mfma_f32_16x16x32_bf16 v[4:7], a[220:223], v[172:175], v[96:99]
    v_mfma_f32_16x16x32_bf16 v[4:7], a[216:219], v[168:171], v[4:7]
    v_mfma_f32_16x16x32_bf16 v[4:7], a[212:215], v[164:167], v[4:7]
    v_mfma_f32_16x16x32_bf16 v[4:7], a[208:211], v[160:163], v[4:7]
    s_nop 7
    v_max3_f32 v155, v0, v1, v2
    v_max3_f32 v155, v155, v3, v8
    v_max3_f32 v155, v155, v9, v10
    v_max3_f32 v155, v155, v11, v16
    v_max3_f32 v155, v155, v17, v18
    v_max3_f32 v155, v155, v19, v24
    v_max3_f32 v155, v155, v25, v26
    v_max3_f32 v155, v155, v27, v32
    v_max3_f32 v155, v155, v33, v34
    v_max3_f32 v155, v155, v35, v40
    v_max3_f32 v155, v155, v41, v42
    v_max3_f32 v155, v155, v43, v44
    v_max3_f32 v155, v155, v45, v46
    v_max3_f32 v155, v155, v47, v36
    v_max3_f32 v155, v155, v37, v38
    v_max3_f32 v155, v155, v39, v28
    v_max3_f32 v155, v155, v29, v30
    v_max3_f32 v155, v155, v31, v20
    v_max3_f32 v155, v155, v21, v22
    v_max3_f32 v155, v155, v23, v12
    v_max3_f32 v155, v155, v13, v14
    v_max3_f32 v155, v155, v15, v4
    v_max3_f32 v155, v155, v5, v6
    v_max_f32 v155, v155, v7
    v_cmp_lt_f32 vcc, s33, v155
    s_nop 0
    s_cbranch_vccnz L_rare0
L_back0:
    v_exp_f32 v0, v0
    v_exp_f32 v1, v1
    v_exp_f32 v2, v2
    v_cvt_pk_bf16_f32 v0, v0, v1
    v_exp_f32 v3, v3
    v_exp_f32 v4, v4
    v_cvt_pk_bf16_f32 v1, v2, v3
    v_exp_f32 v5, v5
    v_exp_f32 v6, v6
    v_cvt_pk_bf16_f32 v2, v4, v5
    v_exp_f32 v7, v7
    v_exp_f32 v8, v8
    v_cvt_pk_bf16_f32 v3, v6, v7
    v_exp_f32 v9, v9
    v_exp_f32 v10, v10
    v_cvt_pk_bf16_f32 v8, v8, v9
    v_exp_f32 v11, v11
    v_exp_f32 v12, v12
    v_cvt_pk_bf16_f32 v9, v10, v11
    v_exp_f32 v13, v13
    v_exp_f32 v14, v14
    v_cvt_pk_bf16_f32 v10, v12, v13
    v_exp_f32 v15, v15
    v_exp_f32 v16, v16
    v_cvt_pk_bf16_f32 v11, v14, v15
    v_exp_f32 v17, v17
    v_exp_f32 v18, v18
    v_cvt_pk_bf16_f32 v16, v16, v17
    v_exp_f32 v19, v19
    v_exp_f32 v20, v20
    v_cvt_pk_bf16_f32 v17, v18, v19
    v_exp_f32 v21, v21
    v_exp_f32 v22, v22
    v_cvt_pk_bf16_f32 v18, v20, v21
    v_exp_f32 v23, v23
    v_exp_f32 v24, v24
    v_cvt_pk_bf16_f32 v19, v22, v23
    v_exp_f32 v25, v25
    v_exp_f32 v26, v26
    v_cvt_pk_bf16_f32 v24, v24, v25
    v_exp_f32 v27, v27
    v_exp_f32 v28, v28
    v_cvt_pk_bf16_f32 v25, v26, v27
    v_exp_f32 v29, v29
    v_exp_f32 v30, v30
    v_cvt_pk_bf16_f32 v26, v28, v29
    v_exp_f32 v31, v31
    v_exp_f32 v32, v32
    v_cvt_pk_bf16_f32 v27, v30, v31
    v_exp_f32 v33, v33
    v_exp_f32 v34, v34
    v_cvt_pk_bf16_f32 v32, v32, v33
    v_exp_f32 v35, v35
    v_exp_f32 v36, v36
    v_cvt_pk_bf16_f32 v33, v34, v35
    v_exp_f32 v37, v37
    v_exp_f32 v38, v38
    v_cvt_pk_bf16_f32 v34, v36, v37
    v_exp_f32 v39, v39
    v_exp_f32 v40, v40
    v_cvt_pk_bf16_f32 v35, v38, v39
    v_exp_f32 v41, v41
    v_exp_f32 v42, v42
    v_cvt_pk_bf16_f32 v40, v40, v41
    v_exp_f32 v43, v43
    v_exp_f32 v44, v44
    v_cvt_pk_bf16_f32 v41, v42, v43
    v_exp_f32 v45, v45
    v_exp_f32 v46, v46
    v_cvt_pk_bf16_f32 v42, v44, v45
    v_exp_f32 v47, v47
    s_nop 0
    v_cvt_pk_bf16_f32 v43, v46, v47
    s_nop 1
    s_waitcnt lgkmcnt(0)
.p2align 6
L_loopS:
    v_mfma_f32_16x16x32_bf16 a[160:163], a[224:227], v[40:43], a[160:163]
    s_add_u32 m0, s32, 0
    v_mfma_f32_16x16x32_bf16 a[128:131], a[224:227], v[32:35], a[128:131]
    v_mfma_f32_16x16x32_bf16 a[96:99], a[224:227], v[24:27], a[96:99]
    v_mfma_f32_16x16x32_bf16 a[64:67], a[224:227], v[16:19], a[64:67]
    v_mfma_f32_16x16x32_bf16 a[32:35], a[224:227], v[8:11], a[32:35]
    buffer_load_dwordx4 v152, s[16:19], s30 offen nt lds
    v_mfma_f32_16x16x32_bf16 a[0:3], a[224:227], v[0:3], a[0:3]
    s_waitcnt lgkmcnt(0)
    v_mfma_f32_16x16x32_bf16 a[4:7], a[228:231], v[0:3], a[4:7]
    v_mfma_f32_16x16x32_bf16 a[36:39], a[228:231], v[8:11], a[36:39]
    v_mfma_f32_16x16x32_bf16 a[68:71], a[228:231], v[16:19], a[68:71]
    buffer_load_dwordx4 v153, s[16:19], s30 offen offset:1024 nt lds
    v_mfma_f32_16x16x32_bf16 a[100:103], a[228:231], v[24:27], a[100:103]
    v_mfma_f32_16x16x32_bf16 a[132:135], a[228:231], v[32:35], a[132:135]
    v_mfma_f32_16x16x32_bf16 a[164:167], a[228:231], v[40:43], a[164:167]
    v_mfma_f32_16x16x32_bf16 a[168:171], a[232:235], v[40:43], a[168:171]
    buffer_load_dwordx4 v152, s[16:19], s30 offen offset:2048 nt lds
    v_mfma_f32_16x16x32_bf16 a[136:139], a[232:235], v[32:35], a[136:139]
    v_mfma_f32_16x16x32_bf16 a[104:107], a[232:235], v[24:27], a[104:107]
    v_mfma_f32_16x16x32_bf16 a[72:75], a[232:235], v[16:19], a[72:75]
    v_mfma_f32_16x16x32_bf16 a[40:43], a[232:235], v[8:11], a[40:43]
    buffer_load_dwordx4 v153, s[16:19], s30 offen offset:3072 nt lds
    v_mfma_f32_16x16x32_bf16 a[8:11], a[232:235], v[0:3], a[8:11]
    s_add_u32 s30, s30, 8192
    v_mfma_f32_16x16x32_bf16 a[12:15], a[236:239], v[0:3], a[12:15]
    v_mfma_f32_16x16x32_bf16 a[44:47], a[236:239], v[8:11], a[44:47]
    v_mfma_f32_16x16x32_bf16 a[76:79], a[236:239], v[16:19], a[76:79]
    v_mfma_f32_16x16x32_bf16 a[108:111], a[236:239], v[24:27], a[108:111]
    v_mfma_f32_16x16x32_bf16 a[140:143], a[236:239], v[32:35], a[140:143]
    v_mfma_f32_16x16x32_bf16 a[172:175], a[236:239], v[40:43], a[172:175]
    s_waitcnt vmcnt(8)
    s_barrier
    v_mfma_f32_16x16x32_bf16 a[176:179], a[240:243], v[40:43], a[176:179]
    ds_read_b128 a[192:195], v144 offset:16384
    ds_read_b128 a[196:199], v145 offset:16384
    v_mfma_f32_16x16x32_bf16 a[144:147], a[240:243], v[32:35], a[144:147]
    ds_read_b128 a[200:203], v146 offset:16384
    ds_read_b128 a[204:207], v147 offset:16384
    v_mfma_f32_16x16x32_bf16 a[112:115], a[240:243], v[24:27], a[112:115]
    ds_read_b128 a[208:211], v144 offset:20480
    ds_read_b128 a[212:215], v145 offset:20480
    v_mfma_f32_16x16x32_bf16 a[80:83], a[240:243], v[16:19], a[80:83]
    ds_read_b128 a[216:219], v146 offset:20480
    ds_read_b128 a[220:223], v147 offset:20480
    v_mfma_f32_16x16x32_bf16 a[48:51], a[240:243], v[8:11], a[48:51]
    s_add_u32 m0, s32, 40960
    v_mfma_f32_16x16x32_bf16 a[16:19], a[240:243], v[0:3], a[16:19]
    v_mfma_f32_16x16x32_bf16 a[20:23], a[244:247], v[0:3], a[20:23]
    v_mfma_f32_16x16x32_bf16 a[52:55], a[244:247], v[8:11], a[52:55]
    v_mfma_f32_16x16x32_bf16 a[84:87], a[244:247], v[16:19], a[84:87]
    v_mfma_f32_16x16x32_bf16 a[116:119], a[244:247], v[24:27], a[116:119]
    v_mfma_f32_16x16x32_bf16 a[148:151], a[244:247], v[32:35], a[148:151]
    v_mfma_f32_16x16x32_bf16 a[180:183], a[244:247], v[40:43], a[180:183]
    v_mfma_f32_16x16x32_bf16 a[184:187], a[248:251], v[40:43], a[184:187]
    v_mfma_f32_16x16x32_bf16 a[152:155], a[248:251], v[32:35], a[152:155]
    v_mfma_f32_16x16x32_bf16 a[120:123], a[248:251], v[24:27], a[120:123]
    v_mfma_f32_16x16x32_bf16 a[88:91], a[248:251], v[16:19], a[88:91]
    v_mfma_f32_16x16x32_bf16 a[56:59], a[248:251], v[8:11], a[56:59]
    buffer_load_dwordx4 v154, s[20:23], s31 offen nt lds
    v_mfma_f32_16x16x32_bf16 a[24:27], a[248:251], v[0:3], a[24:27]
    v_mfma_f32_16x16x32_bf16 a[28:31], a[252:255], v[0:3], a[28:31]
    v_mfma_f32_16x16x32_bf16 a[60:63], a[252:255], v[8:11], a[60:63]
    v_mfma_f32_16x16x32_bf16 a[92:95], a[252:255], v[16:19], a[92:95]
    buffer_load_dwordx4 v154, s[20:23], s31 offen offset:1024 nt lds
    v_mfma_f32_16x16x32_bf16 a[124:127], a[252:255], v[24:27], a[124:127]
    v_mfma_f32_16x16x32_bf16 a[156:159], a[252:255], v[32:35], a[156:159]
    v_mfma_f32_16x16x32_bf16 a[188:191], a[252:255], v[40:43], a[188:191]
    v_mfma_f32_16x16x32_bf16 v[120:123], v[48:51], v[0:3], v[120:123]
    buffer_load_dwordx4 v154, s[20:23], s31 offen offset:2048 nt lds
    v_mfma_f32_16x16x32_bf16 v[124:127], v[48:51], v[8:11], v[124:127]
    v_mfma_f32_16x16x32_bf16 v[128:131], v[48:51], v[16:19], v[128:131]
    v_mfma_f32_16x16x32_bf16 v[132:135], v[48:51], v[24:27], v[132:135]
    v_mfma_f32_16x16x32_bf16 v[136:139], v[48:51], v[32:35], v[136:139]
    buffer_load_dwordx4 v154, s[20:23], s31 offen offset:3072 nt lds
    v_mfma_f32_16x16x32_bf16 v[140:143], v[48:51], v[40:43], v[140:143]
    s_add_u32 s31, s31, 8192
    s_waitcnt lgkmcnt(0)
    v_mfma_f32_16x16x32_bf16 v[0:3], a[192:195], v[160:163], v[96:99]
    v_mfma_f32_16x16x32_bf16 v[0:3], a[196:199], v[164:167], v[0:3]
    v_mfma_f32_16x16x32_bf16 v[0:3], a[200:203], v[168:171], v[0:3]
    v_mfma_f32_16x16x32_bf16 v[0:3], a[204:207], v[172:175], v[0:3]
    v_mfma_f32_16x16x32_bf16 v[8:11], a[204:207], v[188:191], v[100:103]
    v_mfma_f32_16x16x32_bf16 v[8:11], a[200:203], v[184:187], v[8:11]
    s_waitcnt vmcnt(8)
    s_barrier
    v_mfma_f32_16x16x32_bf16 v[8:11], a[196:199], v[180:183], v[8:11]
    ds_read_b64_tr_b16 a[224:225], v148 offset:16384
    ds_read_b64_tr_b16 a[226:227], v148 offset:20480
    v_mfma_f32_16x16x32_bf16 v[8:11], a[192:195], v[176:179], v[8:11]
    ds_read_b64_tr_b16 a[228:229], v148 offset:16416
    ds_read_b64_tr_b16 a[230:231], v148 offset:20512
    v_mfma_f32_16x16x32_bf16 v[16:19], a[192:195], v[192:195], v[104:107]
    ds_read_b64_tr_b16 a[232:233], v149 offset:16384
    ds_read_b64_tr_b16 a[234:235], v149 offset:20480
    v_mfma_f32_16x16x32_bf16 v[16:19], a[196:199], v[196:199], v[16:19]
    ds_read_b64_tr_b16 a[236:237], v149 offset:16416
    ds_read_b64_tr_b16 a[238:239], v149 offset:20512
    v_mfma_f32_16x16x32_bf16 v[16:19], a[200:203], v[200:203], v[16:19]
    ds_read_b64_tr_b16 a[240:241], v150 offset:16384
    ds_read_b64_tr_b16 a[242:243], v150 offset:20480
    v_mfma_f32_16x16x32_bf16 v[16:19], a[204:207], v[204:207], v[16:19]
    ds_read_b64_tr_b16 a[244:245], v150 offset:16416
    ds_read_b64_tr_b16 a[246:247], v150 offset:20512
    v_mfma_f32_16x16x32_bf16 v[24:27], a[204:207], v[220:223], v[108:111]
    ds_read_b64_tr_b16 a[248:249], v151 offset:16384
    ds_read_b64_tr_b16 a[250:251], v151 offset:20480
    v_mfma_f32_16x16x32_bf16 v[24:27], a[200:203], v[216:219], v[24:27]
    ds_read_b64_tr_b16 a[252:253], v151 offset:16416
    s_waitcnt lgkmcnt(13)
    ds_read_b64_tr_b16 a[254:255], v151 offset:20512
    v_mfma_f32_16x16x32_bf16 v[24:27], a[196:199], v[212:215], v[24:27]
    v_mfma_f32_16x16x32_bf16 v[24:27], a[192:195], v[208:211], v[24:27]
    v_mfma_f32_16x16x32_bf16 v[32:35], a[192:195], v[224:227], v[112:115]
    v_mfma_f32_16x16x32_bf16 v[32:35], a[196:199], v[228:231], v[32:35]
    v_mfma_f32_16x16x32_bf16 v[32:35], a[200:203], v[232:235], v[32:35]
    v_mfma_f32_16x16x32_bf16 v[32:35], a[204:207], v[236:239], v[32:35]
    v_mfma_f32_16x16x32_bf16 v[40:43], a[204:207], v[252:255], v[116:119]
    v_mfma_f32_16x16x32_bf16 v[40:43], a[200:203], v[248:251], v[40:43]
    v_mfma_f32_16x16x32_bf16 v[40:43], a[196:199], v[244:247], v[40:43]
    v_mfma_f32_16x16x32_bf16 v[40:43], a[192:195], v[240:243], v[40:43]
    v_mfma_f32_16x16x32_bf16 v[44:47], a[208:211], v[240:243], v[116:119]
    v_mfma_f32_16x16x32_bf16 v[44:47], a[212:215], v[244:247], v[44:47]
    v_mfma_f32_16x16x32_bf16 v[44:47], a[216:219], v[248:251], v[44:47]
    v_mfma_f32_16x16x32_bf16 v[44:47], a[220:223], v[252:255], v[44:47]
    v_mfma_f32_16x16x32_bf16 v[36:39], a[220:223], v[236:239], v[112:115]
    v_mfma_f32_16x16x32_bf16 v[36:39], a[216:219], v[232:235], v[36:39]
    v_mfma_f32_16x16x32_bf16 v[36:39], a[212:215], v[228:231], v[36:39]
    v_mfma_f32_16x16x32_bf16 v[36:39], a[208:211], v[224:227], v[36:39]
    v_mfma_f32_16x16x32_bf16 v[28:31], a[208:211], v[208:211], v[108:111]
    v_mfma_f32_16x16x32_bf16 v[28:31], a[212:215], v[212:215], v[28:31]
    v_mfma_f32_16x16x32_bf16 v[28:31], a[216:219], v[216:219], v[28:31]
    v_mfma_f32_16x16x32_bf16 v[28:31], a[220:223], v[220:223], v[28:31]
    v_mfma_f32_16x16x32_bf16 v[20:23], a[220:223], v[204:207], v[104:107]
    v_mfma_f32_16x16x32_bf16 v[20:23], a[216:219], v[200:203], v[20:23]
    v_mfma_f32_16x16x32_bf16 v[20:23], a[212:215], v[196:199], v[20:23]
    v_mfma_f32_16x16x32_bf16 v[20:23], a[208:211], v[192:195], v[20:23]
    v_mfma_f32_16x16x32_bf16 v[12:15], a[208:211], v[176:179], v[100:103]
    v_mfma_f32_16x16x32_bf16 v[12:15], a[212:215], v[180:183], v[12:15]
    v_mfma_f32_16x16x32_bf16 v[12:15], a[216:219], v[184:187], v[12:15]
    v_mfma_f32_16x16x32_bf16 v[12:15], a[220:223], v[188:191], v[12:15]
    v_mfma_f32_16x16x32_bf16 v[4:7], a[220:223], v[172:175], v[96:99]
    v_mfma_f32_16x16x32_bf16 v[4:7], a[216:219], v[168:171], v[4:7]
    v_mfma_f32_16x16x32_bf16 v[4:7], a[212:215], v[164:167], v[4:7]
    v_mfma_f32_16x16x32_bf16 v[4:7], a[208:211], v[160:163], v[4:7]
    s_nop 7
    v_max3_f32 v155, v0, v1, v2
    v_max3_f32 v155, v155, v3, v8
    v_max3_f32 v155, v155, v9, v10
    v_max3_f32 v155, v155, v11, v16
    v_max3_f32 v155, v155, v17, v18
    v_max3_f32 v155, v155, v19, v24
    v_max3_f32 v155, v155, v25, v26
    v_max3_f32 v155, v155, v27, v32
    v_max3_f32 v155, v155, v33, v34
    v_max3_f32 v155, v155, v35, v40
    v_max3_f32 v155, v155, v41, v42
    v_max3_f32 v155, v155, v43, v44
    v_max3_f32 v155, v155, v45, v46
    v_max3_f32 v155, v155, v47, v36
    v_max3_f32 v155, v155, v37, v38
    v_max3_f32 v155, v155, v39, v28
    v_max3_f32 v155, v155, v29, v30
    v_max3_f32 v155, v155, v31, v20
    v_max3_f32 v155, v155, v21, v22
    v_max3_f32 v155, v155, v23, v12
    v_max3_f32 v155, v155, v13, v14
    v_max3_f32 v155, v155, v15, v4
    v_max3_f32 v155, v155, v5, v6
    v_max_f32 v155, v155, v7
    v_cmp_lt_f32 vcc, s33, v155
    s_nop 0
    s_cbranch_vccnz L_rare1
L_back1:
    v_exp_f32 v0, v0
    v_exp_f32 v1, v1
    v_exp_f32 v2, v2
    v_cvt_pk_bf16_f32 v0, v0, v1
    v_exp_f32 v3, v3
    v_exp_f32 v4, v4
    v_cvt_pk_bf16_f32 v1, v2, v3
    v_exp_f32 v5, v5
    v_exp_f32 v6, v6
    v_cvt_pk_bf16_f32 v2, v4, v5
    v_exp_f32 v7, v7
    v_exp_f32 v8, v8
    v_cvt_pk_bf16_f32 v3, v6, v7
    v_exp_f32 v9, v9
    v_exp_f32 v10, v10
    v_cvt_pk_bf16_f32 v8, v8, v9
    v_exp_f32 v11, v11
    v_exp_f32 v12, v12
    v_cvt_pk_bf16_f32 v9, v10, v11
    v_exp_f32 v13, v13
    v_exp_f32 v14, v14
    v_cvt_pk_bf16_f32 v10, v12, v13
    v_exp_f32 v15, v15
    v_exp_f32 v16, v16
    v_cvt_pk_bf16_f32 v11, v14, v15
    v_exp_f32 v17, v17
    v_exp_f32 v18, v18
    v_cvt_pk_bf16_f32 v16, v16, v17
    v_exp_f32 v19, v19
    v_exp_f32 v20, v20
    v_cvt_pk_bf16_f32 v17, v18, v19
    v_exp_f32 v21, v21
    v_exp_f32 v22, v22
    v_cvt_pk_bf16_f32 v18, v20, v21
    v_exp_f32 v23, v23
    v_exp_f32 v24, v24
    v_cvt_pk_bf16_f32 v19, v22, v23
    v_exp_f32 v25, v25
    v_exp_f32 v26, v26
    v_cvt_pk_bf16_f32 v24, v24, v25
    v_exp_f32 v27, v27
    v_exp_f32 v28, v28
    v_cvt_pk_bf16_f32 v25, v26, v27
    v_exp_f32 v29, v29
    v_exp_f32 v30, v30
    v_cvt_pk_bf16_f32 v26, v28, v29
    v_exp_f32 v31, v31
    v_exp_f32 v32, v32
    v_cvt_pk_bf16_f32 v27, v30, v31
    v_exp_f32 v33, v33
    v_exp_f32 v34, v34
    v_cvt_pk_bf16_f32 v32, v32, v33
    v_exp_f32 v35, v35
    v_exp_f32 v36, v36
    v_cvt_pk_bf16_f32 v33, v34, v35
    v_exp_f32 v37, v37
    v_exp_f32 v38, v38
    v_cvt_pk_bf16_f32 v34, v36, v37
    v_exp_f32 v39, v39
    v_exp_f32 v40, v40
    v_cvt_pk_bf16_f32 v35, v38, v39
    v_exp_f32 v41, v41
    v_exp_f32 v42, v42
    v_cvt_pk_bf16_f32 v40, v40, v41
    v_exp_f32 v43, v43
    v_exp_f32 v44, v44
    v_cvt_pk_bf16_f32 v41, v42, v43
    v_exp_f32 v45, v45
    v_exp_f32 v46, v46
    v_cvt_pk_bf16_f32 v42, v44, v45
    v_exp_f32 v47, v47
    s_nop 0
    v_cvt_pk_bf16_f32 v43, v46, v47
    s_nop 1
    v_mfma_f32_16x16x32_bf16 a[160:163], a[224:227], v[40:43], a[160:163]
    s_add_u32 m0, s32, 8192
    v_mfma_f32_16x16x32_bf16 a[128:131], a[224:227], v[32:35], a[128:131]
    v_mfma_f32_16x16x32_bf16 a[96:99], a[224:227], v[24:27], a[96:99]
    v_mfma_f32_16x16x32_bf16 a[64:67], a[224:227], v[16:19], a[64:67]
    v_mfma_f32_16x16x32_bf16 a[32:35], a[224:227], v[8:11], a[32:35]
    buffer_load_dwordx4 v152, s[16:19], s30 offen nt lds
    v_mfma_f32_16x16x32_bf16 a[0:3], a[224:227], v[0:3], a[0:3]
    s_waitcnt lgkmcnt(0)
    v_mfma_f32_16x16x32_bf16 a[4:7], a[228:231], v[0:3], a[4:7]
    v_mfma_f32_16x16x32_bf16 a[36:39], a[228:231], v[8:11], a[36:39]
    v_mfma_f32_16x16x32_bf16 a[68:71], a[228:231], v[16:19], a[68:71]
    buffer_load_dwordx4 v153, s[16:19], s30 offen offset:1024 nt lds
    v_mfma_f32_16x16x32_bf16 a[100:103], a[228:231], v[24:27], a[100:103]
    v_mfma_f32_16x16x32_bf16 a[132:135], a[228:231], v[32:35], a[132:135]
    v_mfma_f32_16x16x32_bf16 a[164:167], a[228:231], v[40:43], a[164:167]
    v_mfma_f32_16x16x32_bf16 a[168:171], a[232:235], v[40:43], a[168:171]
    buffer_load_dwordx4 v152, s[16:19], s30 offen offset:2048 nt lds
    v_mfma_f32_16x16x32_bf16 a[136:139], a[232:235], v[32:35], a[136:139]
    v_mfma_f32_16x16x32_bf16 a[104:107], a[232:235], v[24:27], a[104:107]
    v_mfma_f32_16x16x32_bf16 a[72:75], a[232:235], v[16:19], a[72:75]
    v_mfma_f32_16x16x32_bf16 a[40:43], a[232:235], v[8:11], a[40:43]
    buffer_load_dwordx4 v153, s[16:19], s30 offen offset:3072 nt lds
    v_mfma_f32_16x16x32_bf16 a[8:11], a[232:235], v[0:3], a[8:11]
    s_add_u32 s30, s30, 8192
    v_mfma_f32_16x16x32_bf16 a[12:15], a[236:239], v[0:3], a[12:15]
    v_mfma_f32_16x16x32_bf16 a[44:47], a[236:239], v[8:11], a[44:47]
    v_mfma_f32_16x16x32_bf16 a[76:79], a[236:239], v[16:19], a[76:79]
    v_mfma_f32_16x16x32_bf16 a[108:111], a[236:239], v[24:27], a[108:111]
    v_mfma_f32_16x16x32_bf16 a[140:143], a[236:239], v[32:35], a[140:143]
    v_mfma_f32_16x16x32_bf16 a[172:175], a[236:239], v[40:43], a[172:175]
    s_waitcnt vmcnt(8)
    s_barrier
    v_mfma_f32_16x16x32_bf16 a[176:179], a[240:243], v[40:43], a[176:179]
    ds_read_b128 a[192:195], v144
    ds_read_b128 a[196:199], v145
    v_mfma_f32_16x16x32_bf16 a[144:147], a[240:243], v[32:35], a[144:147]
    ds_read_b128 a[200:203], v146
    ds_read_b128 a[204:207], v147
    v_mfma_f32_16x16x32_bf16 a[112:115], a[240:243], v[24:27], a[112:115]
    ds_read_b128 a[208:211], v144 offset:4096
    ds_read_b128 a[212:215], v145 offset:4096
    v_mfma_f32_16x16x32_bf16 a[80:83], a[240:243], v[16:19], a[80:83]
    ds_read_b128 a[216:219], v146 offset:4096
    ds_read_b128 a[220:223], v147 offset:4096
    v_mfma_f32_16x16x32_bf16 a[48:51], a[240:243], v[8:11], a[48:51]
    s_add_u32 m0, s32, 49152
    v_mfma_f32_16x16x32_bf16 a[16:19], a[240:243], v[0:3], a[16:19]
    v_mfma_f32_16x16x32_bf16 a[20:23], a[244:247], v[0:3], a[20:23]
    v_mfma_f32_16x16x32_bf16 a[52:55], a[244:247], v[8:11], a[52:55]
    v_mfma_f32_16x16x32_bf16 a[84:87], a[244:247], v[16:19], a[84:87]
    v_mfma_f32_16x16x32_bf16 a[116:119], a[244:247], v[24:27], a[116:119]
    v_mfma_f32_16x16x32_bf16 a[148:151], a[244:247], v[32:35], a[148:151]
    v_mfma_f32_16x16x32_bf16 a[180:183], a[244:247], v[40:43], a[180:183]
    v_mfma_f32_16x16x32_bf16 a[184:187], a[248:251], v[40:43], a[184:187]
    v_mfma_f32_16x16x32_bf16 a[152:155], a[248:251], v[32:35], a[152:155]
    v_mfma_f32_16x16x32_bf16 a[120:123], a[248:251], v[24:27], a[120:123]
    v_mfma_f32_16x16x32_bf16 a[88:91], a[248:251], v[16:19], a[88:91]
    v_mfma_f32_16x16x32_bf16 a[56:59], a[248:251], v[8:11], a[56:59]
    buffer_load_dwordx4 v154, s[20:23], s31 offen nt lds
    v_mfma_f32_16x16x32_bf16 a[24:27], a[248:251], v[0:3], a[24:27]
    v_mfma_f32_16x16x32_bf16 a[28:31], a[252:255], v[0:3], a[28:31]
    v_mfma_f32_16x16x32_bf16 a[60:63], a[252:255], v[8:11], a[60:63]
    v_mfma_f32_16x16x32_bf16 a[92:95], a[252:255], v[16:19], a[92:95]
    buffer_load_dwordx4 v154, s[20:23], s31 offen offset:1024 nt lds
    v_mfma_f32_16x16x32_bf16 a[124:127], a[252:255], v[24:27], a[124:127]
    v_mfma_f32_16x16x32_bf16 a[156:159], a[252:255], v[32:35], a[156:159]
    v_mfma_f32_16x16x32_bf16 a[188:191], a[252:255], v[40:43], a[188:191]
    v_mfma_f32_16x16x32_bf16 v[120:123], v[48:51], v[0:3], v[120:123]
    buffer_load_dwordx4 v154, s[20:23], s31 offen offset:2048 nt lds
    v_mfma_f32_16x16x32_bf16 v[124:127], v[48:51], v[8:11], v[124:127]
    v_mfma_f32_16x16x32_bf16 v[128:131], v[48:51], v[16:19], v[128:131]
    v_mfma_f32_16x16x32_bf16 v[132:135], v[48:51], v[24:27], v[132:135]
    v_mfma_f32_16x16x32_bf16 v[136:139], v[48:51], v[32:35], v[136:139]
    buffer_load_dwordx4 v154, s[20:23], s31 offen offset:3072 nt lds
    v_mfma_f32_16x16x32_bf16 v[140:143], v[48:51], v[40:43], v[140:143]
    s_add_u32 s31, s31, 8192
    s_waitcnt lgkmcnt(0)
    v_mfma_f32_16x16x32_bf16 v[0:3], a[192:195], v[160:163], v[96:99]
    v_mfma_f32_16x16x32_bf16 v[0:3], a[196:199], v[164:167], v[0:3]
    v_mfma_f32_16x16x32_bf16 v[0:3], a[200:203], v[168:171], v[0:3]
    v_mfma_f32_16x16x32_bf16 v[0:3], a[204:207], v[172:175], v[0:3]
    v_mfma_f32_16x16x32_bf16 v[8:11], a[204:207], v[188:191], v[100:103]
    v_mfma_f32_16x16x32_bf16 v[8:11], a[200:203], v[184:187], v[8:11]
    s_waitcnt vmcnt(8)
    s_barrier
    v_mfma_f32_16x16x32_bf16 v[8:11], a[196:199], v[180:183], v[8:11]
    ds_read_b64_tr_b16 a[224:225], v148
    ds_read_b64_tr_b16 a[226:227], v148 offset:4096
    v_mfma_f32_16x16x32_bf16 v[8:11], a[192:195], v[176:179], v[8:11]
    ds_read_b64_tr_b16 a[228:229], v148 offset:32
    ds_read_b64_tr_b16 a[230:231], v148 offset:4128
    v_mfma_f32_16x16x32_bf16 v[16:19], a[192:195], v[192:195], v[104:107]
    ds_read_b64_tr_b16 a[232:233], v149
    ds_read_b64_tr_b16 a[234:235], v149 offset:4096
    v_mfma_f32_16x16x32_bf16 v[16:19], a[196:199], v[196:199], v[16:19]
    ds_read_b64_tr_b16 a[236:237], v149 offset:32
    ds_read_b64_tr_b16 a[238:239], v149 offset:4128
    v_mfma_f32_16x16x32_bf16 v[16:19], a[200:203], v[200:203], v[16:19]
    ds_read_b64_tr_b16 a[240:241], v150
    ds_read_b64_tr_b16 a[242:243], v150 offset:4096
    v_mfma_f32_16x16x32_bf16 v[16:19], a[204:207], v[204:207], v[16:19]
    ds_read_b64_tr_b16 a[244:245], v150 offset:32
    ds_read_b64_tr_b16 a[246:247], v150 offset:4128
    v_mfma_f32_16x16x32_bf16 v[24:27], a[204:207], v[220:223], v[108:111]
    ds_read_b64_tr_b16 a[248:249], v151
    ds_read_b64_tr_b16 a[250:251], v151 offset:4096
    v_mfma_f32_16x16x32_bf16 v[24:27], a[200:203], v[216:219], v[24:27]
    ds_read_b64_tr_b16 a[252:253], v151 offset:32
    s_waitcnt lgkmcnt(13)
    ds_read_b64_tr_b16 a[254:255], v151 offset:4128
    v_mfma_f32_16x16x32_bf16 v[24:27], a[196:199], v[212:215], v[24:27]
    v_mfma_f32_16x16x32_bf16 v[24:27], a[192:195], v[208:211], v[24:27]
    v_mfma_f32_16x16x32_bf16 v[32:35], a[192:195], v[224:227], v[112:115]
    v_mfma_f32_16x16x32_bf16 v[32:35], a[196:199], v[228:231], v[32:35]
    v_mfma_f32_16x16x32_bf16 v[32:35], a[200:203], v[232:235], v[32:35]
    v_mfma_f32_16x16x32_bf16 v[32:35], a[204:207], v[236:239], v[32:35]
    v_mfma_f32_16x16x32_bf16 v[40:43], a[204:207], v[252:255], v[116:119]
    v_mfma_f32_16x16x32_bf16 v[40:43], a[200:203], v[248:251], v[40:43]
    v_mfma_f32_16x16x32_bf16 v[40:43], a[196:199], v[244:247], v[40:43]
    v_mfma_f32_16x16x32_bf16 v[40:43], a[192:195], v[240:243], v[40:43]
    v_mfma_f32_16x16x32_bf16 v[44:47], a[208:211], v[240:243], v[116:119]
    v_mfma_f32_16x16x32_bf16 v[44:47], a[212:215], v[244:247], v[44:47]
    v_mfma_f32_16x16x32_bf16 v[44:47], a[216:219], v[248:251], v[44:47]
    v_mfma_f32_16x16x32_bf16 v[44:47], a[220:223], v[252:255], v[44:47]
    v_mfma_f32_16x16x32_bf16 v[36:39], a[220:223], v[236:239], v[112:115]
    v_mfma_f32_16x16x32_bf16 v[36:39], a[216:219], v[232:235], v[36:39]
    v_mfma_f32_16x16x32_bf16 v[36:39], a[212:215], v[228:231], v[36:39]
    v_mfma_f32_16x16x32_bf16 v[36:39], a[208:211], v[224:227], v[36:39]
    v_mfma_f32_16x16x32_bf16 v[28:31], a[208:211], v[208:211], v[108:111]
    v_mfma_f32_16x16x32_bf16 v[28:31], a[212:215], v[212:215], v[28:31]
    v_mfma_f32_16x16x32_bf16 v[28:31], a[216:219], v[216:219], v[28:31]
    v_mfma_f32_16x16x32_bf16 v[28:31], a[220:223], v[220:223], v[28:31]
    v_mfma_f32_16x16x32_bf16 v[20:23], a[220:223], v[204:207], v[104:107]
    v_mfma_f32_16x16x32_bf16 v[20:23], a[216:219], v[200:203], v[20:23]
    v_mfma_f32_16x16x32_bf16 v[20:23], a[212:215], v[196:199], v[20:23]
    v_mfma_f32_16x16x32_bf16 v[20:23], a[208:211], v[192:195], v[20:23]
    v_mfma_f32_16x16x32_bf16 v[12:15], a[208:211], v[176:179], v[100:103]
    v_mfma_f32_16x16x32_bf16 v[12:15], a[212:215], v[180:183], v[12:15]
    v_mfma_f32_16x16x32_bf16 v[12:15], a[216:219], v[184:187], v[12:15]
    v_mfma_f32_16x16x32_bf16 v[12:15], a[220:223], v[188:191], v[12:15]
    v_mfma_f32_16x16x32_bf16 v[4:7], a[220:223], v[172:175], v[96:99]
    v_mfma_f32_16x16x32_bf16 v[4:7], a[216:219], v[168:171], v[4:7]
    v_mfma_f32_16x16x32_bf16 v[4:7], a[212:215], v[164:167], v[4:7]
    v_mfma_f32_16x16x32_bf16 v[4:7], a[208:211], v[160:163], v[4:7]
    s_nop 7
    v_max3_f32 v155, v0, v1, v2
    v_max3_f32 v155, v155, v3, v8
    v_max3_f32 v155, v155, v9, v10
    v_max3_f32 v155, v155, v11, v16
    v_max3_f32 v155, v155, v17, v18
    v_max3_f32 v155, v155, v19, v24
    v_max3_f32 v155, v155, v25, v26
    v_max3_f32 v155, v155, v27, v32
    v_max3_f32 v155, v155, v33, v34
    v_max3_f32 v155, v155, v35, v40
    v_max3_f32 v155, v155, v41, v42
    v_max3_f32 v155, v155, v43, v44
    v_max3_f32 v155, v155, v45, v46
    v_max3_f32 v155, v155, v47, v36
    v_max3_f32 v155, v155, v37, v38
    v_max3_f32 v155, v155, v39, v28
    v_max3_f32 v155, v155, v29, v30
    v_max3_f32 v155, v155, v31, v20
    v_max3_f32 v155, v155, v21, v22
    v_max3_f32 v155, v155, v23, v12
    v_max3_f32 v155, v155, v13, v14
    v_max3_f32 v155, v155, v15, v4
    v_max3_f32 v155, v155, v5, v6
    v_max_f32 v155, v155, v7
    v_cmp_lt_f32 vcc, s33, v155
    s_nop 0
    s_cbranch_vccnz L_rare2
L_back2:
    v_exp_f32 v0, v0
    v_exp_f32 v1, v1
    v_exp_f32 v2, v2
    v_cvt_pk_bf16_f32 v0, v0, v1
    v_exp_f32 v3, v3
    v_exp_f32 v4, v4
    v_cvt_pk_bf16_f32 v1, v2, v3
    v_exp_f32 v5, v5
    v_exp_f32 v6, v6
    v_cvt_pk_bf16_f32 v2, v4, v5
    v_exp_f32 v7, v7
    v_exp_f32 v8, v8
    v_cvt_pk_bf16_f32 v3, v6, v7
    v_exp_f32 v9, v9
    v_exp_f32 v10, v10
    v_cvt_pk_bf16_f32 v8, v8, v9
    v_exp_f32 v11, v11
    v_exp_f32 v12, v12
    v_cvt_pk_bf16_f32 v9, v10, v11
    v_exp_f32 v13, v13
    v_exp_f32 v14, v14
    v_cvt_pk_bf16_f32 v10, v12, v13
    v_exp_f32 v15, v15
    v_exp_f32 v16, v16
    v_cvt_pk_bf16_f32 v11, v14, v15
    v_exp_f32 v17, v17
    v_exp_f32 v18, v18
    v_cvt_pk_bf16_f32 v16, v16, v17
    v_exp_f32 v19, v19
    v_exp_f32 v20, v20
    v_cvt_pk_bf16_f32 v17, v18, v19
    v_exp_f32 v21, v21
    v_exp_f32 v22, v22
    v_cvt_pk_bf16_f32 v18, v20, v21
    v_exp_f32 v23, v23
    v_exp_f32 v24, v24
    v_cvt_pk_bf16_f32 v19, v22, v23
    v_exp_f32 v25, v25
    v_exp_f32 v26, v26
    v_cvt_pk_bf16_f32 v24, v24, v25
    v_exp_f32 v27, v27
    v_exp_f32 v28, v28
    v_cvt_pk_bf16_f32 v25, v26, v27
    v_exp_f32 v29, v29
    v_exp_f32 v30, v30
    v_cvt_pk_bf16_f32 v26, v28, v29
    v_exp_f32 v31, v31
    v_exp_f32 v32, v32
    v_cvt_pk_bf16_f32 v27, v30, v31
    v_exp_f32 v33, v33
    v_exp_f32 v34, v34
    v_cvt_pk_bf16_f32 v32, v32, v33
    v_exp_f32 v35, v35
    v_exp_f32 v36, v36
    v_cvt_pk_bf16_f32 v33, v34, v35
    v_exp_f32 v37, v37
    v_exp_f32 v38, v38
    v_cvt_pk_bf16_f32 v34, v36, v37
    v_exp_f32 v39, v39
    v_exp_f32 v40, v40
    v_cvt_pk_bf16_f32 v35, v38, v39
    v_exp_f32 v41, v41
    v_exp_f32 v42, v42
    v_cvt_pk_bf16_f32 v40, v40, v41
    v_exp_f32 v43, v43
    v_exp_f32 v44, v44
    v_cvt_pk_bf16_f32 v41, v42, v43
    v_exp_f32 v45, v45
    v_exp_f32 v46, v46
    v_cvt_pk_bf16_f32 v42, v44, v45
    v_exp_f32 v47, v47
    s_nop 0
    v_cvt_pk_bf16_f32 v43, v46, v47
    s_nop 1
    v_mfma_f32_16x16x32_bf16 a[160:163], a[224:227], v[40:43], a[160:163]
    s_cmp_ge_u32 s29, 28
    s_cselect_b32 s18, 0, 0x40000
    v_mfma_f32_16x16x32_bf16 a[128:131], a[224:227], v[32:35], a[128:131]
    s_add_u32 m0, s32, 16384
    v_mfma_f32_16x16x32_bf16 a[96:99], a[224:227], v[24:27], a[96:99]
    v_mfma_f32_16x16x32_bf16 a[64:67], a[224:227], v[16:19], a[64:67]
    v_mfma_f32_16x16x32_bf16 a[32:35], a[224:227], v[8:11], a[32:35]
    buffer_load_dwordx4 v152, s[16:19], s30 offen nt lds
    v_mfma_f32_16x16x32_bf16 a[0:3], a[224:227], v[0:3], a[0:3]
    s_waitcnt lgkmcnt(0)
    v_mfma_f32_16x16x32_bf16 a[4:7], a[228:231], v[0:3], a[4:7]
    v_mfma_f32_16x16x32_bf16 a[36:39], a[228:231], v[8:11], a[36:39]
    v_mfma_f32_16x16x32_bf16 a[68:71], a[228:231], v[16:19], a[68:71]
    buffer_load_dwordx4 v153, s[16:19], s30 offen offset:1024 nt lds
    v_mfma_f32_16x16x32_bf16 a[100:103], a[228:231], v[24:27], a[100:103]
    v_mfma_f32_16x16x32_bf16 a[132:135], a[228:231], v[32:35], a[132:135]
    v_mfma_f32_16x16x32_bf16 a[164:167], a[228:231], v[40:43], a[164:167]
    v_mfma_f32_16x16x32_bf16 a[168:171], a[232:235], v[40:43], a[168:171]
    buffer_load_dwordx4 v152, s[16:19], s30 offen offset:2048 nt lds
    v_mfma_f32_16x16x32_bf16 a[136:139], a[232:235], v[32:35], a[136:139]
    v_mfma_f32_16x16x32_bf16 a[104:107], a[232:235], v[24:27], a[104:107]
    v_mfma_f32_16x16x32_bf16 a[72:75], a[232:235], v[16:19], a[72:75]
    v_mfma_f32_16x16x32_bf16 a[40:43], a[232:235], v[8:11], a[40:43]
    buffer_load_dwordx4 v153, s[16:19], s30 offen offset:3072 nt lds
    v_mfma_f32_16x16x32_bf16 a[8:11], a[232:235], v[0:3], a[8:11]
    s_add_u32 s30, s30, 8192
    v_mfma_f32_16x16x32_bf16 a[12:15], a[236:239], v[0:3], a[12:15]
    v_mfma_f32_16x16x32_bf16 a[44:47], a[236:239], v[8:11], a[44:47]
    v_mfma_f32_16x16x32_bf16 a[76:79], a[236:239], v[16:19], a[76:79]
    v_mfma_f32_16x16x32_bf16 a[108:111], a[236:239], v[24:27], a[108:111]
    v_mfma_f32_16x16x32_bf16 a[140:143], a[236:239], v[32:35], a[140:143]
    v_mfma_f32_16x16x32_bf16 a[172:175], a[236:239], v[40:43], a[172:175]
    s_waitcnt vmcnt(8)
    s_barrier
    v_mfma_f32_16x16x32_bf16 a[176:179], a[240:243], v[40:43], a[176:179]
    ds_read_b128 a[192:195], v144 offset:8192
    ds_read_b128 a[196:199], v145 offset:8192
    v_mfma_f32_16x16x32_bf16 a[144:147], a[240:243], v[32:35], a[144:147]
    ds_read_b128 a[200:203], v146 offset:8192
    ds_read_b128 a[204:207], v147 offset:8192
    v_mfma_f32_16x16x32_bf16 a[112:115], a[240:243], v[24:27], a[112:115]
    ds_read_b128 a[208:211], v144 offset:12288
    ds_read_b128 a[212:215], v145 offset:12288
    v_mfma_f32_16x16x32_bf16 a[80:83], a[240:243], v[16:19], a[80:83]
    ds_read_b128 a[216:219], v146 offset:12288
    ds_read_b128 a[220:223], v147 offset:12288
    v_mfma_f32_16x16x32_bf16 a[48:51], a[240:243], v[8:11], a[48:51]
    s_cmp_ge_u32 s29, 28
    s_cselect_b32 s22, 0, 0x40000
    v_mfma_f32_16x16x32_bf16 a[16:19], a[240:243], v[0:3], a[16:19]
    s_add_u32 m0, s32, 57344
    v_mfma_f32_16x16x32_bf16 a[20:23], a[244:247], v[0:3], a[20:23]
    v_mfma_f32_16x16x32_bf16 a[52:55], a[244:247], v[8:11], a[52:55]
    v_mfma_f32_16x16x32_bf16 a[84:87], a[244:247], v[16:19], a[84:87]
    v_mfma_f32_16x16x32_bf16 a[116:119], a[244:247], v[24:27], a[116:119]
    v_mfma_f32_16x16x32_bf16 a[148:151], a[244:247], v[32:35], a[148:151]
    v_mfma_f32_16x16x32_bf16 a[180:183], a[244:247], v[40:43], a[180:183]
    v_mfma_f32_16x16x32_bf16 a[184:187], a[248:251], v[40:43], a[184:187]
    v_mfma_f32_16x16x32_bf16 a[152:155], a[248:251], v[32:35], a[152:155]
    v_mfma_f32_16x16x32_bf16 a[120:123], a[248:251], v[24:27], a[120:123]
    v_mfma_f32_16x16x32_bf16 a[88:91], a[248:251], v[16:19], a[88:91]
    v_mfma_f32_16x16x32_bf16 a[56:59], a[248:251], v[8:11], a[56:59]
    buffer_load_dwordx4 v154, s[20:23], s31 offen nt lds
    v_mfma_f32_16x16x32_bf16 a[24:27], a[248:251], v[0:3], a[24:27]
    v_mfma_f32_16x16x32_bf16 a[28:31], a[252:255], v[0:3], a[28:31]
    v_mfma_f32_16x16x32_bf16 a[60:63], a[252:255], v[8:11], a[60:63]
    v_mfma_f32_16x16x32_bf16 a[92:95], a[252:255], v[16:19], a[92:95]
    buffer_load_dwordx4 v154, s[20:23], s31 offen offset:1024 nt lds
    v_mfma_f32_16x16x32_bf16 a[124:127], a[252:255], v[24:27], a[124:127]
    v_mfma_f32_16x16x32_bf16 a[156:159], a[252:255], v[32:35], a[156:159]
    v_mfma_f32_16x16x32_bf16 a[188:191], a[252:255], v[40:43], a[188:191]
    v_mfma_f32_16x16x32_bf16 v[120:123], v[48:51], v[0:3], v[120:123]
    buffer_load_dwordx4 v154, s[20:23], s31 offen offset:2048 nt lds
    v_mfma_f32_16x16x32_bf16 v[124:127], v[48:51], v[8:11], v[124:127]
    v_mfma_f32_16x16x32_bf16 v[128:131], v[48:51], v[16:19], v[128:131]
    v_mfma_f32_16x16x32_bf16 v[132:135], v[48:51], v[24:27], v[132:135]
    v_mfma_f32_16x16x32_bf16 v[136:139], v[48:51], v[32:35], v[136:139]
    buffer_load_dwordx4 v154, s[20:23], s31 offen offset:3072 nt lds
    v_mfma_f32_16x16x32_bf16 v[140:143], v[48:51], v[40:43], v[140:143]
    s_add_u32 s31, s31, 8192
    s_waitcnt lgkmcnt(0)
    v_mfma_f32_16x16x32_bf16 v[0:3], a[192:195], v[160:163], v[96:99]
    v_mfma_f32_16x16x32_bf16 v[0:3], a[196:199], v[164:167], v[0:3]
    v_mfma_f32_16x16x32_bf16 v[0:3], a[200:203], v[168:171], v[0:3]
    v_mfma_f32_16x16x32_bf16 v[0:3], a[204:207], v[172:175], v[0:3]
    v_mfma_f32_16x16x32_bf16 v[8:11], a[204:207], v[188:191], v[100:103]
    v_mfma_f32_16x16x32_bf16 v[8:11], a[200:203], v[184:187], v[8:11]
    s_waitcnt vmcnt(8)
    s_barrier
    v_mfma_f32_16x16x32_bf16 v[8:11], a[196:199], v[180:183], v[8:11]
    ds_read_b64_tr_b16 a[224:225], v148 offset:8192
    ds_read_b64_tr_b16 a[226:227], v148 offset:12288
    v_mfma_f32_16x16x32_bf16 v[8:11], a[192:195], v[176:179], v[8:11]
    ds_read_b64_tr_b16 a[228:229], v148 offset:8224
    ds_read_b64_tr_b16 a[230:231], v148 offset:12320
    v_mfma_f32_16x16x32_bf16 v[16:19], a[192:195], v[192:195], v[104:107]
    ds_read_b64_tr_b16 a[232:233], v149 offset:8192
    ds_read_b64_tr_b16 a[234:235], v149 offset:12288
    v_mfma_f32_16x16x32_bf16 v[16:19], a[196:199], v[196:199], v[16:19]
    ds_read_b64_tr_b16 a[236:237], v149 offset:8224
    ds_read_b64_tr_b16 a[238:239], v149 offset:12320
    v_mfma_f32_16x16x32_bf16 v[16:19], a[200:203], v[200:203], v[16:19]
    ds_read_b64_tr_b16 a[240:241], v150 offset:8192
    ds_read_b64_tr_b16 a[242:243], v150 offset:12288
    v_mfma_f32_16x16x32_bf16 v[16:19], a[204:207], v[204:207], v[16:19]
    ds_read_b64_tr_b16 a[244:245], v150 offset:8224
    ds_read_b64_tr_b16 a[246:247], v150 offset:12320
    v_mfma_f32_16x16x32_bf16 v[24:27], a[204:207], v[220:223], v[108:111]
    ds_read_b64_tr_b16 a[248:249], v151 offset:8192
    ds_read_b64_tr_b16 a[250:251], v151 offset:12288
    v_mfma_f32_16x16x32_bf16 v[24:27], a[200:203], v[216:219], v[24:27]
    ds_read_b64_tr_b16 a[252:253], v151 offset:8224
    s_waitcnt lgkmcnt(13)
    ds_read_b64_tr_b16 a[254:255], v151 offset:12320
    v_mfma_f32_16x16x32_bf16 v[24:27], a[196:199], v[212:215], v[24:27]
    v_mfma_f32_16x16x32_bf16 v[24:27], a[192:195], v[208:211], v[24:27]
    v_mfma_f32_16x16x32_bf16 v[32:35], a[192:195], v[224:227], v[112:115]
    v_mfma_f32_16x16x32_bf16 v[32:35], a[196:199], v[228:231], v[32:35]
    v_mfma_f32_16x16x32_bf16 v[32:35], a[200:203], v[232:235], v[32:35]
    v_mfma_f32_16x16x32_bf16 v[32:35], a[204:207], v[236:239], v[32:35]
    v_mfma_f32_16x16x32_bf16 v[40:43], a[204:207], v[252:255], v[116:119]
    v_mfma_f32_16x16x32_bf16 v[40:43], a[200:203], v[248:251], v[40:43]
    v_mfma_f32_16x16x32_bf16 v[40:43], a[196:199], v[244:247], v[40:43]
    v_mfma_f32_16x16x32_bf16 v[40:43], a[192:195], v[240:243], v[40:43]
    v_mfma_f32_16x16x32_bf16 v[44:47], a[208:211], v[240:243], v[116:119]
    v_mfma_f32_16x16x32_bf16 v[44:47], a[212:215], v[244:247], v[44:47]
    v_mfma_f32_16x16x32_bf16 v[44:47], a[216:219], v[248:251], v[44:47]
    v_mfma_f32_16x16x32_bf16 v[44:47], a[220:223], v[252:255], v[44:47]
    v_mfma_f32_16x16x32_bf16 v[36:39], a[220:223], v[236:239], v[112:115]
    v_mfma_f32_16x16x32_bf16 v[36:39], a[216:219], v[232:235], v[36:39]
    v_mfma_f32_16x16x32_bf16 v[36:39], a[212:215], v[228:231], v[36:39]
    v_mfma_f32_16x16x32_bf16 v[36:39], a[208:211], v[224:227], v[36:39]
    v_mfma_f32_16x16x32_bf16 v[28:31], a[208:211], v[208:211], v[108:111]
    v_mfma_f32_16x16x32_bf16 v[28:31], a[212:215], v[212:215], v[28:31]
    v_mfma_f32_16x16x32_bf16 v[28:31], a[216:219], v[216:219], v[28:31]
    v_mfma_f32_16x16x32_bf16 v[28:31], a[220:223], v[220:223], v[28:31]
    v_mfma_f32_16x16x32_bf16 v[20:23], a[220:223], v[204:207], v[104:107]
    v_mfma_f32_16x16x32_bf16 v[20:23], a[216:219], v[200:203], v[20:23]
    v_mfma_f32_16x16x32_bf16 v[20:23], a[212:215], v[196:199], v[20:23]
    v_mfma_f32_16x16x32_bf16 v[20:23], a[208:211], v[192:195], v[20:23]
    v_mfma_f32_16x16x32_bf16 v[12:15], a[208:211], v[176:179], v[100:103]
    v_mfma_f32_16x16x32_bf16 v[12:15], a[212:215], v[180:183], v[12:15]
    v_mfma_f32_16x16x32_bf16 v[12:15], a[216:219], v[184:187], v[12:15]
    v_mfma_f32_16x16x32_bf16 v[12:15], a[220:223], v[188:191], v[12:15]
    v_mfma_f32_16x16x32_bf16 v[4:7], a[220:223], v[172:175], v[96:99]
    v_mfma_f32_16x16x32_bf16 v[4:7], a[216:219], v[168:171], v[4:7]
    v_mfma_f32_16x16x32_bf16 v[4:7], a[212:215], v[164:167], v[4:7]
    s_add_u32 s29, s29, 3
    v_mfma_f32_16x16x32_bf16 v[4:7], a[208:211], v[160:163], v[4:7]
    s_nop 7
    v_max3_f32 v155, v0, v1, v2
    v_max3_f32 v155, v155, v3, v8
    v_max3_f32 v155, v155, v9, v10
    v_max3_f32 v155, v155, v11, v16
    v_max3_f32 v155, v155, v17, v18
    v_max3_f32 v155, v155, v19, v24
    v_max3_f32 v155, v155, v25, v26
    v_max3_f32 v155, v155, v27, v32
    v_max3_f32 v155, v155, v33, v34
    v_max3_f32 v155, v155, v35, v40
    v_max3_f32 v155, v155, v41, v42
    v_max3_f32 v155, v155, v43, v44
    v_max3_f32 v155, v155, v45, v46
    v_max3_f32 v155, v155, v47, v36
    v_max3_f32 v155, v155, v37, v38
    v_max3_f32 v155, v155, v39, v28
    v_max3_f32 v155, v155, v29, v30
    v_max3_f32 v155, v155, v31, v20
    v_max3_f32 v155, v155, v21, v22
    v_max3_f32 v155, v155, v23, v12
    v_max3_f32 v155, v155, v13, v14
    v_max3_f32 v155, v155, v15, v4
    v_max3_f32 v155, v155, v5, v6
    v_max_f32 v155, v155, v7
    v_cmp_lt_f32 vcc, s33, v155
    s_nop 0
    s_cbranch_vccnz L_rare3
L_back3:
    v_exp_f32 v0, v0
    v_exp_f32 v1, v1
    v_exp_f32 v2, v2
    v_cvt_pk_bf16_f32 v0, v0, v1
    v_exp_f32 v3, v3
    v_exp_f32 v4, v4
    v_cvt_pk_bf16_f32 v1, v2, v3
    v_exp_f32 v5, v5
    v_exp_f32 v6, v6
    v_cvt_pk_bf16_f32 v2, v4, v5
    v_exp_f32 v7, v7
    v_exp_f32 v8, v8
    v_cvt_pk_bf16_f32 v3, v6, v7
    v_exp_f32 v9, v9
    v_exp_f32 v10, v10
    v_cvt_pk_bf16_f32 v8, v8, v9
    v_exp_f32 v11, v11
    v_exp_f32 v12, v12
    v_cvt_pk_bf16_f32 v9, v10, v11
    v_exp_f32 v13, v13
    v_exp_f32 v14, v14
    v_cvt_pk_bf16_f32 v10, v12, v13
    v_exp_f32 v15, v15
    v_exp_f32 v16, v16
    v_cvt_pk_bf16_f32 v11, v14, v15
    v_exp_f32 v17, v17
    v_exp_f32 v18, v18
    v_cvt_pk_bf16_f32 v16, v16, v17
    v_exp_f32 v19, v19
    v_exp_f32 v20, v20
    v_cvt_pk_bf16_f32 v17, v18, v19
    v_exp_f32 v21, v21
    v_exp_f32 v22, v22
    v_cvt_pk_bf16_f32 v18, v20, v21
    v_exp_f32 v23, v23
    v_exp_f32 v24, v24
    v_cvt_pk_bf16_f32 v19, v22, v23
    v_exp_f32 v25, v25
    v_exp_f32 v26, v26
    v_cvt_pk_bf16_f32 v24, v24, v25
    v_exp_f32 v27, v27
    v_exp_f32 v28, v28
    v_cvt_pk_bf16_f32 v25, v26, v27
    v_exp_f32 v29, v29
    v_exp_f32 v30, v30
    v_cvt_pk_bf16_f32 v26, v28, v29
    v_exp_f32 v31, v31
    v_exp_f32 v32, v32
    v_cvt_pk_bf16_f32 v27, v30, v31
    v_exp_f32 v33, v33
    v_exp_f32 v34, v34
    v_cvt_pk_bf16_f32 v32, v32, v33
    v_exp_f32 v35, v35
    v_exp_f32 v36, v36
    v_cvt_pk_bf16_f32 v33, v34, v35
    v_exp_f32 v37, v37
    v_exp_f32 v38, v38
    v_cvt_pk_bf16_f32 v34, v36, v37
    v_exp_f32 v39, v39
    v_exp_f32 v40, v40
    v_cvt_pk_bf16_f32 v35, v38, v39
    v_exp_f32 v41, v41
    v_exp_f32 v42, v42
    v_cvt_pk_bf16_f32 v40, v40, v41
    v_exp_f32 v43, v43
    v_exp_f32 v44, v44
    v_cvt_pk_bf16_f32 v41, v42, v43
    v_exp_f32 v45, v45
    v_exp_f32 v46, v46
    v_cvt_pk_bf16_f32 v42, v44, v45
    v_exp_f32 v47, v47
    s_nop 0
    v_cvt_pk_bf16_f32 v43, v46, v47
    s_nop 1
    s_cmp_lt_u32 s29, 31
    s_cbranch_scc1 L_loopS
L_tailS:
    v_mfma_f32_16x16x32_bf16 v[120:123], v[48:51], v[0:3], v[120:123]
    v_mbcnt_lo_u32_b32 v96, -1, 0
    v_mbcnt_hi_u32_b32 v96, -1, v96
    v_mfma_f32_16x16x32_bf16 a[0:3], a[224:227], v[0:3], a[0:3]
    s_add_u32 s35, s32, 24576
    v_and_b32 v97, 15, v96
    s_waitcnt lgkmcnt(0)
    v_mfma_f32_16x16x32_bf16 a[4:7], a[228:231], v[0:3], a[4:7]
    v_lshrrev_b32 v98, 4, v96
    v_and_b32 v99, 7, v97
    v_mfma_f32_16x16x32_bf16 a[8:11], a[232:235], v[0:3], a[8:11]
    v_lshrrev_b32 v100, 1, v98
    v_xor_b32 v99, v99, v100
    v_mfma_f32_16x16x32_bf16 a[12:15], a[236:239], v[0:3], a[12:15]
    v_lshlrev_b32 v100, 8, v97
    v_lshl_add_u32 v99, v99, 4, v100
    v_mfma_f32_16x16x32_bf16 a[16:19], a[240:243], v[0:3], a[16:19]
    v_and_b32 v100, 1, v98
    v_lshl_add_u32 v99, v100, 3, v99
    v_mfma_f32_16x16x32_bf16 a[20:23], a[244:247], v[0:3], a[20:23]
    v_add_u32 v104, s35, v99
    v_xor_b32 v105, 32, v104
    v_mfma_f32_16x16x32_bf16 a[24:27], a[248:251], v[0:3], a[24:27]
    v_xor_b32 v106, 64, v104
    v_xor_b32 v107, 96, v104
    v_mfma_f32_16x16x32_bf16 a[28:31], a[252:255], v[0:3], a[28:31]
    v_xor_b32 v99, v97, v98
    v_lshlrev_b32 v100, 8, v98
    v_mfma_f32_16x16x32_bf16 a[160:163], a[224:227], v[40:43], a[160:163]
    v_lshl_add_u32 v99, v99, 4, v100
    v_add_u32 v108, s35, v99
    v_mfma_f32_16x16x32_bf16 a[128:131], a[224:227], v[32:35], a[128:131]
    v_xor_b32 v109, 64, v108
    v_lshlrev_b32 v99, 4, v96
    v_mfma_f32_16x16x32_bf16 a[96:99], a[224:227], v[24:27], a[96:99]
    v_add_u32 v110, s34, v99
    v_mfma_f32_16x16x32_bf16 a[64:67], a[224:227], v[16:19], a[64:67]
    v_mfma_f32_16x16x32_bf16 a[32:35], a[224:227], v[8:11], a[32:35]
    v_mfma_f32_16x16x32_bf16 a[36:39], a[228:231], v[8:11], a[36:39]
    v_mfma_f32_16x16x32_bf16 a[68:71], a[228:231], v[16:19], a[68:71]
    v_mfma_f32_16x16x32_bf16 a[100:103], a[228:231], v[24:27], a[100:103]
    v_rcp_f32 v122, v120
    v_mfma_f32_16x16x32_bf16 a[132:135], a[228:231], v[32:35], a[132:135]
    v_accvgpr_read_b32 v160, a0
    v_accvgpr_read_b32 v161, a1
    v_mfma_f32_16x16x32_bf16 a[164:167], a[228:231], v[40:43], a[164:167]
    v_accvgpr_read_b32 v162, a2
    v_accvgpr_read_b32 v163, a3
    v_mfma_f32_16x16x32_bf16 a[168:171], a[232:235], v[40:43], a[168:171]
    v_accvgpr_read_b32 v164, a4
    v_accvgpr_read_b32 v165, a5
    v_mfma_f32_16x16x32_bf16 a[136:139], a[232:235], v[32:35], a[136:139]
    v_accvgpr_read_b32 v166, a6
    v_accvgpr_read_b32 v167, a7
    v_mfma_f32_16x16x32_bf16 a[104:107], a[232:235], v[24:27], a[104:107]
    v_pk_mul_f32 v[160:161], v[160:161], v[122:123] op_sel_hi:[1,0]
    v_pk_mul_f32 v[162:163], v[162:163], v[122:123] op_sel_hi:[1,0]
    v_mfma_f32_16x16x32_bf16 a[72:75], a[232:235], v[16:19], a[72:75]
    v_pk_mul_f32 v[164:165], v[164:165], v[122:123] op_sel_hi:[1,0]
    v_pk_mul_f32 v[166:167], v[166:167], v[122:123] op_sel_hi:[1,0]
    v_mfma_f32_16x16x32_bf16 a[40:43], a[232:235], v[8:11], a[40:43]
    v_cvt_pk_bf16_f32 v176, v160, v161
    v_cvt_pk_bf16_f32 v177, v162, v163
    v_mfma_f32_16x16x32_bf16 a[44:47], a[236:239], v[8:11], a[44:47]
    v_cvt_pk_bf16_f32 v178, v164, v165
    v_cvt_pk_bf16_f32 v179, v166, v167
    v_mfma_f32_16x16x32_bf16 a[76:79], a[236:239], v[16:19], a[76:79]
    ds_write_b64 v104, v[176:177]
    ds_write_b64 v105, v[178:179]
    v_mfma_f32_16x16x32_bf16 a[108:111], a[236:239], v[24:27], a[108:111]
    v_accvgpr_read_b32 v168, a8
    v_accvgpr_read_b32 v169, a9
    v_mfma_f32_16x16x32_bf16 a[140:143], a[236:239], v[32:35], a[140:143]
    v_accvgpr_read_b32 v170, a10
    v_accvgpr_read_b32 v171, a11
    v_mfma_f32_16x16x32_bf16 a[172:175], a[236:239], v[40:43], a[172:175]
    v_accvgpr_read_b32 v172, a12
    v_accvgpr_read_b32 v173, a13
    v_mfma_f32_16x16x32_bf16 a[176:179], a[240:243], v[40:43], a[176:179]
    v_accvgpr_read_b32 v174, a14
    v_accvgpr_read_b32 v175, a15
    v_mfma_f32_16x16x32_bf16 a[144:147], a[240:243], v[32:35], a[144:147]
    v_pk_mul_f32 v[168:169], v[168:169], v[122:123] op_sel_hi:[1,0]
    v_pk_mul_f32 v[170:171], v[170:171], v[122:123] op_sel_hi:[1,0]
    v_mfma_f32_16x16x32_bf16 a[112:115], a[240:243], v[24:27], a[112:115]
    v_pk_mul_f32 v[172:173], v[172:173], v[122:123] op_sel_hi:[1,0]
    v_pk_mul_f32 v[174:175], v[174:175], v[122:123] op_sel_hi:[1,0]
    v_mfma_f32_16x16x32_bf16 a[80:83], a[240:243], v[16:19], a[80:83]
    v_cvt_pk_bf16_f32 v180, v168, v169
    v_cvt_pk_bf16_f32 v181, v170, v171
    v_mfma_f32_16x16x32_bf16 a[48:51], a[240:243], v[8:11], a[48:51]
    v_cvt_pk_bf16_f32 v182, v172, v173
    v_cvt_pk_bf16_f32 v183, v174, v175
    v_mfma_f32_16x16x32_bf16 a[52:55], a[244:247], v[8:11], a[52:55]
    ds_write_b64 v106, v[180:181]
    ds_write_b64 v107, v[182:183]
    v_mfma_f32_16x16x32_bf16 a[84:87], a[244:247], v[16:19], a[84:87]
    v_accvgpr_read_b32 v160, a16
    v_accvgpr_read_b32 v161, a17
    v_mfma_f32_16x16x32_bf16 a[116:119], a[244:247], v[24:27], a[116:119]
    v_accvgpr_read_b32 v162, a18
    v_accvgpr_read_b32 v163, a19
    v_mfma_f32_16x16x32_bf16 a[148:151], a[244:247], v[32:35], a[148:151]
    v_accvgpr_read_b32 v164, a20
    v_accvgpr_read_b32 v165, a21
    v_mfma_f32_16x16x32_bf16 a[180:183], a[244:247], v[40:43], a[180:183]
    v_accvgpr_read_b32 v166, a22
    v_accvgpr_read_b32 v167, a23
    v_mfma_f32_16x16x32_bf16 a[184:187], a[248:251], v[40:43], a[184:187]
    v_pk_mul_f32 v[160:161], v[160:161], v[122:123] op_sel_hi:[1,0]
    v_pk_mul_f32 v[162:163], v[162:163], v[122:123] op_sel_hi:[1,0]
    v_mfma_f32_16x16x32_bf16 a[152:155], a[248:251], v[32:35], a[152:155]
    v_pk_mul_f32 v[164:165], v[164:165], v[122:123] op_sel_hi:[1,0]
    v_pk_mul_f32 v[166:167], v[166:167], v[122:123] op_sel_hi:[1,0]
    v_mfma_f32_16x16x32_bf16 a[120:123], a[248:251], v[24:27], a[120:123]
    v_cvt_pk_bf16_f32 v176, v160, v161
    v_cvt_pk_bf16_f32 v177, v162, v163
    v_mfma_f32_16x16x32_bf16 a[88:91], a[248:251], v[16:19], a[88:91]
    v_cvt_pk_bf16_f32 v178, v164, v165
    v_cvt_pk_bf16_f32 v179, v166, v167
    v_mfma_f32_16x16x32_bf16 a[56:59], a[248:251], v[8:11], a[56:59]
    ds_write_b64 v104, v[176:177] offset:128
    ds_write_b64 v105, v[178:179] offset:128
    v_mfma_f32_16x16x32_bf16 a[60:63], a[252:255], v[8:11], a[60:63]
    v_accvgpr_read_b32 v168, a24
    v_accvgpr_read_b32 v169, a25
    v_mfma_f32_16x16x32_bf16 a[92:95], a[252:255], v[16:19], a[92:95]
    v_accvgpr_read_b32 v170, a26
    v_accvgpr_read_b32 v171, a27
    v_mfma_f32_16x16x32_bf16 a[124:127], a[252:255], v[24:27], a[124:127]
    v_accvgpr_read_b32 v172, a28
    v_accvgpr_read_b32 v173, a29
    v_mfma_f32_16x16x32_bf16 a[156:159], a[252:255], v[32:35], a[156:159]
    v_accvgpr_read_b32 v174, a30
    v_accvgpr_read_b32 v175, a31
    v_mfma_f32_16x16x32_bf16 a[188:191], a[252:255], v[40:43], a[188:191]
    v_pk_mul_f32 v[168:169], v[168:169], v[122:123] op_sel_hi:[1,0]
    v_pk_mul_f32 v[170:171], v[170:171], v[122:123] op_sel_hi:[1,0]
    v_mfma_f32_16x16x32_bf16 v[124:127], v[48:51], v[8:11], v[124:127]
    v_pk_mul_f32 v[172:173], v[172:173], v[122:123] op_sel_hi:[1,0]
    v_pk_mul_f32 v[174:175], v[174:175], v[122:123] op_sel_hi:[1,0]
    v_mfma_f32_16x16x32_bf16 v[128:131], v[48:51], v[16:19], v[128:131]
    v_cvt_pk_bf16_f32 v180, v168, v169
    v_cvt_pk_bf16_f32 v181, v170, v171
    v_mfma_f32_16x16x32_bf16 v[132:135], v[48:51], v[24:27], v[132:135]
    v_cvt_pk_bf16_f32 v182, v172, v173
    v_cvt_pk_bf16_f32 v183, v174, v175
    v_mfma_f32_16x16x32_bf16 v[136:139], v[48:51], v[32:35], v[136:139]
    ds_write_b64 v106, v[180:181] offset:128
    ds_write_b64 v107, v[182:183] offset:128
    v_mfma_f32_16x16x32_bf16 v[140:143], v[48:51], v[40:43], v[140:143]
    ds_read_b128 v[184:187], v108
    ds_read_b128 v[188:191], v109 offset:1024
    ds_read_b128 v[192:195], v108 offset:2048
    ds_read_b128 v[196:199], v109 offset:3072
    s_nop 5
    v_rcp_f32 v126, v124
    v_accvgpr_read_b32 v160, a32
    v_accvgpr_read_b32 v161, a33
    v_accvgpr_read_b32 v162, a34
    v_accvgpr_read_b32 v163, a35
    v_accvgpr_read_b32 v164, a36
    v_accvgpr_read_b32 v165, a37
    v_accvgpr_read_b32 v166, a38
    v_accvgpr_read_b32 v167, a39
    v_pk_mul_f32 v[160:161], v[160:161], v[126:127] op_sel_hi:[1,0]
    v_pk_mul_f32 v[162:163], v[162:163], v[126:127] op_sel_hi:[1,0]
    v_pk_mul_f32 v[164:165], v[164:165], v[126:127] op_sel_hi:[1,0]
    v_pk_mul_f32 v[166:167], v[166:167], v[126:127] op_sel_hi:[1,0]
    v_cvt_pk_bf16_f32 v176, v160, v161
    v_cvt_pk_bf16_f32 v177, v162, v163
    v_cvt_pk_bf16_f32 v178, v164, v165
    v_cvt_pk_bf16_f32 v179, v166, v167
    ds_write_b64 v104, v[176:177] offset:40960
    ds_write_b64 v105, v[178:179] offset:40960
    s_mov_b32 s36, 0
    s_waitcnt lgkmcnt(2)
    buffer_store_dwordx4 v[184:187], v110, s[24:27], s36 offen nt
    buffer_store_dwordx4 v[188:191], v110, s[24:27], s36 offen offset:1024 nt
    buffer_store_dwordx4 v[192:195], v110, s[24:27], s36 offen offset:2048 nt
    buffer_store_dwordx4 v[196:199], v110, s[24:27], s36 offen offset:3072 nt
    v_accvgpr_read_b32 v168, a40
    v_accvgpr_read_b32 v169, a41
    v_accvgpr_read_b32 v170, a42
    v_accvgpr_read_b32 v171, a43
    v_accvgpr_read_b32 v172, a44
    v_accvgpr_read_b32 v173, a45
    v_accvgpr_read_b32 v174, a46
    v_accvgpr_read_b32 v175, a47
    v_pk_mul_f32 v[168:169], v[168:169], v[126:127] op_sel_hi:[1,0]
    v_pk_mul_f32 v[170:171], v[170:171], v[126:127] op_sel_hi:[1,0]
    v_pk_mul_f32 v[172:173], v[172:173], v[126:127] op_sel_hi:[1,0]
    v_pk_mul_f32 v[174:175], v[174:175], v[126:127] op_sel_hi:[1,0]
    v_cvt_pk_bf16_f32 v180, v168, v169
    v_cvt_pk_bf16_f32 v181, v170, v171
    v_cvt_pk_bf16_f32 v182, v172, v173
    v_cvt_pk_bf16_f32 v183, v174, v175
    ds_write_b64 v106, v[180:181] offset:40960
    ds_write_b64 v107, v[182:183] offset:40960
    v_accvgpr_read_b32 v160, a48
    v_accvgpr_read_b32 v161, a49
    v_accvgpr_read_b32 v162, a50
    v_accvgpr_read_b32 v163, a51
    v_accvgpr_read_b32 v164, a52
    v_accvgpr_read_b32 v165, a53
    v_accvgpr_read_b32 v166, a54
    v_accvgpr_read_b32 v167, a55
    v_pk_mul_f32 v[160:161], v[160:161], v[126:127] op_sel_hi:[1,0]
    v_pk_mul_f32 v[162:163], v[162:163], v[126:127] op_sel_hi:[1,0]
    v_pk_mul_f32 v[164:165], v[164:165], v[126:127] op_sel_hi:[1,0]
    v_pk_mul_f32 v[166:167], v[166:167], v[126:127] op_sel_hi:[1,0]
    v_cvt_pk_bf16_f32 v176, v160, v161
    v_cvt_pk_bf16_f32 v177, v162, v163
    v_cvt_pk_bf16_f32 v178, v164, v165
    v_cvt_pk_bf16_f32 v179, v166, v167
    ds_write_b64 v104, v[176:177] offset:41088
    ds_write_b64 v105, v[178:179] offset:41088
    v_accvgpr_read_b32 v168, a56
    v_accvgpr_read_b32 v169, a57
    v_accvgpr_read_b32 v170, a58
    v_accvgpr_read_b32 v171, a59
    v_accvgpr_read_b32 v172, a60
    v_accvgpr_read_b32 v173, a61
    v_accvgpr_read_b32 v174, a62
    v_accvgpr_read_b32 v175, a63
    v_pk_mul_f32 v[168:169], v[168:169], v[126:127] op_sel_hi:[1,0]
    v_pk_mul_f32 v[170:171], v[170:171], v[126:127] op_sel_hi:[1,0]
    v_pk_mul_f32 v[172:173], v[172:173], v[126:127] op_sel_hi:[1,0]
    v_pk_mul_f32 v[174:175], v[174:175], v[126:127] op_sel_hi:[1,0]
    v_cvt_pk_bf16_f32 v180, v168, v169
    v_cvt_pk_bf16_f32 v181, v170, v171
    v_cvt_pk_bf16_f32 v182, v172, v173
    v_cvt_pk_bf16_f32 v183, v174, v175
    ds_write_b64 v106, v[180:181] offset:41088
    ds_write_b64 v107, v[182:183] offset:41088
    ds_read_b128 v[184:187], v108 offset:40960
    ds_read_b128 v[188:191], v109 offset:41984
    ds_read_b128 v[192:195], v108 offset:43008
    ds_read_b128 v[196:199], v109 offset:44032
    v_rcp_f32 v130, v128
    v_accvgpr_read_b32 v160, a64
    v_accvgpr_read_b32 v161, a65
    v_accvgpr_read_b32 v162, a66
    v_accvgpr_read_b32 v163, a67
    v_accvgpr_read_b32 v164, a68
    v_accvgpr_read_b32 v165, a69
    v_accvgpr_read_b32 v166, a70
    v_accvgpr_read_b32 v167, a71
    v_pk_mul_f32 v[160:161], v[160:161], v[130:131] op_sel_hi:[1,0]
    v_pk_mul_f32 v[162:163], v[162:163], v[130:131] op_sel_hi:[1,0]
    v_pk_mul_f32 v[164:165], v[164:165], v[130:131] op_sel_hi:[1,0]
    v_pk_mul_f32 v[166:167], v[166:167], v[130:131] op_sel_hi:[1,0]
    v_cvt_pk_bf16_f32 v176, v160, v161
    v_cvt_pk_bf16_f32 v177, v162, v163
    v_cvt_pk_bf16_f32 v178, v164, v165
    v_cvt_pk_bf16_f32 v179, v166, v167
    ds_write_b64 v104, v[176:177] offset:8192
    ds_write_b64 v105, v[178:179] offset:8192
    s_mov_b32 s36, 4096
    s_waitcnt lgkmcnt(2)
    buffer_store_dwordx4 v[184:187], v110, s[24:27], s36 offen nt
    buffer_store_dwordx4 v[188:191], v110, s[24:27], s36 offen offset:1024 nt
    buffer_store_dwordx4 v[192:195], v110, s[24:27], s36 offen offset:2048 nt
    buffer_store_dwordx4 v[196:199], v110, s[24:27], s36 offen offset:3072 nt
    v_accvgpr_read_b32 v168, a72
    v_accvgpr_read_b32 v169, a73
    v_accvgpr_read_b32 v170, a74
    v_accvgpr_read_b32 v171, a75
    v_accvgpr_read_b32 v172, a76
    v_accvgpr_read_b32 v173, a77
    v_accvgpr_read_b32 v174, a78
    v_accvgpr_read_b32 v175, a79
    v_pk_mul_f32 v[168:169], v[168:169], v[130:131] op_sel_hi:[1,0]
    v_pk_mul_f32 v[170:171], v[170:171], v[130:131] op_sel_hi:[1,0]
    v_pk_mul_f32 v[172:173], v[172:173], v[130:131] op_sel_hi:[1,0]
    v_pk_mul_f32 v[174:175], v[174:175], v[130:131] op_sel_hi:[1,0]
    v_cvt_pk_bf16_f32 v180, v168, v169
    v_cvt_pk_bf16_f32 v181, v170, v171
    v_cvt_pk_bf16_f32 v182, v172, v173
    v_cvt_pk_bf16_f32 v183, v174, v175
    ds_write_b64 v106, v[180:181] offset:8192
    ds_write_b64 v107, v[182:183] offset:8192
    v_accvgpr_read_b32 v160, a80
    v_accvgpr_read_b32 v161, a81
    v_accvgpr_read_b32 v162, a82
    v_accvgpr_read_b32 v163, a83
    v_accvgpr_read_b32 v164, a84
    v_accvgpr_read_b32 v165, a85
    v_accvgpr_read_b32 v166, a86
    v_accvgpr_read_b32 v167, a87
    v_pk_mul_f32 v[160:161], v[160:161], v[130:131] op_sel_hi:[1,0]
    v_pk_mul_f32 v[162:163], v[162:163], v[130:131] op_sel_hi:[1,0]
    v_pk_mul_f32 v[164:165], v[164:165], v[130:131] op_sel_hi:[1,0]
    v_pk_mul_f32 v[166:167], v[166:167], v[130:131] op_sel_hi:[1,0]
    v_cvt_pk_bf16_f32 v176, v160, v161
    v_cvt_pk_bf16_f32 v177, v162, v163
    v_cvt_pk_bf16_f32 v178, v164, v165
    v_cvt_pk_bf16_f32 v179, v166, v167
    ds_write_b64 v104, v[176:177] offset:8320
    ds_write_b64 v105, v[178:179] offset:8320
    v_accvgpr_read_b32 v168, a88
    v_accvgpr_read_b32 v169, a89
    v_accvgpr_read_b32 v170, a90
    v_accvgpr_read_b32 v171, a91
    v_accvgpr_read_b32 v172, a92
    v_accvgpr_read_b32 v173, a93
    v_accvgpr_read_b32 v174, a94
    v_accvgpr_read_b32 v175, a95
    v_pk_mul_f32 v[168:169], v[168:169], v[130:131] op_sel_hi:[1,0]
    v_pk_mul_f32 v[170:171], v[170:171], v[130:131] op_sel_hi:[1,0]
    v_pk_mul_f32 v[172:173], v[172:173], v[130:131] op_sel_hi:[1,0]
    v_pk_mul_f32 v[174:175], v[174:175], v[130:131] op_sel_hi:[1,0]
    v_cvt_pk_bf16_f32 v180, v168, v169
    v_cvt_pk_bf16_f32 v181, v170, v171
    v_cvt_pk_bf16_f32 v182, v172, v173
    v_cvt_pk_bf16_f32 v183, v174, v175
    ds_write_b64 v106, v[180:181] offset:8320
    ds_write_b64 v107, v[182:183] offset:8320
    ds_read_b128 v[184:187], v108 offset:8192
    ds_read_b128 v[188:191], v109 offset:9216
    ds_read_b128 v[192:195], v108 offset:10240
    ds_read_b128 v[196:199], v109 offset:11264
    v_rcp_f32 v134, v132
    v_accvgpr_read_b32 v160, a96
    v_accvgpr_read_b32 v161, a97
    v_accvgpr_read_b32 v162, a98
    v_accvgpr_read_b32 v163, a99
    v_accvgpr_read_b32 v164, a100
    v_accvgpr_read_b32 v165, a101
    v_accvgpr_read_b32 v166, a102
    v_accvgpr_read_b32 v167, a103
    v_pk_mul_f32 v[160:161], v[160:161], v[134:135] op_sel_hi:[1,0]
    v_pk_mul_f32 v[162:163], v[162:163], v[134:135] op_sel_hi:[1,0]
    v_pk_mul_f32 v[164:165], v[164:165], v[134:135] op_sel_hi:[1,0]
    v_pk_mul_f32 v[166:167], v[166:167], v[134:135] op_sel_hi:[1,0]
    v_cvt_pk_bf16_f32 v176, v160, v161
    v_cvt_pk_bf16_f32 v177, v162, v163
    v_cvt_pk_bf16_f32 v178, v164, v165
    v_cvt_pk_bf16_f32 v179, v166, v167
    ds_write_b64 v104, v[176:177] offset:49152
    ds_write_b64 v105, v[178:179] offset:49152
    s_mov_b32 s36, 8192
    s_waitcnt lgkmcnt(2)
    buffer_store_dwordx4 v[184:187], v110, s[24:27], s36 offen nt
    buffer_store_dwordx4 v[188:191], v110, s[24:27], s36 offen offset:1024 nt
    buffer_store_dwordx4 v[192:195], v110, s[24:27], s36 offen offset:2048 nt
    buffer_store_dwordx4 v[196:199], v110, s[24:27], s36 offen offset:3072 nt
    v_accvgpr_read_b32 v168, a104
    v_accvgpr_read_b32 v169, a105
    v_accvgpr_read_b32 v170, a106
    v_accvgpr_read_b32 v171, a107
    v_accvgpr_read_b32 v172, a108
    v_accvgpr_read_b32 v173, a109
    v_accvgpr_read_b32 v174, a110
    v_accvgpr_read_b32 v175, a111
    v_pk_mul_f32 v[168:169], v[168:169], v[134:135] op_sel_hi:[1,0]
    v_pk_mul_f32 v[170:171], v[170:171], v[134:135] op_sel_hi:[1,0]
    v_pk_mul_f32 v[172:173], v[172:173], v[134:135] op_sel_hi:[1,0]
    v_pk_mul_f32 v[174:175], v[174:175], v[134:135] op_sel_hi:[1,0]
    v_cvt_pk_bf16_f32 v180, v168, v169
    v_cvt_pk_bf16_f32 v181, v170, v171
    v_cvt_pk_bf16_f32 v182, v172, v173
    v_cvt_pk_bf16_f32 v183, v174, v175
    ds_write_b64 v106, v[180:181] offset:49152
    ds_write_b64 v107, v[182:183] offset:49152
    v_accvgpr_read_b32 v160, a112
    v_accvgpr_read_b32 v161, a113
    v_accvgpr_read_b32 v162, a114
    v_accvgpr_read_b32 v163, a115
    v_accvgpr_read_b32 v164, a116
    v_accvgpr_read_b32 v165, a117
    v_accvgpr_read_b32 v166, a118
    v_accvgpr_read_b32 v167, a119
    v_pk_mul_f32 v[160:161], v[160:161], v[134:135] op_sel_hi:[1,0]
    v_pk_mul_f32 v[162:163], v[162:163], v[134:135] op_sel_hi:[1,0]
    v_pk_mul_f32 v[164:165], v[164:165], v[134:135] op_sel_hi:[1,0]
    v_pk_mul_f32 v[166:167], v[166:167], v[134:135] op_sel_hi:[1,0]
    v_cvt_pk_bf16_f32 v176, v160, v161
    v_cvt_pk_bf16_f32 v177, v162, v163
    v_cvt_pk_bf16_f32 v178, v164, v165
    v_cvt_pk_bf16_f32 v179, v166, v167
    ds_write_b64 v104, v[176:177] offset:49280
    ds_write_b64 v105, v[178:179] offset:49280
    v_accvgpr_read_b32 v168, a120
    v_accvgpr_read_b32 v169, a121
    v_accvgpr_read_b32 v170, a122
    v_accvgpr_read_b32 v171, a123
    v_accvgpr_read_b32 v172, a124
    v_accvgpr_read_b32 v173, a125
    v_accvgpr_read_b32 v174, a126
    v_accvgpr_read_b32 v175, a127
    v_pk_mul_f32 v[168:169], v[168:169], v[134:135] op_sel_hi:[1,0]
    v_pk_mul_f32 v[170:171], v[170:171], v[134:135] op_sel_hi:[1,0]
    v_pk_mul_f32 v[172:173], v[172:173], v[134:135] op_sel_hi:[1,0]
    v_pk_mul_f32 v[174:175], v[174:175], v[134:135] op_sel_hi:[1,0]
    v_cvt_pk_bf16_f32 v180, v168, v169
    v_cvt_pk_bf16_f32 v181, v170, v171
    v_cvt_pk_bf16_f32 v182, v172, v173
    v_cvt_pk_bf16_f32 v183, v174, v175
    ds_write_b64 v106, v[180:181] offset:49280
    ds_write_b64 v107, v[182:183] offset:49280
    ds_read_b128 v[184:187], v108 offset:49152
    ds_read_b128 v[188:191], v109 offset:50176
    ds_read_b128 v[192:195], v108 offset:51200
    ds_read_b128 v[196:199], v109 offset:52224
    v_rcp_f32 v138, v136
    v_accvgpr_read_b32 v160, a128
    v_accvgpr_read_b32 v161, a129
    v_accvgpr_read_b32 v162, a130
    v_accvgpr_read_b32 v163, a131
    v_accvgpr_read_b32 v164, a132
    v_accvgpr_read_b32 v165, a133
    v_accvgpr_read_b32 v166, a134
    v_accvgpr_read_b32 v167, a135
    v_pk_mul_f32 v[160:161], v[160:161], v[138:139] op_sel_hi:[1,0]
    v_pk_mul_f32 v[162:163], v[162:163], v[138:139] op_sel_hi:[1,0]
    v_pk_mul_f32 v[164:165], v[164:165], v[138:139] op_sel_hi:[1,0]
    v_pk_mul_f32 v[166:167], v[166:167], v[138:139] op_sel_hi:[1,0]
    v_cvt_pk_bf16_f32 v176, v160, v161
    v_cvt_pk_bf16_f32 v177, v162, v163
    v_cvt_pk_bf16_f32 v178, v164, v165
    v_cvt_pk_bf16_f32 v179, v166, v167
    ds_write_b64 v104, v[176:177]
    ds_write_b64 v105, v[178:179]
    s_mov_b32 s36, 12288
    s_waitcnt lgkmcnt(2)
    buffer_store_dwordx4 v[184:187], v110, s[24:27], s36 offen nt
    buffer_store_dwordx4 v[188:191], v110, s[24:27], s36 offen offset:1024 nt
    buffer_store_dwordx4 v[192:195], v110, s[24:27], s36 offen offset:2048 nt
    buffer_store_dwordx4 v[196:199], v110, s[24:27], s36 offen offset:3072 nt
    v_accvgpr_read_b32 v168, a136
    v_accvgpr_read_b32 v169, a137
    v_accvgpr_read_b32 v170, a138
    v_accvgpr_read_b32 v171, a139
    v_accvgpr_read_b32 v172, a140
    v_accvgpr_read_b32 v173, a141
    v_accvgpr_read_b32 v174, a142
    v_accvgpr_read_b32 v175, a143
    v_pk_mul_f32 v[168:169], v[168:169], v[138:139] op_sel_hi:[1,0]
    v_pk_mul_f32 v[170:171], v[170:171], v[138:139] op_sel_hi:[1,0]
    v_pk_mul_f32 v[172:173], v[172:173], v[138:139] op_sel_hi:[1,0]
    v_pk_mul_f32 v[174:175], v[174:175], v[138:139] op_sel_hi:[1,0]
    v_cvt_pk_bf16_f32 v180, v168, v169
    v_cvt_pk_bf16_f32 v181, v170, v171
    v_cvt_pk_bf16_f32 v182, v172, v173
    v_cvt_pk_bf16_f32 v183, v174, v175
    ds_write_b64 v106, v[180:181]
    ds_write_b64 v107, v[182:183]
    v_accvgpr_read_b32 v160, a144
    v_accvgpr_read_b32 v161, a145
    v_accvgpr_read_b32 v162, a146
    v_accvgpr_read_b32 v163, a147
    v_accvgpr_read_b32 v164, a148
    v_accvgpr_read_b32 v165, a149
    v_accvgpr_read_b32 v166, a150
    v_accvgpr_read_b32 v167, a151
    v_pk_mul_f32 v[160:161], v[160:161], v[138:139] op_sel_hi:[1,0]
    v_pk_mul_f32 v[162:163], v[162:163], v[138:139] op_sel_hi:[1,0]
    v_pk_mul_f32 v[164:165], v[164:165], v[138:139] op_sel_hi:[1,0]
    v_pk_mul_f32 v[166:167], v[166:167], v[138:139] op_sel_hi:[1,0]
    v_cvt_pk_bf16_f32 v176, v160, v161
    v_cvt_pk_bf16_f32 v177, v162, v163
    v_cvt_pk_bf16_f32 v178, v164, v165
    v_cvt_pk_bf16_f32 v179, v166, v167
    ds_write_b64 v104, v[176:177] offset:128
    ds_write_b64 v105, v[178:179] offset:128
    v_accvgpr_read_b32 v168, a152
    v_accvgpr_read_b32 v169, a153
    v_accvgpr_read_b32 v170, a154
    v_accvgpr_read_b32 v171, a155
    v_accvgpr_read_b32 v172, a156
    v_accvgpr_read_b32 v173, a157
    v_accvgpr_read_b32 v174, a158
    v_accvgpr_read_b32 v175, a159
    v_pk_mul_f32 v[168:169], v[168:169], v[138:139] op_sel_hi:[1,0]
    v_pk_mul_f32 v[170:171], v[170:171], v[138:139] op_sel_hi:[1,0]
    v_pk_mul_f32 v[172:173], v[172:173], v[138:139] op_sel_hi:[1,0]
    v_pk_mul_f32 v[174:175], v[174:175], v[138:139] op_sel_hi:[1,0]
    v_cvt_pk_bf16_f32 v180, v168, v169
    v_cvt_pk_bf16_f32 v181, v170, v171
    v_cvt_pk_bf16_f32 v182, v172, v173
    v_cvt_pk_bf16_f32 v183, v174, v175
    ds_write_b64 v106, v[180:181] offset:128
    ds_write_b64 v107, v[182:183] offset:128
    ds_read_b128 v[184:187], v108
    ds_read_b128 v[188:191], v109 offset:1024
    ds_read_b128 v[192:195], v108 offset:2048
    ds_read_b128 v[196:199], v109 offset:3072
    v_rcp_f32 v142, v140
    v_accvgpr_read_b32 v160, a160
    v_accvgpr_read_b32 v161, a161
    v_accvgpr_read_b32 v162, a162
    v_accvgpr_read_b32 v163, a163
    v_accvgpr_read_b32 v164, a164
    v_accvgpr_read_b32 v165, a165
    v_accvgpr_read_b32 v166, a166
    v_accvgpr_read_b32 v167, a167
    v_pk_mul_f32 v[160:161], v[160:161], v[142:143] op_sel_hi:[1,0]
    v_pk_mul_f32 v[162:163], v[162:163], v[142:143] op_sel_hi:[1,0]
    v_pk_mul_f32 v[164:165], v[164:165], v[142:143] op_sel_hi:[1,0]
    v_pk_mul_f32 v[166:167], v[166:167], v[142:143] op_sel_hi:[1,0]
    v_cvt_pk_bf16_f32 v176, v160, v161
    v_cvt_pk_bf16_f32 v177, v162, v163
    v_cvt_pk_bf16_f32 v178, v164, v165
    v_cvt_pk_bf16_f32 v179, v166, v167
    ds_write_b64 v104, v[176:177] offset:40960
    ds_write_b64 v105, v[178:179] offset:40960
    s_mov_b32 s36, 16384
    s_waitcnt lgkmcnt(2)
    buffer_store_dwordx4 v[184:187], v110, s[24:27], s36 offen nt
    buffer_store_dwordx4 v[188:191], v110, s[24:27], s36 offen offset:1024 nt
    buffer_store_dwordx4 v[192:195], v110, s[24:27], s36 offen offset:2048 nt
    buffer_store_dwordx4 v[196:199], v110, s[24:27], s36 offen offset:3072 nt
    v_accvgpr_read_b32 v168, a168
    v_accvgpr_read_b32 v169, a169
    v_accvgpr_read_b32 v170, a170
    v_accvgpr_read_b32 v171, a171
    v_accvgpr_read_b32 v172, a172
    v_accvgpr_read_b32 v173, a173
    v_accvgpr_read_b32 v174, a174
    v_accvgpr_read_b32 v175, a175
    v_pk_mul_f32 v[168:169], v[168:169], v[142:143] op_sel_hi:[1,0]
    v_pk_mul_f32 v[170:171], v[170:171], v[142:143] op_sel_hi:[1,0]
    v_pk_mul_f32 v[172:173], v[172:173], v[142:143] op_sel_hi:[1,0]
    v_pk_mul_f32 v[174:175], v[174:175], v[142:143] op_sel_hi:[1,0]
    v_cvt_pk_bf16_f32 v180, v168, v169
    v_cvt_pk_bf16_f32 v181, v170, v171
    v_cvt_pk_bf16_f32 v182, v172, v173
    v_cvt_pk_bf16_f32 v183, v174, v175
    ds_write_b64 v106, v[180:181] offset:40960
    ds_write_b64 v107, v[182:183] offset:40960
    v_accvgpr_read_b32 v160, a176
    v_accvgpr_read_b32 v161, a177
    v_accvgpr_read_b32 v162, a178
    v_accvgpr_read_b32 v163, a179
    v_accvgpr_read_b32 v164, a180
    v_accvgpr_read_b32 v165, a181
    v_accvgpr_read_b32 v166, a182
    v_accvgpr_read_b32 v167, a183
    v_pk_mul_f32 v[160:161], v[160:161], v[142:143] op_sel_hi:[1,0]
    v_pk_mul_f32 v[162:163], v[162:163], v[142:143] op_sel_hi:[1,0]
    v_pk_mul_f32 v[164:165], v[164:165], v[142:143] op_sel_hi:[1,0]
    v_pk_mul_f32 v[166:167], v[166:167], v[142:143] op_sel_hi:[1,0]
    v_cvt_pk_bf16_f32 v176, v160, v161
    v_cvt_pk_bf16_f32 v177, v162, v163
    v_cvt_pk_bf16_f32 v178, v164, v165
    v_cvt_pk_bf16_f32 v179, v166, v167
    ds_write_b64 v104, v[176:177] offset:41088
    ds_write_b64 v105, v[178:179] offset:41088
    v_accvgpr_read_b32 v168, a184
    v_accvgpr_read_b32 v169, a185
    v_accvgpr_read_b32 v170, a186
    v_accvgpr_read_b32 v171, a187
    v_accvgpr_read_b32 v172, a188
    v_accvgpr_read_b32 v173, a189
    v_accvgpr_read_b32 v174, a190
    v_accvgpr_read_b32 v175, a191
    v_pk_mul_f32 v[168:169], v[168:169], v[142:143] op_sel_hi:[1,0]
    v_pk_mul_f32 v[170:171], v[170:171], v[142:143] op_sel_hi:[1,0]
    v_pk_mul_f32 v[172:173], v[172:173], v[142:143] op_sel_hi:[1,0]
    v_pk_mul_f32 v[174:175], v[174:175], v[142:143] op_sel_hi:[1,0]
    v_cvt_pk_bf16_f32 v180, v168, v169
    v_cvt_pk_bf16_f32 v181, v170, v171
    v_cvt_pk_bf16_f32 v182, v172, v173
    v_cvt_pk_bf16_f32 v183, v174, v175
    ds_write_b64 v106, v[180:181] offset:41088
    ds_write_b64 v107, v[182:183] offset:41088
    ds_read_b128 v[184:187], v108 offset:40960
    ds_read_b128 v[188:191], v109 offset:41984
    ds_read_b128 v[192:195], v108 offset:43008
    ds_read_b128 v[196:199], v109 offset:44032
    s_mov_b32 s36, 20480
    s_waitcnt lgkmcnt(0)
    buffer_store_dwordx4 v[184:187], v110, s[24:27], s36 offen nt
    buffer_store_dwordx4 v[188:191], v110, s[24:27], s36 offen offset:1024 nt
    buffer_store_dwordx4 v[192:195], v110, s[24:27], s36 offen offset:2048 nt
    buffer_store_dwordx4 v[196:199], v110, s[24:27], s36 offen offset:3072 nt
L_done:
L_end:
    s_endpgm
L_rare0:
    s_call_b64 s[70:71], L_rescale
    s_branch L_back0
L_rare1:
    s_call_b64 s[70:71], L_rescale
    s_branch L_back1
L_rare2:
    s_call_b64 s[70:71], L_rescale
    s_branch L_back2
L_rare3:
    s_call_b64 s[70:71], L_rescale
    s_branch L_back3
L_rescale:
    v_max3_f32 v155, v0, v1, v2
    v_max3_f32 v155, v155, v3, v4
    v_max3_f32 v155, v155, v5, v6
    v_max3_f32 v155, v155, v7, 0
    v_mov_b32 v156, v155
    s_nop 1
    v_permlane16_swap_b32 v155, v156
    v_max_f32 v155, v155, v156
    v_mov_b32 v156, v155
    s_nop 1
    v_permlane32_swap_b32 v155, v156
    v_max_f32 v155, v155, v156
    v_exp_f32 v157, -v155
    v_sub_f32 v0, v0, v155
    v_sub_f32 v1, v1, v155
    v_sub_f32 v2, v2, v155
    v_sub_f32 v3, v3, v155
    v_sub_f32 v4, v4, v155
    v_sub_f32 v5, v5, v155
    v_sub_f32 v6, v6, v155
    v_sub_f32 v7, v7, v155
    v_sub_f32 v96, v96, v155
    v_sub_f32 v97, v97, v155
    v_sub_f32 v98, v98, v155
    v_sub_f32 v99, v99, v155
    v_mul_f32 v120, v120, v157
    v_mul_f32 v121, v121, v157
    v_mul_f32 v122, v122, v157
    v_mul_f32 v123, v123, v157
    v_accvgpr_read_b32 v52, a0
    v_accvgpr_read_b32 v53, a1
    v_accvgpr_read_b32 v54, a2
    v_accvgpr_read_b32 v55, a3
    v_accvgpr_read_b32 v56, a4
    v_accvgpr_read_b32 v57, a5
    v_accvgpr_read_b32 v58, a6
    v_accvgpr_read_b32 v59, a7
    v_mul_f32 v52, v52, v157
    v_mul_f32 v53, v53, v157
    v_mul_f32 v54, v54, v157
    v_mul_f32 v55, v55, v157
    v_mul_f32 v56, v56, v157
    v_mul_f32 v57, v57, v157
    v_mul_f32 v58, v58, v157
    v_mul_f32 v59, v59, v157
    v_accvgpr_write_b32 a0, v52
    v_accvgpr_write_b32 a1, v53
    v_accvgpr_write_b32 a2, v54
    v_accvgpr_write_b32 a3, v55
    v_accvgpr_write_b32 a4, v56
    v_accvgpr_write_b32 a5, v57
    v_accvgpr_write_b32 a6, v58
    v_accvgpr_write_b32 a7, v59
    v_accvgpr_read_b32 v52, a8
    v_accvgpr_read_b32 v53, a9
    v_accvgpr_read_b32 v54, a10
    v_accvgpr_read_b32 v55, a11
    v_accvgpr_read_b32 v56, a12
    v_accvgpr_read_b32 v57, a13
    v_accvgpr_read_b32 v58, a14
    v_accvgpr_read_b32 v59, a15
    v_mul_f32 v52, v52, v157
    v_mul_f32 v53, v53, v157
    v_mul_f32 v54, v54, v157
    v_mul_f32 v55, v55, v157
    v_mul_f32 v56, v56, v157
    v_mul_f32 v57, v57, v157
    v_mul_f32 v58, v58, v157
    v_mul_f32 v59, v59, v157
    v_accvgpr_write_b32 a8, v52
    v_accvgpr_write_b32 a9, v53
    v_accvgpr_write_b32 a10, v54
    v_accvgpr_write_b32 a11, v55
    v_accvgpr_write_b32 a12, v56
    v_accvgpr_write_b32 a13, v57
    v_accvgpr_write_b32 a14, v58
    v_accvgpr_write_b32 a15, v59
    v_accvgpr_read_b32 v52, a16
    v_accvgpr_read_b32 v53, a17
    v_accvgpr_read_b32 v54, a18
    v_accvgpr_read_b32 v55, a19
    v_accvgpr_read_b32 v56, a20
    v_accvgpr_read_b32 v57, a21
    v_accvgpr_read_b32 v58, a22
    v_accvgpr_read_b32 v59, a23
    v_mul_f32 v52, v52, v157
    v_mul_f32 v53, v53, v157
    v_mul_f32 v54, v54, v157
    v_mul_f32 v55, v55, v157
    v_mul_f32 v56, v56, v157
    v_mul_f32 v57, v57, v157
    v_mul_f32 v58, v58, v157
    v_mul_f32 v59, v59, v157
    v_accvgpr_write_b32 a16, v52
    v_accvgpr_write_b32 a17, v53
    v_accvgpr_write_b32 a18, v54
    v_accvgpr_write_b32 a19, v55
    v_accvgpr_write_b32 a20, v56
    v_accvgpr_write_b32 a21, v57
    v_accvgpr_write_b32 a22, v58
    v_accvgpr_write_b32 a23, v59
    v_accvgpr_read_b32 v52, a24
    v_accvgpr_read_b32 v53, a25
    v_accvgpr_read_b32 v54, a26
    v_accvgpr_read_b32 v55, a27
    v_accvgpr_read_b32 v56, a28
    v_accvgpr_read_b32 v57, a29
    v_accvgpr_read_b32 v58, a30
    v_accvgpr_read_b32 v59, a31
    v_mul_f32 v52, v52, v157
    v_mul_f32 v53, v53, v157
    v_mul_f32 v54, v54, v157
    v_mul_f32 v55, v55, v157
    v_mul_f32 v56, v56, v157
    v_mul_f32 v57, v57, v157
    v_mul_f32 v58, v58, v157
    v_mul_f32 v59, v59, v157
    v_accvgpr_write_b32 a24, v52
    v_accvgpr_write_b32 a25, v53
    v_accvgpr_write_b32 a26, v54
    v_accvgpr_write_b32 a27, v55
    v_accvgpr_write_b32 a28, v56
    v_accvgpr_write_b32 a29, v57
    v_accvgpr_write_b32 a30, v58
    v_accvgpr_write_b32 a31, v59
    v_max3_f32 v155, v8, v9, v10
    v_max3_f32 v155, v155, v11, v12
    v_max3_f32 v155, v155, v13, v14
    v_max3_f32 v155, v155, v15, 0
    v_mov_b32 v156, v155
    s_nop 1
    v_permlane16_swap_b32 v155, v156
    v_max_f32 v155, v155, v156
    v_mov_b32 v156, v155
    s_nop 1
    v_permlane32_swap_b32 v155, v156
    v_max_f32 v155, v155, v156
    v_exp_f32 v157, -v155
    v_sub_f32 v8, v8, v155
    v_sub_f32 v9, v9, v155
    v_sub_f32 v10, v10, v155
    v_sub_f32 v11, v11, v155
    v_sub_f32 v12, v12, v155
    v_sub_f32 v13, v13, v155
    v_sub_f32 v14, v14, v155
    v_sub_f32 v15, v15, v155
    v_sub_f32 v100, v100, v155
    v_sub_f32 v101, v101, v155
    v_sub_f32 v102, v102, v155
    v_sub_f32 v103, v103, v155
    v_mul_f32 v124, v124, v157
    v_mul_f32 v125, v125, v157
    v_mul_f32 v126, v126, v157
    v_mul_f32 v127, v127, v157
    v_accvgpr_read_b32 v52, a32
    v_accvgpr_read_b32 v53, a33
    v_accvgpr_read_b32 v54, a34
    v_accvgpr_read_b32 v55, a35
    v_accvgpr_read_b32 v56, a36
    v_accvgpr_read_b32 v57, a37
    v_accvgpr_read_b32 v58, a38
    v_accvgpr_read_b32 v59, a39
    v_mul_f32 v52, v52, v157
    v_mul_f32 v53, v53, v157
    v_mul_f32 v54, v54, v157
    v_mul_f32 v55, v55, v157
    v_mul_f32 v56, v56, v157
    v_mul_f32 v57, v57, v157
    v_mul_f32 v58, v58, v157
    v_mul_f32 v59, v59, v157
    v_accvgpr_write_b32 a32, v52
    v_accvgpr_write_b32 a33, v53
    v_accvgpr_write_b32 a34, v54
    v_accvgpr_write_b32 a35, v55
    v_accvgpr_write_b32 a36, v56
    v_accvgpr_write_b32 a37, v57
    v_accvgpr_write_b32 a38, v58
    v_accvgpr_write_b32 a39, v59
    v_accvgpr_read_b32 v52, a40
    v_accvgpr_read_b32 v53, a41
    v_accvgpr_read_b32 v54, a42
    v_accvgpr_read_b32 v55, a43
    v_accvgpr_read_b32 v56, a44
    v_accvgpr_read_b32 v57, a45
    v_accvgpr_read_b32 v58, a46
    v_accvgpr_read_b32 v59, a47
    v_mul_f32 v52, v52, v157
    v_mul_f32 v53, v53, v157
    v_mul_f32 v54, v54, v157
    v_mul_f32 v55, v55, v157
    v_mul_f32 v56, v56, v157
    v_mul_f32 v57, v57, v157
    v_mul_f32 v58, v58, v157
    v_mul_f32 v59, v59, v157
    v_accvgpr_write_b32 a40, v52
    v_accvgpr_write_b32 a41, v53
    v_accvgpr_write_b32 a42, v54
    v_accvgpr_write_b32 a43, v55
    v_accvgpr_write_b32 a44, v56
    v_accvgpr_write_b32 a45, v57
    v_accvgpr_write_b32 a46, v58
    v_accvgpr_write_b32 a47, v59
    v_accvgpr_read_b32 v52, a48
    v_accvgpr_read_b32 v53, a49
    v_accvgpr_read_b32 v54, a50
    v_accvgpr_read_b32 v55, a51
    v_accvgpr_read_b32 v56, a52
    v_accvgpr_read_b32 v57, a53
    v_accvgpr_read_b32 v58, a54
    v_accvgpr_read_b32 v59, a55
    v_mul_f32 v52, v52, v157
    v_mul_f32 v53, v53, v157
    v_mul_f32 v54, v54, v157
    v_mul_f32 v55, v55, v157
    v_mul_f32 v56, v56, v157
    v_mul_f32 v57, v57, v157
    v_mul_f32 v58, v58, v157
    v_mul_f32 v59, v59, v157
    v_accvgpr_write_b32 a48, v52
    v_accvgpr_write_b32 a49, v53
    v_accvgpr_write_b32 a50, v54
    v_accvgpr_write_b32 a51, v55
    v_accvgpr_write_b32 a52, v56
    v_accvgpr_write_b32 a53, v57
    v_accvgpr_write_b32 a54, v58
    v_accvgpr_write_b32 a55, v59
    v_accvgpr_read_b32 v52, a56
    v_accvgpr_read_b32 v53, a57
    v_accvgpr_read_b32 v54, a58
    v_accvgpr_read_b32 v55, a59
    v_accvgpr_read_b32 v56, a60
    v_accvgpr_read_b32 v57, a61
    v_accvgpr_read_b32 v58, a62
    v_accvgpr_read_b32 v59, a63
    v_mul_f32 v52, v52, v157
    v_mul_f32 v53, v53, v157
    v_mul_f32 v54, v54, v157
    v_mul_f32 v55, v55, v157
    v_mul_f32 v56, v56, v157
    v_mul_f32 v57, v57, v157
    v_mul_f32 v58, v58, v157
    v_mul_f32 v59, v59, v157
    v_accvgpr_write_b32 a56, v52
    v_accvgpr_write_b32 a57, v53
    v_accvgpr_write_b32 a58, v54
    v_accvgpr_write_b32 a59, v55
    v_accvgpr_write_b32 a60, v56
    v_accvgpr_write_b32 a61, v57
    v_accvgpr_write_b32 a62, v58
    v_accvgpr_write_b32 a63, v59
    v_max3_f32 v155, v16, v17, v18
    v_max3_f32 v155, v155, v19, v20
    v_max3_f32 v155, v155, v21, v22
    v_max3_f32 v155, v155, v23, 0
    v_mov_b32 v156, v155
    s_nop 1
    v_permlane16_swap_b32 v155, v156
    v_max_f32 v155, v155, v156
    v_mov_b32 v156, v155
    s_nop 1
    v_permlane32_swap_b32 v155, v156
    v_max_f32 v155, v155, v156
    v_exp_f32 v157, -v155
    v_sub_f32 v16, v16, v155
    v_sub_f32 v17, v17, v155
    v_sub_f32 v18, v18, v155
    v_sub_f32 v19, v19, v155
    v_sub_f32 v20, v20, v155
    v_sub_f32 v21, v21, v155
    v_sub_f32 v22, v22, v155
    v_sub_f32 v23, v23, v155
    v_sub_f32 v104, v104, v155
    v_sub_f32 v105, v105, v155
    v_sub_f32 v106, v106, v155
    v_sub_f32 v107, v107, v155
    v_mul_f32 v128, v128, v157
    v_mul_f32 v129, v129, v157
    v_mul_f32 v130, v130, v157
    v_mul_f32 v131, v131, v157
    v_accvgpr_read_b32 v52, a64
    v_accvgpr_read_b32 v53, a65
    v_accvgpr_read_b32 v54, a66
    v_accvgpr_read_b32 v55, a67
    v_accvgpr_read_b32 v56, a68
    v_accvgpr_read_b32 v57, a69
    v_accvgpr_read_b32 v58, a70
    v_accvgpr_read_b32 v59, a71
    v_mul_f32 v52, v52, v157
    v_mul_f32 v53, v53, v157
    v_mul_f32 v54, v54, v157
    v_mul_f32 v55, v55, v157
    v_mul_f32 v56, v56, v157
    v_mul_f32 v57, v57, v157
    v_mul_f32 v58, v58, v157
    v_mul_f32 v59, v59, v157
    v_accvgpr_write_b32 a64, v52
    v_accvgpr_write_b32 a65, v53
    v_accvgpr_write_b32 a66, v54
    v_accvgpr_write_b32 a67, v55
    v_accvgpr_write_b32 a68, v56
    v_accvgpr_write_b32 a69, v57
    v_accvgpr_write_b32 a70, v58
    v_accvgpr_write_b32 a71, v59
    v_accvgpr_read_b32 v52, a72
    v_accvgpr_read_b32 v53, a73
    v_accvgpr_read_b32 v54, a74
    v_accvgpr_read_b32 v55, a75
    v_accvgpr_read_b32 v56, a76
    v_accvgpr_read_b32 v57, a77
    v_accvgpr_read_b32 v58, a78
    v_accvgpr_read_b32 v59, a79
    v_mul_f32 v52, v52, v157
    v_mul_f32 v53, v53, v157
    v_mul_f32 v54, v54, v157
    v_mul_f32 v55, v55, v157
    v_mul_f32 v56, v56, v157
    v_mul_f32 v57, v57, v157
    v_mul_f32 v58, v58, v157
    v_mul_f32 v59, v59, v157
    v_accvgpr_write_b32 a72, v52
    v_accvgpr_write_b32 a73, v53
    v_accvgpr_write_b32 a74, v54
    v_accvgpr_write_b32 a75, v55
    v_accvgpr_write_b32 a76, v56
    v_accvgpr_write_b32 a77, v57
    v_accvgpr_write_b32 a78, v58
    v_accvgpr_write_b32 a79, v59
    v_accvgpr_read_b32 v52, a80
    v_accvgpr_read_b32 v53, a81
    v_accvgpr_read_b32 v54, a82
    v_accvgpr_read_b32 v55, a83
    v_accvgpr_read_b32 v56, a84
    v_accvgpr_read_b32 v57, a85
    v_accvgpr_read_b32 v58, a86
    v_accvgpr_read_b32 v59, a87
    v_mul_f32 v52, v52, v157
    v_mul_f32 v53, v53, v157
    v_mul_f32 v54, v54, v157
    v_mul_f32 v55, v55, v157
    v_mul_f32 v56, v56, v157
    v_mul_f32 v57, v57, v157
    v_mul_f32 v58, v58, v157
    v_mul_f32 v59, v59, v157
    v_accvgpr_write_b32 a80, v52
    v_accvgpr_write_b32 a81, v53
    v_accvgpr_write_b32 a82, v54
    v_accvgpr_write_b32 a83, v55
    v_accvgpr_write_b32 a84, v56
    v_accvgpr_write_b32 a85, v57
    v_accvgpr_write_b32 a86, v58
    v_accvgpr_write_b32 a87, v59
    v_accvgpr_read_b32 v52, a88
    v_accvgpr_read_b32 v53, a89
    v_accvgpr_read_b32 v54, a90
    v_accvgpr_read_b32 v55, a91
    v_accvgpr_read_b32 v56, a92
    v_accvgpr_read_b32 v57, a93
    v_accvgpr_read_b32 v58, a94
    v_accvgpr_read_b32 v59, a95
    v_mul_f32 v52, v52, v157
    v_mul_f32 v53, v53, v157
    v_mul_f32 v54, v54, v157
    v_mul_f32 v55, v55, v157
    v_mul_f32 v56, v56, v157
    v_mul_f32 v57, v57, v157
    v_mul_f32 v58, v58, v157
    v_mul_f32 v59, v59, v157
    v_accvgpr_write_b32 a88, v52
    v_accvgpr_write_b32 a89, v53
    v_accvgpr_write_b32 a90, v54
    v_accvgpr_write_b32 a91, v55
    v_accvgpr_write_b32 a92, v56
    v_accvgpr_write_b32 a93, v57
    v_accvgpr_write_b32 a94, v58
    v_accvgpr_write_b32 a95, v59
    v_max3_f32 v155, v24, v25, v26
    v_max3_f32 v155, v155, v27, v28
    v_max3_f32 v155, v155, v29, v30
    v_max3_f32 v155, v155, v31, 0
    v_mov_b32 v156, v155
    s_nop 1
    v_permlane16_swap_b32 v155, v156
    v_max_f32 v155, v155, v156
    v_mov_b32 v156, v155
    s_nop 1
    v_permlane32_swap_b32 v155, v156
    v_max_f32 v155, v155, v156
    v_exp_f32 v157, -v155
    v_sub_f32 v24, v24, v155
    v_sub_f32 v25, v25, v155
    v_sub_f32 v26, v26, v155
    v_sub_f32 v27, v27, v155
    v_sub_f32 v28, v28, v155
    v_sub_f32 v29, v29, v155
    v_sub_f32 v30, v30, v155
    v_sub_f32 v31, v31, v155
    v_sub_f32 v108, v108, v155
    v_sub_f32 v109, v109, v155
    v_sub_f32 v110, v110, v155
    v_sub_f32 v111, v111, v155
    v_mul_f32 v132, v132, v157
    v_mul_f32 v133, v133, v157
    v_mul_f32 v134, v134, v157
    v_mul_f32 v135, v135, v157
    v_accvgpr_read_b32 v52, a96
    v_accvgpr_read_b32 v53, a97
    v_accvgpr_read_b32 v54, a98
    v_accvgpr_read_b32 v55, a99
    v_accvgpr_read_b32 v56, a100
    v_accvgpr_read_b32 v57, a101
    v_accvgpr_read_b32 v58, a102
    v_accvgpr_read_b32 v59, a103
    v_mul_f32 v52, v52, v157
    v_mul_f32 v53, v53, v157
    v_mul_f32 v54, v54, v157
    v_mul_f32 v55, v55, v157
    v_mul_f32 v56, v56, v157
    v_mul_f32 v57, v57, v157
    v_mul_f32 v58, v58, v157
    v_mul_f32 v59, v59, v157
    v_accvgpr_write_b32 a96, v52
    v_accvgpr_write_b32 a97, v53
    v_accvgpr_write_b32 a98, v54
    v_accvgpr_write_b32 a99, v55
    v_accvgpr_write_b32 a100, v56
    v_accvgpr_write_b32 a101, v57
    v_accvgpr_write_b32 a102, v58
    v_accvgpr_write_b32 a103, v59
    v_accvgpr_read_b32 v52, a104
    v_accvgpr_read_b32 v53, a105
    v_accvgpr_read_b32 v54, a106
    v_accvgpr_read_b32 v55, a107
    v_accvgpr_read_b32 v56, a108
    v_accvgpr_read_b32 v57, a109
    v_accvgpr_read_b32 v58, a110
    v_accvgpr_read_b32 v59, a111
    v_mul_f32 v52, v52, v157
    v_mul_f32 v53, v53, v157
    v_mul_f32 v54, v54, v157
    v_mul_f32 v55, v55, v157
    v_mul_f32 v56, v56, v157
    v_mul_f32 v57, v57, v157
    v_mul_f32 v58, v58, v157
    v_mul_f32 v59, v59, v157
    v_accvgpr_write_b32 a104, v52
    v_accvgpr_write_b32 a105, v53
    v_accvgpr_write_b32 a106, v54
    v_accvgpr_write_b32 a107, v55
    v_accvgpr_write_b32 a108, v56
    v_accvgpr_write_b32 a109, v57
    v_accvgpr_write_b32 a110, v58
    v_accvgpr_write_b32 a111, v59
    v_accvgpr_read_b32 v52, a112
    v_accvgpr_read_b32 v53, a113
    v_accvgpr_read_b32 v54, a114
    v_accvgpr_read_b32 v55, a115
    v_accvgpr_read_b32 v56, a116
    v_accvgpr_read_b32 v57, a117
    v_accvgpr_read_b32 v58, a118
    v_accvgpr_read_b32 v59, a119
    v_mul_f32 v52, v52, v157
    v_mul_f32 v53, v53, v157
    v_mul_f32 v54, v54, v157
    v_mul_f32 v55, v55, v157
    v_mul_f32 v56, v56, v157
    v_mul_f32 v57, v57, v157
    v_mul_f32 v58, v58, v157
    v_mul_f32 v59, v59, v157
    v_accvgpr_write_b32 a112, v52
    v_accvgpr_write_b32 a113, v53
    v_accvgpr_write_b32 a114, v54
    v_accvgpr_write_b32 a115, v55
    v_accvgpr_write_b32 a116, v56
    v_accvgpr_write_b32 a117, v57
    v_accvgpr_write_b32 a118, v58
    v_accvgpr_write_b32 a119, v59
    v_accvgpr_read_b32 v52, a120
    v_accvgpr_read_b32 v53, a121
    v_accvgpr_read_b32 v54, a122
    v_accvgpr_read_b32 v55, a123
    v_accvgpr_read_b32 v56, a124
    v_accvgpr_read_b32 v57, a125
    v_accvgpr_read_b32 v58, a126
    v_accvgpr_read_b32 v59, a127
    v_mul_f32 v52, v52, v157
    v_mul_f32 v53, v53, v157
    v_mul_f32 v54, v54, v157
    v_mul_f32 v55, v55, v157
    v_mul_f32 v56, v56, v157
    v_mul_f32 v57, v57, v157
    v_mul_f32 v58, v58, v157
    v_mul_f32 v59, v59, v157
    v_accvgpr_write_b32 a120, v52
    v_accvgpr_write_b32 a121, v53
    v_accvgpr_write_b32 a122, v54
    v_accvgpr_write_b32 a123, v55
    v_accvgpr_write_b32 a124, v56
    v_accvgpr_write_b32 a125, v57
    v_accvgpr_write_b32 a126, v58
    v_accvgpr_write_b32 a127, v59
    v_max3_f32 v155, v32, v33, v34
    v_max3_f32 v155, v155, v35, v36
    v_max3_f32 v155, v155, v37, v38
    v_max3_f32 v155, v155, v39, 0
    v_mov_b32 v156, v155
    s_nop 1
    v_permlane16_swap_b32 v155, v156
    v_max_f32 v155, v155, v156
    v_mov_b32 v156, v155
    s_nop 1
    v_permlane32_swap_b32 v155, v156
    v_max_f32 v155, v155, v156
    v_exp_f32 v157, -v155
    v_sub_f32 v32, v32, v155
    v_sub_f32 v33, v33, v155
    v_sub_f32 v34, v34, v155
    v_sub_f32 v35, v35, v155
    v_sub_f32 v36, v36, v155
    v_sub_f32 v37, v37, v155
    v_sub_f32 v38, v38, v155
    v_sub_f32 v39, v39, v155
    v_sub_f32 v112, v112, v155
    v_sub_f32 v113, v113, v155
    v_sub_f32 v114, v114, v155
    v_sub_f32 v115, v115, v155
    v_mul_f32 v136, v136, v157
    v_mul_f32 v137, v137, v157
    v_mul_f32 v138, v138, v157
    v_mul_f32 v139, v139, v157
    v_accvgpr_read_b32 v52, a128
    v_accvgpr_read_b32 v53, a129
    v_accvgpr_read_b32 v54, a130
    v_accvgpr_read_b32 v55, a131
    v_accvgpr_read_b32 v56, a132
    v_accvgpr_read_b32 v57, a133
    v_accvgpr_read_b32 v58, a134
    v_accvgpr_read_b32 v59, a135
    v_mul_f32 v52, v52, v157
    v_mul_f32 v53, v53, v157
    v_mul_f32 v54, v54, v157
    v_mul_f32 v55, v55, v157
    v_mul_f32 v56, v56, v157
    v_mul_f32 v57, v57, v157
    v_mul_f32 v58, v58, v157
    v_mul_f32 v59, v59, v157
    v_accvgpr_write_b32 a128, v52
    v_accvgpr_write_b32 a129, v53
    v_accvgpr_write_b32 a130, v54
    v_accvgpr_write_b32 a131, v55
    v_accvgpr_write_b32 a132, v56
    v_accvgpr_write_b32 a133, v57
    v_accvgpr_write_b32 a134, v58
    v_accvgpr_write_b32 a135, v59
    v_accvgpr_read_b32 v52, a136
    v_accvgpr_read_b32 v53, a137
    v_accvgpr_read_b32 v54, a138
    v_accvgpr_read_b32 v55, a139
    v_accvgpr_read_b32 v56, a140
    v_accvgpr_read_b32 v57, a141
    v_accvgpr_read_b32 v58, a142
    v_accvgpr_read_b32 v59, a143
    v_mul_f32 v52, v52, v157
    v_mul_f32 v53, v53, v157
    v_mul_f32 v54, v54, v157
    v_mul_f32 v55, v55, v157
    v_mul_f32 v56, v56, v157
    v_mul_f32 v57, v57, v157
    v_mul_f32 v58, v58, v157
    v_mul_f32 v59, v59, v157
    v_accvgpr_write_b32 a136, v52
    v_accvgpr_write_b32 a137, v53
    v_accvgpr_write_b32 a138, v54
    v_accvgpr_write_b32 a139, v55
    v_accvgpr_write_b32 a140, v56
    v_accvgpr_write_b32 a141, v57
    v_accvgpr_write_b32 a142, v58
    v_accvgpr_write_b32 a143, v59
    v_accvgpr_read_b32 v52, a144
    v_accvgpr_read_b32 v53, a145
    v_accvgpr_read_b32 v54, a146
    v_accvgpr_read_b32 v55, a147
    v_accvgpr_read_b32 v56, a148
    v_accvgpr_read_b32 v57, a149
    v_accvgpr_read_b32 v58, a150
    v_accvgpr_read_b32 v59, a151
    v_mul_f32 v52, v52, v157
    v_mul_f32 v53, v53, v157
    v_mul_f32 v54, v54, v157
    v_mul_f32 v55, v55, v157
    v_mul_f32 v56, v56, v157
    v_mul_f32 v57, v57, v157
    v_mul_f32 v58, v58, v157
    v_mul_f32 v59, v59, v157
    v_accvgpr_write_b32 a144, v52
    v_accvgpr_write_b32 a145, v53
    v_accvgpr_write_b32 a146, v54
    v_accvgpr_write_b32 a147, v55
    v_accvgpr_write_b32 a148, v56
    v_accvgpr_write_b32 a149, v57
    v_accvgpr_write_b32 a150, v58
    v_accvgpr_write_b32 a151, v59
    v_accvgpr_read_b32 v52, a152
    v_accvgpr_read_b32 v53, a153
    v_accvgpr_read_b32 v54, a154
    v_accvgpr_read_b32 v55, a155
    v_accvgpr_read_b32 v56, a156
    v_accvgpr_read_b32 v57, a157
    v_accvgpr_read_b32 v58, a158
    v_accvgpr_read_b32 v59, a159
    v_mul_f32 v52, v52, v157
    v_mul_f32 v53, v53, v157
    v_mul_f32 v54, v54, v157
    v_mul_f32 v55, v55, v157
    v_mul_f32 v56, v56, v157
    v_mul_f32 v57, v57, v157
    v_mul_f32 v58, v58, v157
    v_mul_f32 v59, v59, v157
    v_accvgpr_write_b32 a152, v52
    v_accvgpr_write_b32 a153, v53
    v_accvgpr_write_b32 a154, v54
    v_accvgpr_write_b32 a155, v55
    v_accvgpr_write_b32 a156, v56
    v_accvgpr_write_b32 a157, v57
    v_accvgpr_write_b32 a158, v58
    v_accvgpr_write_b32 a159, v59
    v_max3_f32 v155, v40, v41, v42
    v_max3_f32 v155, v155, v43, v44
    v_max3_f32 v155, v155, v45, v46
    v_max3_f32 v155, v155, v47, 0
    v_mov_b32 v156, v155
    s_nop 1
    v_permlane16_swap_b32 v155, v156
    v_max_f32 v155, v155, v156
    v_mov_b32 v156, v155
    s_nop 1
    v_permlane32_swap_b32 v155, v156
    v_max_f32 v155, v155, v156
    v_exp_f32 v157, -v155
    v_sub_f32 v40, v40, v155
    v_sub_f32 v41, v41, v155
    v_sub_f32 v42, v42, v155
    v_sub_f32 v43, v43, v155
    v_sub_f32 v44, v44, v155
    v_sub_f32 v45, v45, v155
    v_sub_f32 v46, v46, v155
    v_sub_f32 v47, v47, v155
    v_sub_f32 v116, v116, v155
    v_sub_f32 v117, v117, v155
    v_sub_f32 v118, v118, v155
    v_sub_f32 v119, v119, v155
    v_mul_f32 v140, v140, v157
    v_mul_f32 v141, v141, v157
    v_mul_f32 v142, v142, v157
    v_mul_f32 v143, v143, v157
    v_accvgpr_read_b32 v52, a160
    v_accvgpr_read_b32 v53, a161
    v_accvgpr_read_b32 v54, a162
    v_accvgpr_read_b32 v55, a163
    v_accvgpr_read_b32 v56, a164
    v_accvgpr_read_b32 v57, a165
    v_accvgpr_read_b32 v58, a166
    v_accvgpr_read_b32 v59, a167
    v_mul_f32 v52, v52, v157
    v_mul_f32 v53, v53, v157
    v_mul_f32 v54, v54, v157
    v_mul_f32 v55, v55, v157
    v_mul_f32 v56, v56, v157
    v_mul_f32 v57, v57, v157
    v_mul_f32 v58, v58, v157
    v_mul_f32 v59, v59, v157
    v_accvgpr_write_b32 a160, v52
    v_accvgpr_write_b32 a161, v53
    v_accvgpr_write_b32 a162, v54
    v_accvgpr_write_b32 a163, v55
    v_accvgpr_write_b32 a164, v56
    v_accvgpr_write_b32 a165, v57
    v_accvgpr_write_b32 a166, v58
    v_accvgpr_write_b32 a167, v59
    v_accvgpr_read_b32 v52, a168
    v_accvgpr_read_b32 v53, a169
    v_accvgpr_read_b32 v54, a170
    v_accvgpr_read_b32 v55, a171
    v_accvgpr_read_b32 v56, a172
    v_accvgpr_read_b32 v57, a173
    v_accvgpr_read_b32 v58, a174
    v_accvgpr_read_b32 v59, a175
    v_mul_f32 v52, v52, v157
    v_mul_f32 v53, v53, v157
    v_mul_f32 v54, v54, v157
    v_mul_f32 v55, v55, v157
    v_mul_f32 v56, v56, v157
    v_mul_f32 v57, v57, v157
    v_mul_f32 v58, v58, v157
    v_mul_f32 v59, v59, v157
    v_accvgpr_write_b32 a168, v52
    v_accvgpr_write_b32 a169, v53
    v_accvgpr_write_b32 a170, v54
    v_accvgpr_write_b32 a171, v55
    v_accvgpr_write_b32 a172, v56
    v_accvgpr_write_b32 a173, v57
    v_accvgpr_write_b32 a174, v58
    v_accvgpr_write_b32 a175, v59
    v_accvgpr_read_b32 v52, a176
    v_accvgpr_read_b32 v53, a177
    v_accvgpr_read_b32 v54, a178
    v_accvgpr_read_b32 v55, a179
    v_accvgpr_read_b32 v56, a180
    v_accvgpr_read_b32 v57, a181
    v_accvgpr_read_b32 v58, a182
    v_accvgpr_read_b32 v59, a183
    v_mul_f32 v52, v52, v157
    v_mul_f32 v53, v53, v157
    v_mul_f32 v54, v54, v157
    v_mul_f32 v55, v55, v157
    v_mul_f32 v56, v56, v157
    v_mul_f32 v57, v57, v157
    v_mul_f32 v58, v58, v157
    v_mul_f32 v59, v59, v157
    v_accvgpr_write_b32 a176, v52
    v_accvgpr_write_b32 a177, v53
    v_accvgpr_write_b32 a178, v54
    v_accvgpr_write_b32 a179, v55
    v_accvgpr_write_b32 a180, v56
    v_accvgpr_write_b32 a181, v57
    v_accvgpr_write_b32 a182, v58
    v_accvgpr_write_b32 a183, v59
    v_accvgpr_read_b32 v52, a184
    v_accvgpr_read_b32 v53, a185
    v_accvgpr_read_b32 v54, a186
    v_accvgpr_read_b32 v55, a187
    v_accvgpr_read_b32 v56, a188
    v_accvgpr_read_b32 v57, a189
    v_accvgpr_read_b32 v58, a190
    v_accvgpr_read_b32 v59, a191
    v_mul_f32 v52, v52, v157
    v_mul_f32 v53, v53, v157
    v_mul_f32 v54, v54, v157
    v_mul_f32 v55, v55, v157
    v_mul_f32 v56, v56, v157
    v_mul_f32 v57, v57, v157
    v_mul_f32 v58, v58, v157
    v_mul_f32 v59, v59, v157
    v_accvgpr_write_b32 a184, v52
    v_accvgpr_write_b32 a185, v53
    v_accvgpr_write_b32 a186, v54
    v_accvgpr_write_b32 a187, v55
    v_accvgpr_write_b32 a188, v56
    v_accvgpr_write_b32 a189, v57
    v_accvgpr_write_b32 a190, v58
    v_accvgpr_write_b32 a191, v59
    s_setpc_b64 s[70:71]
.section .rodata,"a"
.p2align 6
.amdhsa_kernel standalone__mha_softmax__near_ridge_kernel
  .amdhsa_next_free_vgpr 512
  .amdhsa_next_free_sgpr 72
  .amdhsa_accum_offset 256
  .amdhsa_group_segment_fixed_size 0
  .amdhsa_kernarg_size 48
  .amdhsa_user_sgpr_count 2
  .amdhsa_user_sgpr_kernarg_segment_ptr 1
  .amdhsa_system_sgpr_workgroup_id_x 1
.end_amdhsa_kernel
```
